```python
import torch

def _softmax(x, axis=-1):
    return torch.softmax(x, dim=axis)

def _gelu(x):
    return torch.nn.functional.gelu(x, approximate='tanh')

def _silu(x):
    return torch.nn.functional.silu(x)

def _sigmoid(x):
    return torch.sigmoid(x)

def _layernorm(x, axis=-1, eps=1e-05):
    m = x.mean(dim=axis, keepdim=True)
    v = x.var(dim=axis, keepdim=True, unbiased=False)
    return (x - m) / torch.sqrt(v + eps)

def _scatter_add(tgt, idx, src, axis=0):
    return tgt.clone().index_add_(axis, idx, src)

def _segment_sum(src, seg, n):
    out = torch.zeros((n,) + src.shape[1:], dtype=src.dtype)
    return out.index_add_(0, seg, src)

def _pad(x, pw):
    flat = tuple((v for pair in reversed(pw) for v in pair))
    return torch.nn.functional.pad(x, flat)
kernel_name = 'adaLN_cond__spectral_fnet__mixer_gmlp__prompt'

def setup_inputs():

    _w = lambda a: (lambda t: t.to(torch.bfloat16) if t.is_floating_point() else t)(torch.as_tensor(a))

    def _A_setup():
        B, S, D = (1, 2048, 512)
        ns = torch.arange(S)[:, None] * torch.arange(S)[None, :]
        nd = torch.arange(D)[:, None] * torch.arange(D)[None, :]
        Ws_re = torch.cos(-2.0 * torch.pi * ns / S).to(float)
        Ws_im = torch.sin(-2.0 * torch.pi * ns / S).to(float)
        Wd_re = torch.cos(-2.0 * torch.pi * nd / D).to(float)
        Wd_im = torch.sin(-2.0 * torch.pi * nd / D).to(float)
        return {'x': _w((lambda *s: torch.randn(*s, dtype=torch.bfloat16) * 0.05)(B, S, D)), 'dft_seq_re': _w(Ws_re), 'dft_seq_im': _w(Ws_im), 'dft_hid_re': _w(Wd_re), 'dft_hid_im': _w(Wd_im)}
    _A_in = _A_setup()

    def _B_setup():
        B, S, D, F = (1, 2048, 512, 1792)
        Fh = F // 2
        return {'x': _w((lambda *s: torch.randn(*s, dtype=torch.bfloat16) * 0.05)(B, S, D)), 'w_in': _w((lambda *s: torch.randn(*s, dtype=torch.bfloat16) * 3.2)(D, 2 * Fh)), 'w_sp': _w(0.01 * (lambda *s: torch.randn(*s, dtype=torch.bfloat16) * 3.2)(S, S)), 'b_sp': _w(1.0 + 0.01 * (lambda *s: torch.randn(*s, dtype=torch.bfloat16) * 1.6)(S)), 'w_out': _w((lambda *s: torch.randn(*s, dtype=torch.bfloat16) * 1.6)(Fh, D))}
    _B_in = _B_setup()
    return {'A_x': _A_in['x'], 'A_dft_seq_re': _A_in['dft_seq_re'], 'A_dft_seq_im': _A_in['dft_seq_im'], 'A_dft_hid_re': _A_in['dft_hid_re'], 'A_dft_hid_im': _A_in['dft_hid_im'], 'B_x': _B_in['x'], 'B_w_in': _B_in['w_in'], 'B_w_sp': _B_in['w_sp'], 'B_b_sp': _B_in['b_sp'], 'B_w_out': _B_in['w_out'], 'c': _w((lambda *s: torch.randn(*s, dtype=torch.bfloat16) * 0.1)(1, 512) * 8.0), 'w_mod': _w((lambda *s: torch.randn(*s, dtype=torch.bfloat16) * 0.1)(512, 6 * 512) * 512 ** (-0.5) * 8.0)}

def reference(A_x, A_dft_seq_re, A_dft_seq_im, A_dft_hid_re, A_dft_hid_im, B_x, B_w_in, B_w_sp, B_b_sp, B_w_out, c, w_mod):

    def _A_ref(x, dft_seq_re, dft_seq_im, dft_hid_re, dft_hid_im):
        a = torch.einsum('bsd,ed->bse', x, dft_hid_re)
        b = torch.einsum('bsd,ed->bse', x, dft_hid_im)
        y = torch.einsum('ts,bse->bte', dft_seq_re, a) - torch.einsum('ts,bse->bte', dft_seq_im, b)
        return y

    def _B_ref(x, w_in, w_sp, b_sp, w_out):
        B, S, D = x.shape
        F = w_in.shape[-1]
        Fh = F // 2
        z = _gelu(torch.einsum('bsd,df->bsf', x, w_in))
        z1 = z[..., :Fh].clone()
        z2 = _layernorm(z[..., Fh:], axis=-1)
        g = torch.einsum('ts,bsf->btf', w_sp, z2) + b_sp[None, :, None]
        return torch.einsum('bsf,fd->bsd', z1 * g, w_out)
    x = A_x
    mod = (_silu(c) @ w_mod).reshape(c.shape[0], 6, 1, -1)
    sa, ca, ga, sb, cb, gb = (mod[:, 0].clone(), mod[:, 1].clone(), mod[:, 2].clone(), mod[:, 3].clone(), mod[:, 4].clone(), mod[:, 5].clone())
    h = _layernorm(x, axis=-1) * (1 + ca) + sa
    x = x + ga * _A_ref(h, A_dft_seq_re, A_dft_seq_im, A_dft_hid_re, A_dft_hid_im)
    h = _layernorm(x, axis=-1) * (1 + cb) + sb
    x = x + gb * _B_ref(h, B_w_in, B_w_sp, B_b_sp, B_w_out)
    return x
```

```asm
; @launch grid=(256,1,1) block=(256,1,1) lds=163840
.amdgcn_target "amdgcn-amd-amdhsa--gfx950"
.text
.globl adaLN_cond__spectral_fnet__mixer_gmlp__prompt_kernel
.p2align 8
.type adaLN_cond__spectral_fnet__mixer_gmlp__prompt_kernel,@function
adaLN_cond__spectral_fnet__mixer_gmlp__prompt_kernel:
  s_cmp_ge_u32 s2, 256
  s_cbranch_scc1 persist_end
  s_load_dwordx2 s[4:5], s[0:1], 0
  s_load_dwordx2 s[6:7], s[0:1], 112
  s_load_dwordx2 s[24:25], s[0:1], 80
  s_load_dwordx2 s[26:27], s[0:1], 88
  s_load_dwordx2 s[44:45], s[0:1], 48
  s_load_dwordx2 s[46:47], s[0:1], 56
  s_getpc_b64 s[10:11]
e_pc:
  s_sub_u32 s10, s10, e_pc-adaLN_cond__spectral_fnet__mixer_gmlp__prompt_kernel
  s_subb_u32 s11, s11, 0
  v_lshlrev_b32 v240, 7, v0
  v_cmp_gt_u32 vcc, 128, v0
  s_nop 0
  s_and_saveexec_b64 s[8:9], vcc
  s_cbranch_execz e_nc
  global_load_dword v241, v240, s[10:11]
e_nc:
  s_mov_b64 exec, s[8:9]
  v_lshrrev_b32 v2, 6, v0
  s_nop 0
  v_readfirstlane_b32 s3, v2
  s_waitcnt lgkmcnt(0)
  s_mov_b32 s96, s6
  s_mov_b32 s97, s7
  s_mov_b32 s98, 0x2000000
  s_mov_b32 s99, 0x20000
  v_mov_b32 v5, 0
  s_mov_b32 s12, 23396352
  buffer_load_dword v249, v5, s[96:99], s12 offen sc1
  s_mov_b32 s65, 0
  v_and_b32 v1, 63, v0
  s_cmp_ge_u32 s2, 217
  s_cbranch_scc1 p1_idle
  s_cmp_ge_u32 s2, 161
  s_cbranch_scc1 p1_wf
  s_cmp_ge_u32 s2, 65
  s_cbranch_scc1 p1_mod
  s_lshl_b32 s28, s2, 3
  s_lshl_b32 s29, s3, 1
  s_add_u32 s28, s28, s29
  v_lshlrev_b32 v2, 4, v1
  v_mov_b32 v200, 0x3b000000
  v_mov_b32 v201, 0x3727c5ac
  v_mov_b32 v202, 0x3f803f80
  s_add_u32 s34, s28, 0
  s_lshl_b32 s30, s34, 10
  s_sub_u32 s31, 2048, s34
  s_and_b32 s31, s31, 2047
  s_lshl_b32 s31, s31, 10
  s_sub_u32 s32, 1024, s34
  s_lshl_b32 s32, s32, 10
  s_add_u32 s33, s34, 1024
  s_lshl_b32 s33, s33, 10
  s_mov_b32 s40, 1.0
  s_cmp_eq_u32 s34, 0
  s_cselect_b32 s40, 0.5, s40
  s_cmp_eq_u32 s34, 512
  s_cselect_b32 s40, 0.5, s40
  s_cmp_gt_u32 s34, 512
  s_cselect_b32 s40, 0, s40
  s_add_u32 s39, s28, 1
  s_lshl_b32 s35, s39, 10
  s_sub_u32 s36, 2048, s39
  s_and_b32 s36, s36, 2047
  s_lshl_b32 s36, s36, 10
  s_sub_u32 s37, 1024, s39
  s_lshl_b32 s37, s37, 10
  s_add_u32 s38, s39, 1024
  s_lshl_b32 s38, s38, 10
  s_mov_b32 s41, 1.0
  s_cmp_eq_u32 s39, 0
  s_cselect_b32 s41, 0.5, s41
  s_cmp_eq_u32 s39, 512
  s_cselect_b32 s41, 0.5, s41
  s_cmp_gt_u32 s39, 512
  s_cselect_b32 s41, 0, s41
  s_waitcnt lgkmcnt(0)
  s_mov_b32 s8, s4
  s_mov_b32 s9, s5
  s_mov_b32 s10, 0x200000
  s_mov_b32 s11, 0x20000
  s_mov_b32 s12, s6
  s_mov_b32 s13, s7
  s_mov_b32 s14, 0x2000000
  s_mov_b32 s15, 0x20000
  buffer_load_dwordx4 v[8:11], v2, s[8:11], s30 offen
  buffer_load_dwordx4 v[12:15], v2, s[8:11], s31 offen
  buffer_load_dwordx4 v[16:19], v2, s[8:11], s32 offen
  buffer_load_dwordx4 v[20:23], v2, s[8:11], s33 offen
  buffer_load_dwordx4 v[24:27], v2, s[8:11], s35 offen
  buffer_load_dwordx4 v[28:31], v2, s[8:11], s36 offen
  buffer_load_dwordx4 v[32:35], v2, s[8:11], s37 offen
  buffer_load_dwordx4 v[36:39], v2, s[8:11], s38 offen
  v_mov_b32 v4, 0
  v_mov_b32 v5, 0
  v_mov_b32 v6, 0
  v_mov_b32 v7, 0
  v_lshlrev_b32 v3, 4, v0
  s_lshl_b32 s42, s2, 12
  s_add_u32 s42, s42, 32768
  s_cmp_lt_u32 s2, 32
  s_cselect_b32 s42, s42, 0x40000000
  buffer_store_dwordx4 v[4:7], v3, s[12:15], s42 offen sc1
  s_waitcnt vmcnt(8)
  v_dot2_f32_bf16 v40, v8, v202, 0
  v_dot2_f32_bf16 v48, v8, v8, 0
  v_dot2_f32_bf16 v40, v9, v202, v40
  v_dot2_f32_bf16 v48, v9, v9, v48
  v_dot2_f32_bf16 v40, v10, v202, v40
  v_dot2_f32_bf16 v48, v10, v10, v48
  v_dot2_f32_bf16 v40, v11, v202, v40
  v_dot2_f32_bf16 v48, v11, v11, v48
  s_waitcnt vmcnt(7)
  v_dot2_f32_bf16 v41, v12, v202, 0
  v_dot2_f32_bf16 v49, v12, v12, 0
  v_dot2_f32_bf16 v41, v13, v202, v41
  v_dot2_f32_bf16 v49, v13, v13, v49
  v_dot2_f32_bf16 v41, v14, v202, v41
  v_dot2_f32_bf16 v49, v14, v14, v49
  v_dot2_f32_bf16 v41, v15, v202, v41
  v_dot2_f32_bf16 v49, v15, v15, v49
  s_waitcnt vmcnt(6)
  v_dot2_f32_bf16 v42, v16, v202, 0
  v_dot2_f32_bf16 v50, v16, v16, 0
  v_dot2_f32_bf16 v42, v17, v202, v42
  v_dot2_f32_bf16 v50, v17, v17, v50
  v_dot2_f32_bf16 v42, v18, v202, v42
  v_dot2_f32_bf16 v50, v18, v18, v50
  v_dot2_f32_bf16 v42, v19, v202, v42
  v_dot2_f32_bf16 v50, v19, v19, v50
  s_waitcnt vmcnt(5)
  v_dot2_f32_bf16 v43, v20, v202, 0
  v_dot2_f32_bf16 v51, v20, v20, 0
  v_dot2_f32_bf16 v43, v21, v202, v43
  v_dot2_f32_bf16 v51, v21, v21, v51
  v_dot2_f32_bf16 v43, v22, v202, v43
  v_dot2_f32_bf16 v51, v22, v22, v51
  v_dot2_f32_bf16 v43, v23, v202, v43
  v_dot2_f32_bf16 v51, v23, v23, v51
  s_waitcnt vmcnt(4)
  v_dot2_f32_bf16 v44, v24, v202, 0
  v_dot2_f32_bf16 v52, v24, v24, 0
  v_dot2_f32_bf16 v44, v25, v202, v44
  v_dot2_f32_bf16 v52, v25, v25, v52
  v_dot2_f32_bf16 v44, v26, v202, v44
  v_dot2_f32_bf16 v52, v26, v26, v52
  v_dot2_f32_bf16 v44, v27, v202, v44
  v_dot2_f32_bf16 v52, v27, v27, v52
  s_waitcnt vmcnt(3)
  v_dot2_f32_bf16 v45, v28, v202, 0
  v_dot2_f32_bf16 v53, v28, v28, 0
  v_dot2_f32_bf16 v45, v29, v202, v45
  v_dot2_f32_bf16 v53, v29, v29, v53
  v_dot2_f32_bf16 v45, v30, v202, v45
  v_dot2_f32_bf16 v53, v30, v30, v53
  v_dot2_f32_bf16 v45, v31, v202, v45
  v_dot2_f32_bf16 v53, v31, v31, v53
  s_waitcnt vmcnt(2)
  v_dot2_f32_bf16 v46, v32, v202, 0
  v_dot2_f32_bf16 v54, v32, v32, 0
  v_dot2_f32_bf16 v46, v33, v202, v46
  v_dot2_f32_bf16 v54, v33, v33, v54
  v_dot2_f32_bf16 v46, v34, v202, v46
  v_dot2_f32_bf16 v54, v34, v34, v54
  v_dot2_f32_bf16 v46, v35, v202, v46
  v_dot2_f32_bf16 v54, v35, v35, v54
  s_waitcnt vmcnt(1)
  v_dot2_f32_bf16 v47, v36, v202, 0
  v_dot2_f32_bf16 v55, v36, v36, 0
  v_dot2_f32_bf16 v47, v37, v202, v47
  v_dot2_f32_bf16 v55, v37, v37, v55
  v_dot2_f32_bf16 v47, v38, v202, v47
  v_dot2_f32_bf16 v55, v38, v38, v55
  v_dot2_f32_bf16 v47, v39, v202, v47
  v_dot2_f32_bf16 v55, v39, v39, v55
  v_lshlrev_b32 v64, 16, v8
  v_and_b32 v65, 0xffff0000, v8
  v_lshlrev_b32 v66, 16, v9
  v_and_b32 v67, 0xffff0000, v9
  v_lshlrev_b32 v68, 16, v10
  v_and_b32 v69, 0xffff0000, v10
  v_lshlrev_b32 v70, 16, v11
  v_and_b32 v71, 0xffff0000, v11
  v_lshlrev_b32 v72, 16, v12
  v_and_b32 v73, 0xffff0000, v12
  v_lshlrev_b32 v74, 16, v13
  v_and_b32 v75, 0xffff0000, v13
  v_lshlrev_b32 v76, 16, v14
  v_and_b32 v77, 0xffff0000, v14
  v_lshlrev_b32 v78, 16, v15
  v_and_b32 v79, 0xffff0000, v15
  v_lshlrev_b32 v80, 16, v16
  v_and_b32 v81, 0xffff0000, v16
  v_lshlrev_b32 v82, 16, v17
  v_and_b32 v83, 0xffff0000, v17
  v_lshlrev_b32 v84, 16, v18
  v_and_b32 v85, 0xffff0000, v18
  v_lshlrev_b32 v86, 16, v19
  v_and_b32 v87, 0xffff0000, v19
  v_lshlrev_b32 v88, 16, v20
  v_and_b32 v89, 0xffff0000, v20
  v_lshlrev_b32 v90, 16, v21
  v_and_b32 v91, 0xffff0000, v21
  v_lshlrev_b32 v92, 16, v22
  v_and_b32 v93, 0xffff0000, v22
  v_lshlrev_b32 v94, 16, v23
  v_and_b32 v95, 0xffff0000, v23
  v_lshlrev_b32 v96, 16, v24
  v_and_b32 v97, 0xffff0000, v24
  v_lshlrev_b32 v98, 16, v25
  v_and_b32 v99, 0xffff0000, v25
  v_lshlrev_b32 v100, 16, v26
  v_and_b32 v101, 0xffff0000, v26
  v_lshlrev_b32 v102, 16, v27
  v_and_b32 v103, 0xffff0000, v27
  v_lshlrev_b32 v104, 16, v28
  v_and_b32 v105, 0xffff0000, v28
  v_lshlrev_b32 v106, 16, v29
  v_and_b32 v107, 0xffff0000, v29
  v_lshlrev_b32 v108, 16, v30
  v_and_b32 v109, 0xffff0000, v30
  v_lshlrev_b32 v110, 16, v31
  v_and_b32 v111, 0xffff0000, v31
  v_lshlrev_b32 v112, 16, v32
  v_and_b32 v113, 0xffff0000, v32
  v_lshlrev_b32 v114, 16, v33
  v_and_b32 v115, 0xffff0000, v33
  v_lshlrev_b32 v116, 16, v34
  v_and_b32 v117, 0xffff0000, v34
  v_lshlrev_b32 v118, 16, v35
  v_and_b32 v119, 0xffff0000, v35
  v_lshlrev_b32 v120, 16, v36
  v_and_b32 v121, 0xffff0000, v36
  v_lshlrev_b32 v122, 16, v37
  v_and_b32 v123, 0xffff0000, v37
  v_lshlrev_b32 v124, 16, v38
  v_and_b32 v125, 0xffff0000, v38
  v_lshlrev_b32 v126, 16, v39
  v_and_b32 v127, 0xffff0000, v39
  v_add_f32 v40, v40, v40 quad_perm:[1,0,3,2] row_mask:0xf bank_mask:0xf
  v_add_f32 v41, v41, v41 quad_perm:[1,0,3,2] row_mask:0xf bank_mask:0xf
  v_add_f32 v42, v42, v42 quad_perm:[1,0,3,2] row_mask:0xf bank_mask:0xf
  v_add_f32 v43, v43, v43 quad_perm:[1,0,3,2] row_mask:0xf bank_mask:0xf
  v_add_f32 v44, v44, v44 quad_perm:[1,0,3,2] row_mask:0xf bank_mask:0xf
  v_add_f32 v45, v45, v45 quad_perm:[1,0,3,2] row_mask:0xf bank_mask:0xf
  v_add_f32 v46, v46, v46 quad_perm:[1,0,3,2] row_mask:0xf bank_mask:0xf
  v_add_f32 v47, v47, v47 quad_perm:[1,0,3,2] row_mask:0xf bank_mask:0xf
  v_add_f32 v48, v48, v48 quad_perm:[1,0,3,2] row_mask:0xf bank_mask:0xf
  v_add_f32 v49, v49, v49 quad_perm:[1,0,3,2] row_mask:0xf bank_mask:0xf
  v_add_f32 v50, v50, v50 quad_perm:[1,0,3,2] row_mask:0xf bank_mask:0xf
  v_add_f32 v51, v51, v51 quad_perm:[1,0,3,2] row_mask:0xf bank_mask:0xf
  v_add_f32 v52, v52, v52 quad_perm:[1,0,3,2] row_mask:0xf bank_mask:0xf
  v_add_f32 v53, v53, v53 quad_perm:[1,0,3,2] row_mask:0xf bank_mask:0xf
  v_add_f32 v54, v54, v54 quad_perm:[1,0,3,2] row_mask:0xf bank_mask:0xf
  v_add_f32 v55, v55, v55 quad_perm:[1,0,3,2] row_mask:0xf bank_mask:0xf
  v_add_f32 v40, v40, v40 quad_perm:[2,3,0,1] row_mask:0xf bank_mask:0xf
  v_add_f32 v41, v41, v41 quad_perm:[2,3,0,1] row_mask:0xf bank_mask:0xf
  v_add_f32 v42, v42, v42 quad_perm:[2,3,0,1] row_mask:0xf bank_mask:0xf
  v_add_f32 v43, v43, v43 quad_perm:[2,3,0,1] row_mask:0xf bank_mask:0xf
  v_add_f32 v44, v44, v44 quad_perm:[2,3,0,1] row_mask:0xf bank_mask:0xf
  v_add_f32 v45, v45, v45 quad_perm:[2,3,0,1] row_mask:0xf bank_mask:0xf
  v_add_f32 v46, v46, v46 quad_perm:[2,3,0,1] row_mask:0xf bank_mask:0xf
  v_add_f32 v47, v47, v47 quad_perm:[2,3,0,1] row_mask:0xf bank_mask:0xf
  v_add_f32 v48, v48, v48 quad_perm:[2,3,0,1] row_mask:0xf bank_mask:0xf
  v_add_f32 v49, v49, v49 quad_perm:[2,3,0,1] row_mask:0xf bank_mask:0xf
  v_add_f32 v50, v50, v50 quad_perm:[2,3,0,1] row_mask:0xf bank_mask:0xf
  v_add_f32 v51, v51, v51 quad_perm:[2,3,0,1] row_mask:0xf bank_mask:0xf
  v_add_f32 v52, v52, v52 quad_perm:[2,3,0,1] row_mask:0xf bank_mask:0xf
  v_add_f32 v53, v53, v53 quad_perm:[2,3,0,1] row_mask:0xf bank_mask:0xf
  v_add_f32 v54, v54, v54 quad_perm:[2,3,0,1] row_mask:0xf bank_mask:0xf
  v_add_f32 v55, v55, v55 quad_perm:[2,3,0,1] row_mask:0xf bank_mask:0xf
  v_add_f32 v40, v40, v40 row_half_mirror row_mask:0xf bank_mask:0xf
  v_add_f32 v41, v41, v41 row_half_mirror row_mask:0xf bank_mask:0xf
  v_add_f32 v42, v42, v42 row_half_mirror row_mask:0xf bank_mask:0xf
  v_add_f32 v43, v43, v43 row_half_mirror row_mask:0xf bank_mask:0xf
  v_add_f32 v44, v44, v44 row_half_mirror row_mask:0xf bank_mask:0xf
  v_add_f32 v45, v45, v45 row_half_mirror row_mask:0xf bank_mask:0xf
  v_add_f32 v46, v46, v46 row_half_mirror row_mask:0xf bank_mask:0xf
  v_add_f32 v47, v47, v47 row_half_mirror row_mask:0xf bank_mask:0xf
  v_add_f32 v48, v48, v48 row_half_mirror row_mask:0xf bank_mask:0xf
  v_add_f32 v49, v49, v49 row_half_mirror row_mask:0xf bank_mask:0xf
  v_add_f32 v50, v50, v50 row_half_mirror row_mask:0xf bank_mask:0xf
  v_add_f32 v51, v51, v51 row_half_mirror row_mask:0xf bank_mask:0xf
  v_add_f32 v52, v52, v52 row_half_mirror row_mask:0xf bank_mask:0xf
  v_add_f32 v53, v53, v53 row_half_mirror row_mask:0xf bank_mask:0xf
  v_add_f32 v54, v54, v54 row_half_mirror row_mask:0xf bank_mask:0xf
  v_add_f32 v55, v55, v55 row_half_mirror row_mask:0xf bank_mask:0xf
  v_add_f32 v40, v40, v40 row_mirror row_mask:0xf bank_mask:0xf
  v_add_f32 v41, v41, v41 row_mirror row_mask:0xf bank_mask:0xf
  v_add_f32 v42, v42, v42 row_mirror row_mask:0xf bank_mask:0xf
  v_add_f32 v43, v43, v43 row_mirror row_mask:0xf bank_mask:0xf
  v_add_f32 v44, v44, v44 row_mirror row_mask:0xf bank_mask:0xf
  v_add_f32 v45, v45, v45 row_mirror row_mask:0xf bank_mask:0xf
  v_add_f32 v46, v46, v46 row_mirror row_mask:0xf bank_mask:0xf
  v_add_f32 v47, v47, v47 row_mirror row_mask:0xf bank_mask:0xf
  v_add_f32 v48, v48, v48 row_mirror row_mask:0xf bank_mask:0xf
  v_add_f32 v49, v49, v49 row_mirror row_mask:0xf bank_mask:0xf
  v_add_f32 v50, v50, v50 row_mirror row_mask:0xf bank_mask:0xf
  v_add_f32 v51, v51, v51 row_mirror row_mask:0xf bank_mask:0xf
  v_add_f32 v52, v52, v52 row_mirror row_mask:0xf bank_mask:0xf
  v_add_f32 v53, v53, v53 row_mirror row_mask:0xf bank_mask:0xf
  v_add_f32 v54, v54, v54 row_mirror row_mask:0xf bank_mask:0xf
  v_add_f32 v55, v55, v55 row_mirror row_mask:0xf bank_mask:0xf
  v_add_f32 v40, v40, v40 row_bcast:15 row_mask:0xa bank_mask:0xf
  v_add_f32 v41, v41, v41 row_bcast:15 row_mask:0xa bank_mask:0xf
  v_add_f32 v42, v42, v42 row_bcast:15 row_mask:0xa bank_mask:0xf
  v_add_f32 v43, v43, v43 row_bcast:15 row_mask:0xa bank_mask:0xf
  v_add_f32 v44, v44, v44 row_bcast:15 row_mask:0xa bank_mask:0xf
  v_add_f32 v45, v45, v45 row_bcast:15 row_mask:0xa bank_mask:0xf
  v_add_f32 v46, v46, v46 row_bcast:15 row_mask:0xa bank_mask:0xf
  v_add_f32 v47, v47, v47 row_bcast:15 row_mask:0xa bank_mask:0xf
  v_add_f32 v48, v48, v48 row_bcast:15 row_mask:0xa bank_mask:0xf
  v_add_f32 v49, v49, v49 row_bcast:15 row_mask:0xa bank_mask:0xf
  v_add_f32 v50, v50, v50 row_bcast:15 row_mask:0xa bank_mask:0xf
  v_add_f32 v51, v51, v51 row_bcast:15 row_mask:0xa bank_mask:0xf
  v_add_f32 v52, v52, v52 row_bcast:15 row_mask:0xa bank_mask:0xf
  v_add_f32 v53, v53, v53 row_bcast:15 row_mask:0xa bank_mask:0xf
  v_add_f32 v54, v54, v54 row_bcast:15 row_mask:0xa bank_mask:0xf
  v_add_f32 v55, v55, v55 row_bcast:15 row_mask:0xa bank_mask:0xf
  v_add_f32 v40, v40, v40 row_bcast:31 row_mask:0xc bank_mask:0xf
  v_add_f32 v41, v41, v41 row_bcast:31 row_mask:0xc bank_mask:0xf
  v_add_f32 v42, v42, v42 row_bcast:31 row_mask:0xc bank_mask:0xf
  v_add_f32 v43, v43, v43 row_bcast:31 row_mask:0xc bank_mask:0xf
  v_add_f32 v44, v44, v44 row_bcast:31 row_mask:0xc bank_mask:0xf
  v_add_f32 v45, v45, v45 row_bcast:31 row_mask:0xc bank_mask:0xf
  v_add_f32 v46, v46, v46 row_bcast:31 row_mask:0xc bank_mask:0xf
  v_add_f32 v47, v47, v47 row_bcast:31 row_mask:0xc bank_mask:0xf
  v_add_f32 v48, v48, v48 row_bcast:31 row_mask:0xc bank_mask:0xf
  v_add_f32 v49, v49, v49 row_bcast:31 row_mask:0xc bank_mask:0xf
  v_add_f32 v50, v50, v50 row_bcast:31 row_mask:0xc bank_mask:0xf
  v_add_f32 v51, v51, v51 row_bcast:31 row_mask:0xc bank_mask:0xf
  v_add_f32 v52, v52, v52 row_bcast:31 row_mask:0xc bank_mask:0xf
  v_add_f32 v53, v53, v53 row_bcast:31 row_mask:0xc bank_mask:0xf
  v_add_f32 v54, v54, v54 row_bcast:31 row_mask:0xc bank_mask:0xf
  v_add_f32 v55, v55, v55 row_bcast:31 row_mask:0xc bank_mask:0xf
  v_mul_f32 v40, v40, v200
  v_mul_f32 v41, v41, v200
  v_mul_f32 v42, v42, v200
  v_mul_f32 v43, v43, v200
  v_mul_f32 v44, v44, v200
  v_mul_f32 v45, v45, v200
  v_mul_f32 v46, v46, v200
  v_mul_f32 v47, v47, v200
  v_mul_f32 v48, v48, v200
  v_mul_f32 v49, v49, v200
  v_mul_f32 v50, v50, v200
  v_mul_f32 v51, v51, v200
  v_mul_f32 v52, v52, v200
  v_mul_f32 v53, v53, v200
  v_mul_f32 v54, v54, v200
  v_mul_f32 v55, v55, v200
  v_fma_f32 v48, -v40, v40, v48
  v_fma_f32 v49, -v41, v41, v49
  v_fma_f32 v50, -v42, v42, v50
  v_fma_f32 v51, -v43, v43, v51
  v_fma_f32 v52, -v44, v44, v52
  v_fma_f32 v53, -v45, v45, v53
  v_fma_f32 v54, -v46, v46, v54
  v_fma_f32 v55, -v47, v47, v55
  v_max_f32 v48, 0, v48
  v_max_f32 v49, 0, v49
  v_max_f32 v50, 0, v50
  v_max_f32 v51, 0, v51
  v_max_f32 v52, 0, v52
  v_max_f32 v53, 0, v53
  v_max_f32 v54, 0, v54
  v_max_f32 v55, 0, v55
  v_add_f32 v48, v48, v201
  v_add_f32 v49, v49, v201
  v_add_f32 v50, v50, v201
  v_add_f32 v51, v51, v201
  v_add_f32 v52, v52, v201
  v_add_f32 v53, v53, v201
  v_add_f32 v54, v54, v201
  v_add_f32 v55, v55, v201
  v_rsq_f32 v48, v48
  v_rsq_f32 v49, v49
  v_rsq_f32 v50, v50
  v_rsq_f32 v51, v51
  v_rsq_f32 v52, v52
  v_rsq_f32 v53, v53
  v_rsq_f32 v54, v54
  v_rsq_f32 v55, v55
  v_mul_f32 v48, s40, v48
  v_mul_f32 v49, s40, v49
  v_mul_f32 v50, s40, v50
  v_mul_f32 v51, s40, v51
  v_mul_f32 v52, s41, v52
  v_mul_f32 v53, s41, v53
  v_mul_f32 v54, s41, v54
  v_mul_f32 v55, s41, v55
  v_mul_f32 v40, v40, v48
  v_mul_f32 v41, v41, v49
  v_mul_f32 v42, v42, v50
  v_mul_f32 v43, v43, v51
  v_mul_f32 v44, v44, v52
  v_mul_f32 v45, v45, v53
  v_mul_f32 v46, v46, v54
  v_mul_f32 v47, v47, v55
  v_readlane_b32 s44, v48, 63
  v_readlane_b32 s45, v40, 63
  v_readlane_b32 s46, v49, 63
  v_readlane_b32 s47, v41, 63
  v_readlane_b32 s48, v50, 63
  v_readlane_b32 s49, v42, 63
  v_readlane_b32 s50, v51, 63
  v_readlane_b32 s51, v43, 63
  v_readlane_b32 s52, v52, 63
  v_readlane_b32 s53, v44, 63
  v_readlane_b32 s54, v53, 63
  v_readlane_b32 s55, v45, 63
  v_readlane_b32 s56, v54, 63
  v_readlane_b32 s57, v46, 63
  v_readlane_b32 s58, v55, 63
  v_readlane_b32 s59, v47, 63
  v_mov_b32 v8, s44
  v_mov_b32 v9, s45
  v_mov_b32 v10, s46
  v_mov_b32 v11, s47
  v_mov_b32 v12, s48
  v_mov_b32 v13, s49
  v_mov_b32 v14, s50
  v_mov_b32 v15, s51
  v_mov_b32 v16, s52
  v_mov_b32 v17, s53
  v_mov_b32 v18, s54
  v_mov_b32 v19, s55
  v_mov_b32 v20, s56
  v_mov_b32 v21, s57
  v_mov_b32 v22, s58
  v_mov_b32 v23, s59
  v_pk_fma_f32 v[64:65], v[64:65], v[8:9], v[8:9] op_sel:[0,0,1] op_sel_hi:[1,0,1] neg_lo:[0,0,1] neg_hi:[0,0,1]
  v_pk_fma_f32 v[66:67], v[66:67], v[8:9], v[8:9] op_sel:[0,0,1] op_sel_hi:[1,0,1] neg_lo:[0,0,1] neg_hi:[0,0,1]
  v_pk_fma_f32 v[68:69], v[68:69], v[8:9], v[8:9] op_sel:[0,0,1] op_sel_hi:[1,0,1] neg_lo:[0,0,1] neg_hi:[0,0,1]
  v_pk_fma_f32 v[70:71], v[70:71], v[8:9], v[8:9] op_sel:[0,0,1] op_sel_hi:[1,0,1] neg_lo:[0,0,1] neg_hi:[0,0,1]
  v_pk_fma_f32 v[72:73], v[72:73], v[10:11], v[10:11] op_sel:[0,0,1] op_sel_hi:[1,0,1] neg_lo:[0,0,1] neg_hi:[0,0,1]
  v_pk_fma_f32 v[74:75], v[74:75], v[10:11], v[10:11] op_sel:[0,0,1] op_sel_hi:[1,0,1] neg_lo:[0,0,1] neg_hi:[0,0,1]
  v_pk_fma_f32 v[76:77], v[76:77], v[10:11], v[10:11] op_sel:[0,0,1] op_sel_hi:[1,0,1] neg_lo:[0,0,1] neg_hi:[0,0,1]
  v_pk_fma_f32 v[78:79], v[78:79], v[10:11], v[10:11] op_sel:[0,0,1] op_sel_hi:[1,0,1] neg_lo:[0,0,1] neg_hi:[0,0,1]
  v_pk_fma_f32 v[80:81], v[80:81], v[12:13], v[12:13] op_sel:[0,0,1] op_sel_hi:[1,0,1] neg_lo:[0,0,1] neg_hi:[0,0,1]
  v_pk_fma_f32 v[82:83], v[82:83], v[12:13], v[12:13] op_sel:[0,0,1] op_sel_hi:[1,0,1] neg_lo:[0,0,1] neg_hi:[0,0,1]
  v_pk_fma_f32 v[84:85], v[84:85], v[12:13], v[12:13] op_sel:[0,0,1] op_sel_hi:[1,0,1] neg_lo:[0,0,1] neg_hi:[0,0,1]
  v_pk_fma_f32 v[86:87], v[86:87], v[12:13], v[12:13] op_sel:[0,0,1] op_sel_hi:[1,0,1] neg_lo:[0,0,1] neg_hi:[0,0,1]
  v_pk_fma_f32 v[88:89], v[88:89], v[14:15], v[14:15] op_sel:[0,0,1] op_sel_hi:[1,0,1] neg_lo:[0,0,1] neg_hi:[0,0,1]
  v_pk_fma_f32 v[90:91], v[90:91], v[14:15], v[14:15] op_sel:[0,0,1] op_sel_hi:[1,0,1] neg_lo:[0,0,1] neg_hi:[0,0,1]
  v_pk_fma_f32 v[92:93], v[92:93], v[14:15], v[14:15] op_sel:[0,0,1] op_sel_hi:[1,0,1] neg_lo:[0,0,1] neg_hi:[0,0,1]
  v_pk_fma_f32 v[94:95], v[94:95], v[14:15], v[14:15] op_sel:[0,0,1] op_sel_hi:[1,0,1] neg_lo:[0,0,1] neg_hi:[0,0,1]
  v_pk_fma_f32 v[96:97], v[96:97], v[16:17], v[16:17] op_sel:[0,0,1] op_sel_hi:[1,0,1] neg_lo:[0,0,1] neg_hi:[0,0,1]
  v_pk_fma_f32 v[98:99], v[98:99], v[16:17], v[16:17] op_sel:[0,0,1] op_sel_hi:[1,0,1] neg_lo:[0,0,1] neg_hi:[0,0,1]
  v_pk_fma_f32 v[100:101], v[100:101], v[16:17], v[16:17] op_sel:[0,0,1] op_sel_hi:[1,0,1] neg_lo:[0,0,1] neg_hi:[0,0,1]
  v_pk_fma_f32 v[102:103], v[102:103], v[16:17], v[16:17] op_sel:[0,0,1] op_sel_hi:[1,0,1] neg_lo:[0,0,1] neg_hi:[0,0,1]
  v_pk_fma_f32 v[104:105], v[104:105], v[18:19], v[18:19] op_sel:[0,0,1] op_sel_hi:[1,0,1] neg_lo:[0,0,1] neg_hi:[0,0,1]
  v_pk_fma_f32 v[106:107], v[106:107], v[18:19], v[18:19] op_sel:[0,0,1] op_sel_hi:[1,0,1] neg_lo:[0,0,1] neg_hi:[0,0,1]
  v_pk_fma_f32 v[108:109], v[108:109], v[18:19], v[18:19] op_sel:[0,0,1] op_sel_hi:[1,0,1] neg_lo:[0,0,1] neg_hi:[0,0,1]
  v_pk_fma_f32 v[110:111], v[110:111], v[18:19], v[18:19] op_sel:[0,0,1] op_sel_hi:[1,0,1] neg_lo:[0,0,1] neg_hi:[0,0,1]
  v_pk_fma_f32 v[112:113], v[112:113], v[20:21], v[20:21] op_sel:[0,0,1] op_sel_hi:[1,0,1] neg_lo:[0,0,1] neg_hi:[0,0,1]
  v_pk_fma_f32 v[114:115], v[114:115], v[20:21], v[20:21] op_sel:[0,0,1] op_sel_hi:[1,0,1] neg_lo:[0,0,1] neg_hi:[0,0,1]
  v_pk_fma_f32 v[116:117], v[116:117], v[20:21], v[20:21] op_sel:[0,0,1] op_sel_hi:[1,0,1] neg_lo:[0,0,1] neg_hi:[0,0,1]
  v_pk_fma_f32 v[118:119], v[118:119], v[20:21], v[20:21] op_sel:[0,0,1] op_sel_hi:[1,0,1] neg_lo:[0,0,1] neg_hi:[0,0,1]
  v_pk_fma_f32 v[120:121], v[120:121], v[22:23], v[22:23] op_sel:[0,0,1] op_sel_hi:[1,0,1] neg_lo:[0,0,1] neg_hi:[0,0,1]
  v_pk_fma_f32 v[122:123], v[122:123], v[22:23], v[22:23] op_sel:[0,0,1] op_sel_hi:[1,0,1] neg_lo:[0,0,1] neg_hi:[0,0,1]
  v_pk_fma_f32 v[124:125], v[124:125], v[22:23], v[22:23] op_sel:[0,0,1] op_sel_hi:[1,0,1] neg_lo:[0,0,1] neg_hi:[0,0,1]
  v_pk_fma_f32 v[126:127], v[126:127], v[22:23], v[22:23] op_sel:[0,0,1] op_sel_hi:[1,0,1] neg_lo:[0,0,1] neg_hi:[0,0,1]
  v_pk_add_f32 v[24:25], v[64:65], v[72:73]
  v_pk_add_f32 v[26:27], v[64:65], v[72:73] neg_lo:[0,1] neg_hi:[0,1]
  v_pk_add_f32 v[28:29], v[80:81], v[88:89]
  v_pk_add_f32 v[30:31], v[88:89], v[80:81] neg_lo:[0,1] neg_hi:[0,1]
  v_pk_add_f32 v[128:129], v[24:25], v[28:29]
  v_pk_add_f32 v[144:145], v[24:25], v[28:29] neg_lo:[0,1] neg_hi:[0,1]
  v_pk_add_f32 v[160:161], v[26:27], v[30:31]
  v_pk_add_f32 v[176:177], v[26:27], v[30:31] neg_lo:[0,1] neg_hi:[0,1]
  v_pk_add_f32 v[32:33], v[66:67], v[74:75]
  v_pk_add_f32 v[34:35], v[66:67], v[74:75] neg_lo:[0,1] neg_hi:[0,1]
  v_pk_add_f32 v[36:37], v[82:83], v[90:91]
  v_pk_add_f32 v[38:39], v[90:91], v[82:83] neg_lo:[0,1] neg_hi:[0,1]
  v_pk_add_f32 v[130:131], v[32:33], v[36:37]
  v_pk_add_f32 v[146:147], v[32:33], v[36:37] neg_lo:[0,1] neg_hi:[0,1]
  v_pk_add_f32 v[162:163], v[34:35], v[38:39]
  v_pk_add_f32 v[178:179], v[34:35], v[38:39] neg_lo:[0,1] neg_hi:[0,1]
  v_pk_add_f32 v[24:25], v[68:69], v[76:77]
  v_pk_add_f32 v[26:27], v[68:69], v[76:77] neg_lo:[0,1] neg_hi:[0,1]
  v_pk_add_f32 v[28:29], v[84:85], v[92:93]
  v_pk_add_f32 v[30:31], v[92:93], v[84:85] neg_lo:[0,1] neg_hi:[0,1]
  v_pk_add_f32 v[132:133], v[24:25], v[28:29]
  v_pk_add_f32 v[148:149], v[24:25], v[28:29] neg_lo:[0,1] neg_hi:[0,1]
  v_pk_add_f32 v[164:165], v[26:27], v[30:31]
  v_pk_add_f32 v[180:181], v[26:27], v[30:31] neg_lo:[0,1] neg_hi:[0,1]
  v_pk_add_f32 v[32:33], v[70:71], v[78:79]
  v_pk_add_f32 v[34:35], v[70:71], v[78:79] neg_lo:[0,1] neg_hi:[0,1]
  v_pk_add_f32 v[36:37], v[86:87], v[94:95]
  v_pk_add_f32 v[38:39], v[94:95], v[86:87] neg_lo:[0,1] neg_hi:[0,1]
  v_pk_add_f32 v[134:135], v[32:33], v[36:37]
  v_pk_add_f32 v[150:151], v[32:33], v[36:37] neg_lo:[0,1] neg_hi:[0,1]
  v_pk_add_f32 v[166:167], v[34:35], v[38:39]
  v_pk_add_f32 v[182:183], v[34:35], v[38:39] neg_lo:[0,1] neg_hi:[0,1]
  v_pk_add_f32 v[24:25], v[96:97], v[104:105]
  v_pk_add_f32 v[26:27], v[96:97], v[104:105] neg_lo:[0,1] neg_hi:[0,1]
  v_pk_add_f32 v[28:29], v[112:113], v[120:121]
  v_pk_add_f32 v[30:31], v[120:121], v[112:113] neg_lo:[0,1] neg_hi:[0,1]
  v_pk_add_f32 v[136:137], v[24:25], v[28:29]
  v_pk_add_f32 v[152:153], v[24:25], v[28:29] neg_lo:[0,1] neg_hi:[0,1]
  v_pk_add_f32 v[168:169], v[26:27], v[30:31]
  v_pk_add_f32 v[184:185], v[26:27], v[30:31] neg_lo:[0,1] neg_hi:[0,1]
  v_pk_add_f32 v[32:33], v[98:99], v[106:107]
  v_pk_add_f32 v[34:35], v[98:99], v[106:107] neg_lo:[0,1] neg_hi:[0,1]
  v_pk_add_f32 v[36:37], v[114:115], v[122:123]
  v_pk_add_f32 v[38:39], v[122:123], v[114:115] neg_lo:[0,1] neg_hi:[0,1]
  v_pk_add_f32 v[138:139], v[32:33], v[36:37]
  v_pk_add_f32 v[154:155], v[32:33], v[36:37] neg_lo:[0,1] neg_hi:[0,1]
  v_pk_add_f32 v[170:171], v[34:35], v[38:39]
  v_pk_add_f32 v[186:187], v[34:35], v[38:39] neg_lo:[0,1] neg_hi:[0,1]
  v_pk_add_f32 v[24:25], v[100:101], v[108:109]
  v_pk_add_f32 v[26:27], v[100:101], v[108:109] neg_lo:[0,1] neg_hi:[0,1]
  v_pk_add_f32 v[28:29], v[116:117], v[124:125]
  v_pk_add_f32 v[30:31], v[124:125], v[116:117] neg_lo:[0,1] neg_hi:[0,1]
  v_pk_add_f32 v[140:141], v[24:25], v[28:29]
  v_pk_add_f32 v[156:157], v[24:25], v[28:29] neg_lo:[0,1] neg_hi:[0,1]
  v_pk_add_f32 v[172:173], v[26:27], v[30:31]
  v_pk_add_f32 v[188:189], v[26:27], v[30:31] neg_lo:[0,1] neg_hi:[0,1]
  v_pk_add_f32 v[32:33], v[102:103], v[110:111]
  v_pk_add_f32 v[34:35], v[102:103], v[110:111] neg_lo:[0,1] neg_hi:[0,1]
  v_pk_add_f32 v[36:37], v[118:119], v[126:127]
  v_pk_add_f32 v[38:39], v[126:127], v[118:119] neg_lo:[0,1] neg_hi:[0,1]
  v_pk_add_f32 v[142:143], v[32:33], v[36:37]
  v_pk_add_f32 v[158:159], v[32:33], v[36:37] neg_lo:[0,1] neg_hi:[0,1]
  v_pk_add_f32 v[174:175], v[34:35], v[38:39]
  v_pk_add_f32 v[190:191], v[34:35], v[38:39] neg_lo:[0,1] neg_hi:[0,1]
  v_mul_u32_u24 v3, 144, v1
  s_lshl_b32 s43, s3, 2
  s_add_u32 s43, s43, 86016
  v_add_u32 v3, s43, v3
  v_cvt_pk_bf16_f32 v64, v128, v136
  v_cvt_pk_bf16_f32 v65, v129, v137
  v_cvt_pk_bf16_f32 v66, v130, v138
  v_cvt_pk_bf16_f32 v67, v131, v139
  v_cvt_pk_bf16_f32 v68, v132, v140
  v_cvt_pk_bf16_f32 v69, v133, v141
  v_cvt_pk_bf16_f32 v70, v134, v142
  v_cvt_pk_bf16_f32 v71, v135, v143
  ds_write_b32 v3, v64 offset:0
  ds_write_b32 v3, v65 offset:16
  ds_write_b32 v3, v66 offset:32
  ds_write_b32 v3, v67 offset:48
  ds_write_b32 v3, v68 offset:64
  ds_write_b32 v3, v69 offset:80
  ds_write_b32 v3, v70 offset:96
  ds_write_b32 v3, v71 offset:112
  v_cvt_pk_bf16_f32 v72, v144, v152
  v_cvt_pk_bf16_f32 v73, v145, v153
  v_cvt_pk_bf16_f32 v74, v146, v154
  v_cvt_pk_bf16_f32 v75, v147, v155
  v_cvt_pk_bf16_f32 v76, v148, v156
  v_cvt_pk_bf16_f32 v77, v149, v157
  v_cvt_pk_bf16_f32 v78, v150, v158
  v_cvt_pk_bf16_f32 v79, v151, v159
  ds_write_b32 v3, v72 offset:9216
  ds_write_b32 v3, v73 offset:9232
  ds_write_b32 v3, v74 offset:9248
  ds_write_b32 v3, v75 offset:9264
  ds_write_b32 v3, v76 offset:9280
  ds_write_b32 v3, v77 offset:9296
  ds_write_b32 v3, v78 offset:9312
  ds_write_b32 v3, v79 offset:9328
  v_cvt_pk_bf16_f32 v80, v160, v168
  v_cvt_pk_bf16_f32 v81, v161, v169
  v_cvt_pk_bf16_f32 v82, v162, v170
  v_cvt_pk_bf16_f32 v83, v163, v171
  v_cvt_pk_bf16_f32 v84, v164, v172
  v_cvt_pk_bf16_f32 v85, v165, v173
  v_cvt_pk_bf16_f32 v86, v166, v174
  v_cvt_pk_bf16_f32 v87, v167, v175
  ds_write_b32 v3, v80 offset:18432
  ds_write_b32 v3, v81 offset:18448
  ds_write_b32 v3, v82 offset:18464
  ds_write_b32 v3, v83 offset:18480
  ds_write_b32 v3, v84 offset:18496
  ds_write_b32 v3, v85 offset:18512
  ds_write_b32 v3, v86 offset:18528
  ds_write_b32 v3, v87 offset:18544
  v_cvt_pk_bf16_f32 v88, v176, v184
  v_cvt_pk_bf16_f32 v89, v177, v185
  v_cvt_pk_bf16_f32 v90, v178, v186
  v_cvt_pk_bf16_f32 v91, v179, v187
  v_cvt_pk_bf16_f32 v92, v180, v188
  v_cvt_pk_bf16_f32 v93, v181, v189
  v_cvt_pk_bf16_f32 v94, v182, v190
  v_cvt_pk_bf16_f32 v95, v183, v191
  ds_write_b32 v3, v88 offset:27648
  ds_write_b32 v3, v89 offset:27664
  ds_write_b32 v3, v90 offset:27680
  ds_write_b32 v3, v91 offset:27696
  ds_write_b32 v3, v92 offset:27712
  ds_write_b32 v3, v93 offset:27728
  ds_write_b32 v3, v94 offset:27744
  ds_write_b32 v3, v95 offset:27760
  v_lshrrev_b32 v4, 3, v0
  v_mul_u32_u24 v4, 144, v4
  v_and_b32 v5, 7, v0
  v_lshl_add_u32 v4, v5, 4, v4
  v_add_u32 v4, 86016, v4
  v_lshrrev_b32 v5, 4, v0
  v_mul_u32_u24 v5, 17408, v5
  v_and_b32 v6, 15, v0
  v_lshl_add_u32 v5, v6, 4, v5
  s_lshr_b32 s38, s2, 2
  s_lshl_b32 s38, s38, 10
  s_and_b32 s39, s2, 3
  s_lshl_b32 s39, s39, 8
  s_add_u32 s38, s38, s39
  s_add_u32 s38, s38, 589824
  s_add_u32 s39, s38, 278528
  s_waitcnt lgkmcnt(0)
  s_barrier
  ds_read_b128 v[96:99], v4 offset:0
  ds_read_b128 v[100:103], v4 offset:4608
  ds_read_b128 v[104:107], v4 offset:9216
  ds_read_b128 v[108:111], v4 offset:13824
  ds_read_b128 v[112:115], v4 offset:18432
  ds_read_b128 v[116:119], v4 offset:23040
  ds_read_b128 v[120:123], v4 offset:27648
  ds_read_b128 v[124:127], v4 offset:32256
  s_waitcnt lgkmcnt(6)
  buffer_store_dwordx4 v[96:99], v5, s[12:15], s38 offen sc1
  buffer_store_dwordx4 v[100:103], v5, s[12:15], s39 offen sc1
  s_add_u32 s38, s38, 557056
  s_add_u32 s39, s39, 557056
  s_waitcnt lgkmcnt(4)
  buffer_store_dwordx4 v[104:107], v5, s[12:15], s38 offen sc1
  buffer_store_dwordx4 v[108:111], v5, s[12:15], s39 offen sc1
  s_add_u32 s38, s38, 557056
  s_add_u32 s39, s39, 557056
  s_waitcnt lgkmcnt(2)
  buffer_store_dwordx4 v[112:115], v5, s[12:15], s38 offen sc1
  buffer_store_dwordx4 v[116:119], v5, s[12:15], s39 offen sc1
  s_add_u32 s38, s38, 557056
  s_add_u32 s39, s39, 557056
  s_waitcnt lgkmcnt(0)
  buffer_store_dwordx4 v[120:123], v5, s[12:15], s38 offen sc1
  buffer_store_dwordx4 v[124:127], v5, s[12:15], s39 offen sc1
  s_branch p1_end
p1_mod:
  s_sub_u32 s28, s2, 65
  s_lshr_b32 s29, s28, 4
  s_lshl_b32 s29, s29, 3
  s_and_b32 s30, s28, 7
  s_add_u32 s29, s29, s30
  s_lshl_b32 s29, s29, 1
  s_bfe_u32 s30, s28, 0x10003
  s_add_u32 s28, s29, s30
  v_and_b32 v2, 3, v1
  v_lshrrev_b32 v3, 2, v1
  s_lshl_b32 s29, s3, 7
  v_lshl_add_u32 v4, v3, 3, s29
  v_lshlrev_b32 v5, 1, v4
  s_mov_b32 s30, 6144
  v_mul_lo_u32 v6, v4, s30
  v_lshl_add_u32 v6, v2, 4, v6
  s_lshl_b32 s31, s28, 6
  s_waitcnt lgkmcnt(0)
  s_mov_b32 s12, s6
  s_mov_b32 s13, s7
  s_mov_b32 s14, 0x2000000
  s_mov_b32 s15, 0x20000
  s_mov_b32 s16, s26
  s_mov_b32 s17, s27
  s_mov_b32 s18, 0x300000
  s_mov_b32 s19, 0x20000
  s_mov_b32 s20, s24
  s_mov_b32 s21, s25
  s_mov_b32 s22, 0x400
  s_mov_b32 s23, 0x20000
  s_waitcnt vmcnt(0)
  buffer_load_dwordx4 v[8:11], v5, s[20:23], 0 offen
  s_waitcnt vmcnt(0)
  buffer_load_dwordx4 v[40:43], v6, s[16:19], s31 offen
  s_waitcnt vmcnt(0)
  s_add_u32 s31, s31, 6144
  buffer_load_dwordx4 v[44:47], v6, s[16:19], s31 offen
  s_add_u32 s31, s31, 6144
  buffer_load_dwordx4 v[48:51], v6, s[16:19], s31 offen
  s_add_u32 s31, s31, 6144
  buffer_load_dwordx4 v[52:55], v6, s[16:19], s31 offen
  s_add_u32 s31, s31, 6144
  buffer_load_dwordx4 v[56:59], v6, s[16:19], s31 offen
  s_add_u32 s31, s31, 6144
  buffer_load_dwordx4 v[60:63], v6, s[16:19], s31 offen
  s_add_u32 s31, s31, 6144
  buffer_load_dwordx4 v[64:67], v6, s[16:19], s31 offen
  s_add_u32 s31, s31, 6144
  buffer_load_dwordx4 v[68:71], v6, s[16:19], s31 offen
  v_lshlrev_b32 v120, 16, v8
  v_and_b32 v121, 0xffff0000, v8
  v_lshlrev_b32 v122, 16, v9
  v_and_b32 v123, 0xffff0000, v9
  v_lshlrev_b32 v124, 16, v10
  v_and_b32 v125, 0xffff0000, v10
  v_lshlrev_b32 v126, 16, v11
  v_and_b32 v127, 0xffff0000, v11
  s_mov_b32 s32, 0xbfb8aa3b
  v_mul_f32 v104, s32, v120
  v_mul_f32 v105, s32, v121
  v_mul_f32 v106, s32, v122
  v_mul_f32 v107, s32, v123
  v_mul_f32 v108, s32, v124
  v_mul_f32 v109, s32, v125
  v_mul_f32 v110, s32, v126
  v_mul_f32 v111, s32, v127
  v_exp_f32 v104, v104
  v_exp_f32 v105, v105
  v_exp_f32 v106, v106
  v_exp_f32 v107, v107
  v_exp_f32 v108, v108
  v_exp_f32 v109, v109
  v_exp_f32 v110, v110
  v_exp_f32 v111, v111
  v_add_f32 v104, 1.0, v104
  v_add_f32 v105, 1.0, v105
  v_add_f32 v106, 1.0, v106
  v_add_f32 v107, 1.0, v107
  v_add_f32 v108, 1.0, v108
  v_add_f32 v109, 1.0, v109
  v_add_f32 v110, 1.0, v110
  v_add_f32 v111, 1.0, v111
  v_rcp_f32 v104, v104
  v_rcp_f32 v105, v105
  v_rcp_f32 v106, v106
  v_rcp_f32 v107, v107
  v_rcp_f32 v108, v108
  v_rcp_f32 v109, v109
  v_rcp_f32 v110, v110
  v_rcp_f32 v111, v111
  v_mul_f32 v120, v120, v104
  v_mul_f32 v121, v121, v105
  v_mul_f32 v122, v122, v106
  v_mul_f32 v123, v123, v107
  v_mul_f32 v124, v124, v108
  v_mul_f32 v125, v125, v109
  v_mul_f32 v126, v126, v110
  v_mul_f32 v127, v127, v111
  v_cvt_pk_bf16_f32 v8, v120, v121
  v_cvt_pk_bf16_f32 v9, v122, v123
  v_cvt_pk_bf16_f32 v10, v124, v125
  v_cvt_pk_bf16_f32 v11, v126, v127
  v_lshlrev_b32 v120, 16, v8
  v_and_b32 v121, 0xffff0000, v8
  v_lshlrev_b32 v122, 16, v9
  v_and_b32 v123, 0xffff0000, v9
  v_lshlrev_b32 v124, 16, v10
  v_and_b32 v125, 0xffff0000, v10
  v_lshlrev_b32 v126, 16, v11
  v_and_b32 v127, 0xffff0000, v11
  s_mov_b32 s64, s28
  s_waitcnt vmcnt(7)
  v_lshlrev_b32 v112, 16, v40
  v_and_b32 v113, 0xffff0000, v40
  v_lshlrev_b32 v114, 16, v41
  v_and_b32 v115, 0xffff0000, v41
  v_lshlrev_b32 v116, 16, v42
  v_and_b32 v117, 0xffff0000, v42
  v_lshlrev_b32 v118, 16, v43
  v_and_b32 v119, 0xffff0000, v43
  v_pk_mul_f32 v[104:105], v[112:113], v[120:121] op_sel:[0,0] op_sel_hi:[1,0]
  v_pk_mul_f32 v[106:107], v[114:115], v[120:121] op_sel:[0,0] op_sel_hi:[1,0]
  v_pk_mul_f32 v[108:109], v[116:117], v[120:121] op_sel:[0,0] op_sel_hi:[1,0]
  v_pk_mul_f32 v[110:111], v[118:119], v[120:121] op_sel:[0,0] op_sel_hi:[1,0]
  s_waitcnt vmcnt(6)
  v_lshlrev_b32 v112, 16, v44
  v_and_b32 v113, 0xffff0000, v44
  v_lshlrev_b32 v114, 16, v45
  v_and_b32 v115, 0xffff0000, v45
  v_lshlrev_b32 v116, 16, v46
  v_and_b32 v117, 0xffff0000, v46
  v_lshlrev_b32 v118, 16, v47
  v_and_b32 v119, 0xffff0000, v47
  v_pk_fma_f32 v[104:105], v[112:113], v[120:121], v[104:105] op_sel:[0,1,0] op_sel_hi:[1,1,1]
  v_pk_fma_f32 v[106:107], v[114:115], v[120:121], v[106:107] op_sel:[0,1,0] op_sel_hi:[1,1,1]
  v_pk_fma_f32 v[108:109], v[116:117], v[120:121], v[108:109] op_sel:[0,1,0] op_sel_hi:[1,1,1]
  v_pk_fma_f32 v[110:111], v[118:119], v[120:121], v[110:111] op_sel:[0,1,0] op_sel_hi:[1,1,1]
  s_waitcnt vmcnt(5)
  v_lshlrev_b32 v112, 16, v48
  v_and_b32 v113, 0xffff0000, v48
  v_lshlrev_b32 v114, 16, v49
  v_and_b32 v115, 0xffff0000, v49
  v_lshlrev_b32 v116, 16, v50
  v_and_b32 v117, 0xffff0000, v50
  v_lshlrev_b32 v118, 16, v51
  v_and_b32 v119, 0xffff0000, v51
  v_pk_fma_f32 v[104:105], v[112:113], v[122:123], v[104:105] op_sel:[0,0,0] op_sel_hi:[1,0,1]
  v_pk_fma_f32 v[106:107], v[114:115], v[122:123], v[106:107] op_sel:[0,0,0] op_sel_hi:[1,0,1]
  v_pk_fma_f32 v[108:109], v[116:117], v[122:123], v[108:109] op_sel:[0,0,0] op_sel_hi:[1,0,1]
  v_pk_fma_f32 v[110:111], v[118:119], v[122:123], v[110:111] op_sel:[0,0,0] op_sel_hi:[1,0,1]
  s_waitcnt vmcnt(4)
  v_lshlrev_b32 v112, 16, v52
  v_and_b32 v113, 0xffff0000, v52
  v_lshlrev_b32 v114, 16, v53
  v_and_b32 v115, 0xffff0000, v53
  v_lshlrev_b32 v116, 16, v54
  v_and_b32 v117, 0xffff0000, v54
  v_lshlrev_b32 v118, 16, v55
  v_and_b32 v119, 0xffff0000, v55
  v_pk_fma_f32 v[104:105], v[112:113], v[122:123], v[104:105] op_sel:[0,1,0] op_sel_hi:[1,1,1]
  v_pk_fma_f32 v[106:107], v[114:115], v[122:123], v[106:107] op_sel:[0,1,0] op_sel_hi:[1,1,1]
  v_pk_fma_f32 v[108:109], v[116:117], v[122:123], v[108:109] op_sel:[0,1,0] op_sel_hi:[1,1,1]
  v_pk_fma_f32 v[110:111], v[118:119], v[122:123], v[110:111] op_sel:[0,1,0] op_sel_hi:[1,1,1]
  s_waitcnt vmcnt(3)
  v_lshlrev_b32 v112, 16, v56
  v_and_b32 v113, 0xffff0000, v56
  v_lshlrev_b32 v114, 16, v57
  v_and_b32 v115, 0xffff0000, v57
  v_lshlrev_b32 v116, 16, v58
  v_and_b32 v117, 0xffff0000, v58
  v_lshlrev_b32 v118, 16, v59
  v_and_b32 v119, 0xffff0000, v59
  v_pk_fma_f32 v[104:105], v[112:113], v[124:125], v[104:105] op_sel:[0,0,0] op_sel_hi:[1,0,1]
  v_pk_fma_f32 v[106:107], v[114:115], v[124:125], v[106:107] op_sel:[0,0,0] op_sel_hi:[1,0,1]
  v_pk_fma_f32 v[108:109], v[116:117], v[124:125], v[108:109] op_sel:[0,0,0] op_sel_hi:[1,0,1]
  v_pk_fma_f32 v[110:111], v[118:119], v[124:125], v[110:111] op_sel:[0,0,0] op_sel_hi:[1,0,1]
  s_waitcnt vmcnt(2)
  v_lshlrev_b32 v112, 16, v60
  v_and_b32 v113, 0xffff0000, v60
  v_lshlrev_b32 v114, 16, v61
  v_and_b32 v115, 0xffff0000, v61
  v_lshlrev_b32 v116, 16, v62
  v_and_b32 v117, 0xffff0000, v62
  v_lshlrev_b32 v118, 16, v63
  v_and_b32 v119, 0xffff0000, v63
  v_pk_fma_f32 v[104:105], v[112:113], v[124:125], v[104:105] op_sel:[0,1,0] op_sel_hi:[1,1,1]
  v_pk_fma_f32 v[106:107], v[114:115], v[124:125], v[106:107] op_sel:[0,1,0] op_sel_hi:[1,1,1]
  v_pk_fma_f32 v[108:109], v[116:117], v[124:125], v[108:109] op_sel:[0,1,0] op_sel_hi:[1,1,1]
  v_pk_fma_f32 v[110:111], v[118:119], v[124:125], v[110:111] op_sel:[0,1,0] op_sel_hi:[1,1,1]
  s_waitcnt vmcnt(1)
  v_lshlrev_b32 v112, 16, v64
  v_and_b32 v113, 0xffff0000, v64
  v_lshlrev_b32 v114, 16, v65
  v_and_b32 v115, 0xffff0000, v65
  v_lshlrev_b32 v116, 16, v66
  v_and_b32 v117, 0xffff0000, v66
  v_lshlrev_b32 v118, 16, v67
  v_and_b32 v119, 0xffff0000, v67
  v_pk_fma_f32 v[104:105], v[112:113], v[126:127], v[104:105] op_sel:[0,0,0] op_sel_hi:[1,0,1]
  v_pk_fma_f32 v[106:107], v[114:115], v[126:127], v[106:107] op_sel:[0,0,0] op_sel_hi:[1,0,1]
  v_pk_fma_f32 v[108:109], v[116:117], v[126:127], v[108:109] op_sel:[0,0,0] op_sel_hi:[1,0,1]
  v_pk_fma_f32 v[110:111], v[118:119], v[126:127], v[110:111] op_sel:[0,0,0] op_sel_hi:[1,0,1]
  s_waitcnt vmcnt(0)
  v_lshlrev_b32 v112, 16, v68
  v_and_b32 v113, 0xffff0000, v68
  v_lshlrev_b32 v114, 16, v69
  v_and_b32 v115, 0xffff0000, v69
  v_lshlrev_b32 v116, 16, v70
  v_and_b32 v117, 0xffff0000, v70
  v_lshlrev_b32 v118, 16, v71
  v_and_b32 v119, 0xffff0000, v71
  v_pk_fma_f32 v[104:105], v[112:113], v[126:127], v[104:105] op_sel:[0,1,0] op_sel_hi:[1,1,1]
  v_pk_fma_f32 v[106:107], v[114:115], v[126:127], v[106:107] op_sel:[0,1,0] op_sel_hi:[1,1,1]
  v_pk_fma_f32 v[108:109], v[116:117], v[126:127], v[108:109] op_sel:[0,1,0] op_sel_hi:[1,1,1]
  v_pk_fma_f32 v[110:111], v[118:119], v[126:127], v[110:111] op_sel:[0,1,0] op_sel_hi:[1,1,1]
  v_add_f32 v104, v104, v104 row_ror:4 row_mask:0xf bank_mask:0xf
  v_add_f32 v105, v105, v105 row_ror:4 row_mask:0xf bank_mask:0xf
  v_add_f32 v106, v106, v106 row_ror:4 row_mask:0xf bank_mask:0xf
  v_add_f32 v107, v107, v107 row_ror:4 row_mask:0xf bank_mask:0xf
  v_add_f32 v108, v108, v108 row_ror:4 row_mask:0xf bank_mask:0xf
  v_add_f32 v109, v109, v109 row_ror:4 row_mask:0xf bank_mask:0xf
  v_add_f32 v110, v110, v110 row_ror:4 row_mask:0xf bank_mask:0xf
  v_add_f32 v111, v111, v111 row_ror:4 row_mask:0xf bank_mask:0xf
  v_add_f32 v104, v104, v104 row_ror:8 row_mask:0xf bank_mask:0xf
  v_add_f32 v105, v105, v105 row_ror:8 row_mask:0xf bank_mask:0xf
  v_add_f32 v106, v106, v106 row_ror:8 row_mask:0xf bank_mask:0xf
  v_add_f32 v107, v107, v107 row_ror:8 row_mask:0xf bank_mask:0xf
  v_add_f32 v108, v108, v108 row_ror:8 row_mask:0xf bank_mask:0xf
  v_add_f32 v109, v109, v109 row_ror:8 row_mask:0xf bank_mask:0xf
  v_add_f32 v110, v110, v110 row_ror:8 row_mask:0xf bank_mask:0xf
  v_add_f32 v111, v111, v111 row_ror:8 row_mask:0xf bank_mask:0xf
  v_mov_b32 v40, v104
  v_mov_b32 v41, v105
  v_mov_b32 v42, v106
  v_mov_b32 v43, v107
  v_mov_b32 v44, v108
  v_mov_b32 v45, v109
  v_mov_b32 v46, v110
  v_mov_b32 v47, v111
  v_permlane16_swap_b32 v104, v40
  v_permlane16_swap_b32 v105, v41
  v_permlane16_swap_b32 v106, v42
  v_permlane16_swap_b32 v107, v43
  v_permlane16_swap_b32 v108, v44
  v_permlane16_swap_b32 v109, v45
  v_permlane16_swap_b32 v110, v46
  v_permlane16_swap_b32 v111, v47
  v_add_f32 v104, v104, v40
  v_add_f32 v105, v105, v41
  v_add_f32 v106, v106, v42
  v_add_f32 v107, v107, v43
  v_add_f32 v108, v108, v44
  v_add_f32 v109, v109, v45
  v_add_f32 v110, v110, v46
  v_add_f32 v111, v111, v47
  v_mov_b32 v40, v104
  v_mov_b32 v41, v105
  v_mov_b32 v42, v106
  v_mov_b32 v43, v107
  v_mov_b32 v44, v108
  v_mov_b32 v45, v109
  v_mov_b32 v46, v110
  v_mov_b32 v47, v111
  v_permlane32_swap_b32 v104, v40
  v_permlane32_swap_b32 v105, v41
  v_permlane32_swap_b32 v106, v42
  v_permlane32_swap_b32 v107, v43
  v_permlane32_swap_b32 v108, v44
  v_permlane32_swap_b32 v109, v45
  v_permlane32_swap_b32 v110, v46
  v_permlane32_swap_b32 v111, v47
  v_add_f32 v104, v104, v40
  v_add_f32 v105, v105, v41
  v_add_f32 v106, v106, v42
  v_add_f32 v107, v107, v43
  v_add_f32 v108, v108, v44
  v_add_f32 v109, v109, v45
  v_add_f32 v110, v110, v46
  v_add_f32 v111, v111, v47
  v_lshlrev_b32 v7, 5, v2
  s_lshl_b32 s33, s3, 7
  s_add_u32 s33, s33, 86016
  v_add_u32 v7, s33, v7
  v_cmp_gt_u32 vcc, 4, v1
  s_nop 0
  s_and_saveexec_b64 s[34:35], vcc
  ds_write_b128 v7, v[104:107]
  ds_write_b128 v7, v[108:111] offset:16
  s_mov_b64 exec, s[34:35]
  s_waitcnt lgkmcnt(0)
  s_barrier
  s_cmp_lg_u32 s3, 0
  s_cbranch_scc1 p1_end
  v_and_b32 v7, 31, v1
  v_lshlrev_b32 v7, 2, v7
  v_add_u32 v9, 86016, v7
  ds_read_b32 v64, v9 offset:0
  ds_read_b32 v65, v9 offset:128
  ds_read_b32 v66, v9 offset:256
  ds_read_b32 v67, v9 offset:384
  s_waitcnt lgkmcnt(0)
  v_add_f32 v64, v64, v65
  v_add_f32 v64, v64, v66
  v_add_f32 v64, v64, v67
  v_cvt_pk_bf16_f32 v64, v64, v64
  v_lshlrev_b32 v64, 16, v64
  s_lshr_b32 s33, s64, 4
  s_cmp_eq_u32 s33, 1
  s_cbranch_scc1 p1_onep
  s_cmp_eq_u32 s33, 4
  s_cbranch_scc0 p1_modst
p1_onep:
  v_add_f32 v64, 1.0, v64
  v_cvt_pk_bf16_f32 v64, v64, v64
  v_lshlrev_b32 v64, 16, v64
p1_modst:
  v_mov_b32 v10, 0x40000000
  v_cmp_gt_u32 vcc, 32, v1
  s_nop 1
  v_cndmask_b32 v7, v10, v7, vcc
  s_lshl_b32 s34, s64, 7
  buffer_store_dword v64, v7, s[12:15], s34 offen offset:0 sc1
  s_and_b32 s34, s64, 15
  s_lshl_b32 s34, s34, 6
  s_add_u32 s34, s34, 12288
  s_add_u32 s35, s34, 1024
  s_cmp_eq_u32 s33, 4
  s_cselect_b32 s36, s34, 0x40000000
  s_cmp_eq_u32 s33, 3
  s_cselect_b32 s36, s35, s36
  v_lshrrev_b32 v64, 16, v64
  s_nop 1
  v_mov_b32_dpp v65, v64 quad_perm:[1,0,3,2] row_mask:0xf bank_mask:0xf
  v_lshl_or_b32 v64, v65, 16, v64
  v_lshrrev_b32 v7, 1, v7
  v_and_b32 v65, 1, v1
  v_cmp_eq_u32 vcc, 0, v65
  s_nop 1
  v_cndmask_b32 v7, v10, v7, vcc
  buffer_store_dword v64, v7, s[12:15], s36 offen sc1
  s_branch p1_end
p1_wf:
  s_sub_u32 s28, s2, 161
  s_lshr_b32 s29, s28, 1
  s_and_b32 s30, s28, 1
  v_lshrrev_b32 v2, 3, v1
  v_and_b32 v3, 7, v1
  v_bfe_u32 v4, v2, 1, 1
  v_lshlrev_b32 v4, 1, v4
  v_xor_b32 v5, v3, v4
  v_lshlrev_b32 v5, 4, v5
  v_mul_u32_u24 v6, 3584, v2
  v_add_u32 v6, v6, v5
  v_xor_b32 v7, 64, v5
  v_mul_u32_u24 v8, 3584, v2
  v_add_u32 v7, v8, v7
  s_mul_i32 s31, s30, 917504
  s_lshl_b32 s32, s29, 7
  s_add_u32 s31, s31, s32
  s_mul_i32 s32, s3, 229376
  s_add_u32 s31, s31, s32
  s_lshl_b32 s33, s3, 13
  s_add_u32 s33, s33, 86016
  s_waitcnt lgkmcnt(0)
  s_mov_b32 s12, s6
  s_mov_b32 s13, s7
  s_mov_b32 s14, 0x2000000
  s_mov_b32 s15, 0x20000
  s_mov_b32 s16, s44
  s_mov_b32 s17, s45
  s_mov_b32 s18, 0x1c0000
  s_mov_b32 s19, 0x20000
  s_waitcnt vmcnt(0)
  buffer_load_dword v20, v6, s[16:19], s31 offen
  s_waitcnt vmcnt(0)
  s_add_u32 m0, s33, 0
  s_nop 0
  buffer_load_dwordx4 v6, s[16:19], s31 offen lds
  s_add_u32 s31, s31, 28672
  s_add_u32 m0, s33, 1024
  s_nop 0
  buffer_load_dwordx4 v7, s[16:19], s31 offen lds
  s_add_u32 s31, s31, 28672
  s_add_u32 m0, s33, 2048
  s_nop 0
  buffer_load_dwordx4 v6, s[16:19], s31 offen lds
  s_add_u32 s31, s31, 28672
  s_add_u32 m0, s33, 3072
  s_nop 0
  buffer_load_dwordx4 v7, s[16:19], s31 offen lds
  s_add_u32 s31, s31, 28672
  s_add_u32 m0, s33, 4096
  s_nop 0
  buffer_load_dwordx4 v6, s[16:19], s31 offen lds
  s_add_u32 s31, s31, 28672
  s_add_u32 m0, s33, 5120
  s_nop 0
  buffer_load_dwordx4 v7, s[16:19], s31 offen lds
  s_add_u32 s31, s31, 28672
  s_add_u32 m0, s33, 6144
  s_nop 0
  buffer_load_dwordx4 v6, s[16:19], s31 offen lds
  s_add_u32 s31, s31, 28672
  s_add_u32 m0, s33, 7168
  s_nop 0
  buffer_load_dwordx4 v7, s[16:19], s31 offen lds
  s_add_u32 s31, s31, 28672
  v_lshrrev_b32 v9, 4, v1
  v_bfe_u32 v10, v1, 2, 2
  v_lshl_add_u32 v11, v9, 3, v10
  v_bfe_u32 v12, v10, 1, 1
  v_and_b32 v13, 1, v9
  v_lshl_or_b32 v12, v13, 1, v12
  v_lshlrev_b32 v12, 5, v12
  v_lshl_add_u32 v12, v11, 7, v12
  v_and_b32 v13, 3, v1
  v_lshl_add_u32 v12, v13, 3, v12
  v_add_u32 v12, s33, v12
  v_xor_b32 v16, 0, v12
  v_xor_b32 v17, 32, v12
  v_xor_b32 v18, 64, v12
  v_xor_b32 v19, 96, v12
  v_lshlrev_b32 v14, 4, v1
  s_lshl_b32 s34, s29, 16
  s_lshl_b32 s35, s30, 13
  s_add_u32 s34, s34, s35
  s_lshl_b32 s35, s3, 11
  s_add_u32 s34, s34, s35
  s_add_u32 s34, s34, 20512768
  s_waitcnt vmcnt(0)
  ds_read_b64_tr_b16 v[24:25], v16 offset:0
  ds_read_b64_tr_b16 v[26:27], v16 offset:512
  ds_read_b64_tr_b16 v[28:29], v17 offset:0
  ds_read_b64_tr_b16 v[30:31], v17 offset:512
  ds_read_b64_tr_b16 v[32:33], v18 offset:0
  ds_read_b64_tr_b16 v[34:35], v18 offset:512
  ds_read_b64_tr_b16 v[36:37], v19 offset:0
  ds_read_b64_tr_b16 v[38:39], v19 offset:512
  s_waitcnt lgkmcnt(0)
  s_add_u32 s35, s34, 0
  buffer_store_dwordx4 v[24:27], v14, s[12:15], s35 offen offset:0 sc1
  s_add_u32 s35, s34, 16384
  buffer_store_dwordx4 v[28:31], v14, s[12:15], s35 offen offset:0 sc1
  s_add_u32 s35, s34, 32768
  buffer_store_dwordx4 v[32:35], v14, s[12:15], s35 offen offset:0 sc1
  s_add_u32 s35, s34, 49152
  buffer_store_dwordx4 v[36:39], v14, s[12:15], s35 offen offset:0 sc1
  ds_read_b64_tr_b16 v[40:41], v16 offset:4096
  ds_read_b64_tr_b16 v[42:43], v16 offset:4608
  ds_read_b64_tr_b16 v[44:45], v17 offset:4096
  ds_read_b64_tr_b16 v[46:47], v17 offset:4608
  ds_read_b64_tr_b16 v[48:49], v18 offset:4096
  ds_read_b64_tr_b16 v[50:51], v18 offset:4608
  ds_read_b64_tr_b16 v[52:53], v19 offset:4096
  ds_read_b64_tr_b16 v[54:55], v19 offset:4608
  s_waitcnt lgkmcnt(0)
  s_add_u32 s35, s34, 0
  buffer_store_dwordx4 v[40:43], v14, s[12:15], s35 offen offset:1024 sc1
  s_add_u32 s35, s34, 16384
  buffer_store_dwordx4 v[44:47], v14, s[12:15], s35 offen offset:1024 sc1
  s_add_u32 s35, s34, 32768
  buffer_store_dwordx4 v[48:51], v14, s[12:15], s35 offen offset:1024 sc1
  s_add_u32 s35, s34, 49152
  buffer_store_dwordx4 v[52:55], v14, s[12:15], s35 offen offset:1024 sc1
  s_branch p1_end
p1_idle:
  s_waitcnt lgkmcnt(0)
  s_mov_b32 s12, s6
  s_mov_b32 s13, s7
  s_mov_b32 s14, 0x2000000
  s_mov_b32 s15, 0x20000
  s_cmp_lt_u32 s2, 999
  s_cbranch_scc1 p1_noseq
  s_mov_b32 s16, s26
  s_mov_b32 s17, s27
  s_mov_b32 s18, 0x300000
  s_mov_b32 s19, 0x20000
  s_mov_b32 s20, s44
  s_mov_b32 s21, s45
  s_mov_b32 s22, 0x1c0000
  s_mov_b32 s23, 0x20000
  s_sub_u32 s28, s2, 221
  s_lshl_b32 s28, s28, 2
  s_add_u32 s28, s28, s3
  s_lshl_b32 s28, s28, 13
  v_lshlrev_b32 v5, 7, v1
  buffer_load_dword v241, v5, s[16:19], s28 offen
  s_waitcnt vmcnt(0)
  buffer_load_dword v241, v5, s[20:23], s28 offen
  s_add_u32 s28, s28, 1146880
  buffer_load_dword v241, v5, s[16:19], s28 offen
  buffer_load_dword v241, v5, s[20:23], s28 offen
  s_add_u32 s28, s28, 1146880
  buffer_load_dword v241, v5, s[16:19], s28 offen
  s_add_u32 s28, s28, 1146880
p1_noseq:
  s_getpc_b64 s[56:57]
p1_pc:
  s_sub_u32 s56, s56, p1_pc-adaLN_cond__spectral_fnet__mixer_gmlp__prompt_kernel
  s_subb_u32 s57, s57, 0
  s_lshl_b32 s58, s3, 14
  v_lshlrev_b32 v240, 7, v1
  v_add_u32 v240, s58, v240
  s_cmp_lt_u32 s2, 248
  s_cbranch_scc1 p1_nocode
  v_cmp_gt_u32 vcc, code_end-adaLN_cond__spectral_fnet__mixer_gmlp__prompt_kernel, v240
  s_nop 0
  s_and_saveexec_b64 s[58:59], vcc
  s_cbranch_execz p1_nc0
  global_load_dword v241, v240, s[56:57]
p1_nc0:
  s_mov_b64 exec, s[58:59]
  v_add_u32 v240, 8192, v240
  v_cmp_gt_u32 vcc, code_end-adaLN_cond__spectral_fnet__mixer_gmlp__prompt_kernel, v240
  s_nop 0
  s_and_saveexec_b64 s[58:59], vcc
  s_cbranch_execz p1_nc1
  global_load_dword v241, v240, s[56:57]
p1_nc1:
  s_mov_b64 exec, s[58:59]
  v_add_u32 v240, 8192, v240
p1_nocode:
  s_sub_u32 s28, s2, 217
  s_cmp_ge_u32 s28, 4
  s_cbranch_scc1 p1_end
  v_lshrrev_b32 v5, 4, v0
  v_mul_u32_u24 v5, 17408, v5
  v_and_b32 v6, 15, v0
  v_lshl_add_u32 v5, v6, 4, v5
  s_mul_i32 s38, s28, 557056
  s_add_u32 s38, s38, 606208
  s_add_u32 s39, s38, 278528
  v_mov_b32 v8, 0
  v_mov_b32 v9, 0
  v_mov_b32 v10, 0
  v_mov_b32 v11, 0
  buffer_store_dwordx4 v[8:11], v5, s[12:15], s38 offen offset:256 sc1
  buffer_store_dwordx4 v[8:11], v5, s[12:15], s39 offen offset:256 sc1
  buffer_store_dwordx4 v[8:11], v5, s[12:15], s38 offen offset:512 sc1
  buffer_store_dwordx4 v[8:11], v5, s[12:15], s39 offen offset:512 sc1
  buffer_store_dwordx4 v[8:11], v5, s[12:15], s38 offen offset:768 sc1
  buffer_store_dwordx4 v[8:11], v5, s[12:15], s39 offen offset:768 sc1
p1_end:
  s_load_dwordx2 s[4:5], s[0:1], 8
  s_load_dwordx2 s[6:7], s[0:1], 112
  s_load_dwordx2 s[24:25], s[0:1], 16
  s_load_dwordx2 s[26:27], s[0:1], 88
  s_load_dwordx2 s[44:45], s[0:1], 72
  s_load_dwordx2 s[46:47], s[0:1], 48
  v_and_b32 v1, 63, v0
  s_and_b32 s28, s2, 7
  s_lshr_b32 s29, s2, 3
  s_lshr_b32 s30, s28, 1
  s_and_b32 s31, s28, 1
  s_lshl_b32 s31, s31, 2
  s_lshr_b32 s32, s29, 3
  s_lshl_b32 s43, s32, 1
  s_add_u32 s31, s31, s32
  s_and_b32 s32, s29, 7
  s_add_u32 s43, s43, s32
  s_lshr_b32 s33, s30, 1
  s_and_b32 s34, s30, 1
  v_lshrrev_b32 v2, 3, v1
  v_and_b32 v3, 7, v1
  v_lshrrev_b32 v4, 1, v2
  v_xor_b32 v5, v3, v4
  v_lshlrev_b32 v5, 4, v5
  v_lshl_add_u32 v5, v2, 13, v5
  v_xor_b32 v6, 64, v5
  v_lshlrev_b32 v7, 4, v1
  v_lshrrev_b32 v8, 4, v1
  v_and_b32 v9, 15, v1
  v_lshlrev_b32 v10, 4, v8
  s_lshl_b32 s35, s32, 8
  s_lshl_b32 s36, s3, 6
  s_add_u32 s35, s35, s36
  s_lshl_b32 s36, s31, 19
  s_lshl_b32 s37, s34, 12
  s_add_u32 s36, s36, s37
  s_add_u32 s42, s36, 0x80000
  s_lshl_b32 s40, s30, 3
  s_add_u32 s40, s40, s31
  s_cmp_eq_u32 s40, 7
  s_cselect_b32 s42, s42, 0x40000000
  s_cselect_b32 s61, 1, 0
  s_add_u32 s66, s36, 393216
  s_mov_b32 s67, 6144
  s_lshl_b32 s37, s3, 17
  s_add_u32 s36, s36, s37
  s_lshl_b32 s38, s3, 11
  s_mul_i32 s39, s30, 557056
  s_lshl_b32 s40, s32, 2
  s_add_u32 s40, s40, s3
  s_mul_i32 s40, s40, 17408
  s_add_u32 s39, s39, s40
  s_add_u32 s39, s39, 589824
  s_add_u32 s52, s43, 0
  s_and_b32 s52, s52, 7
  s_lshl_b32 s52, s52, 7
  s_add_u32 s53, s43, 1
  s_and_b32 s53, s53, 7
  s_lshl_b32 s53, s53, 7
  s_add_u32 s54, s43, 2
  s_and_b32 s54, s54, 7
  s_lshl_b32 s54, s54, 7
  s_add_u32 s55, s43, 3
  s_and_b32 s55, s55, 7
  s_lshl_b32 s55, s55, 7
  s_add_u32 s56, s43, 4
  s_and_b32 s56, s56, 7
  s_lshl_b32 s56, s56, 7
  s_add_u32 s57, s43, 5
  s_and_b32 s57, s57, 7
  s_lshl_b32 s57, s57, 7
  s_add_u32 s58, s43, 6
  s_and_b32 s58, s58, 7
  s_lshl_b32 s58, s58, 7
  s_add_u32 s59, s43, 7
  s_and_b32 s59, s59, 7
  s_lshl_b32 s59, s59, 7
  s_movk_i32 s60, 1024
  v_lshrrev_b32 v20, 1, v9
  v_xor_b32 v20, v20, v8
  v_lshlrev_b32 v20, 4, v20
  v_lshl_add_u32 v20, v9, 7, v20
  v_xor_b32 v21, 64, v20
  v_add_u32 v22, 0x10000, v20
  v_and_b32 v23, 7, v9
  v_lshrrev_b32 v24, 1, v23
  v_xor_b32 v24, v24, v8
  v_lshlrev_b32 v24, 4, v24
  v_lshl_add_u32 v23, v23, 7, v24
  v_add_u32 v23, 73728, v23
  v_xor_b32 v24, 64, v23
  s_waitcnt lgkmcnt(0)
  s_cmp_eq_u32 s33, 0
  s_cselect_b32 s4, s4, s24
  s_cselect_b32 s5, s5, s25
  s_mov_b32 s8, s4
  s_mov_b32 s9, s5
  s_mov_b32 s10, 0x800000
  s_mov_b32 s11, 0x20000
  s_mov_b32 s12, s6
  s_mov_b32 s13, s7
  s_mov_b32 s14, 0x2000000
  s_mov_b32 s15, 0x20000
  s_mov_b32 s16, s26
  s_mov_b32 s17, s27
  s_mov_b32 s18, 0x300000
  s_mov_b32 s19, 0x20000
  s_mov_b32 s20, s44
  s_mov_b32 s21, s45
  s_mov_b32 s22, 0xe0000
  s_mov_b32 s23, 0x20000
  s_mov_b32 s48, s46
  s_mov_b32 s49, s47
  s_mov_b32 s50, 0x1c0000
  s_mov_b32 s51, 0x20000
  v_lshrrev_b32 v230, 5, v1
  v_lshlrev_b32 v230, 12, v230
  v_and_b32 v231, 31, v1
  v_lshl_add_u32 v230, v231, 7, v230
  v_lshlrev_b32 v231, 7, v1
  v_mov_b32 v232, 0x40000000
  v_cmp_gt_u32 vcc, 7, v1
  s_nop 1
  v_cndmask_b32 v231, v232, v231, vcc
  s_waitcnt vmcnt(0) lgkmcnt(0)
  s_barrier
  v_readfirstlane_b32 s101, v249
  s_nop 0
  s_mul_i32 s101, s101, 0x9E3779B1
  s_add_u32 s101, s101, 0x7F4A7C15
  s_cmp_lg_u32 s3, 3
  s_cbranch_scc1 adaLN_cond__spectral_fnet__mixer_gmlp__prompt_kernel_join2
  v_mov_b32 v254, s101
  v_mov_b32 v255, 0
  s_lshl_b32 s88, s2, 7
  s_add_u32 s88, s88, 23068672
  s_mov_b64 s[90:91], exec
  s_mov_b64 exec, 1
  buffer_store_dword v254, v255, s[96:99], s88 offen sc1
  s_mov_b64 exec, s[90:91]
  v_and_b32 v250, 63, v0
  v_lshlrev_b32 v251, 7, v250
  v_mov_b32 v252, 0x40000000
  v_add_u32 v253, 216, v250
  v_lshlrev_b32 v253, 7, v253
  v_cmp_gt_u32 vcc, 5, v250
  s_nop 1
  v_cndmask_b32 v252, v252, v253, vcc
  v_mov_b32 v253, 8192
  v_cmp_eq_u32 vcc, 0, v250
  s_nop 1
  v_cndmask_b32 v252, v252, v253, vcc
  v_mov_b32 v250, v251
  s_mov_b32 s88, 23068672
  s_mov_b32 s89, 0x40000
adaLN_cond__spectral_fnet__mixer_gmlp__prompt_kernel_gb3:
  buffer_load_dword v244, v250, s[96:99], s88 offen sc1
  buffer_load_dword v245, v252, s[96:99], s88 offen sc1
  s_waitcnt vmcnt(0)
  v_cmp_le_u32 vcc, 0x40000000, v250
  s_nop 1
  v_cndmask_b32 v244, v244, v254, vcc
  v_xor_b32 v244, v244, v254
  v_cmp_le_u32 vcc, 0x40000000, v252
  s_nop 1
  v_cndmask_b32 v245, v245, v254, vcc
  v_xor_b32 v245, v245, v254
  v_or_b32 v244, v244, v245
  v_cmp_ne_u32 vcc, 0, v244
  s_nop 4
  s_cbranch_vccz adaLN_cond__spectral_fnet__mixer_gmlp__prompt_kernel_gbd4
  s_sub_u32 s89, s89, 1
  s_cmp_lg_u32 s89, 0
  s_cbranch_scc1 adaLN_cond__spectral_fnet__mixer_gmlp__prompt_kernel_gb3
adaLN_cond__spectral_fnet__mixer_gmlp__prompt_kernel_gbd4:
  s_mov_b64 s[90:91], exec
  s_branch adaLN_cond__spectral_fnet__mixer_gmlp__prompt_kernel_join25
adaLN_cond__spectral_fnet__mixer_gmlp__prompt_kernel_join2:
  s_getpc_b64 s[92:93]
adaLN_cond__spectral_fnet__mixer_gmlp__prompt_kernel_ct6:
  s_lshl_b32 s94, s3, 13
  v_and_b32 v244, 63, v0
  v_lshlrev_b32 v244, 7, v244
  v_add_u32 v244, s94, v244
  v_cmp_gt_u32 vcc, code_end-adaLN_cond__spectral_fnet__mixer_gmlp__prompt_kernel_ct6, v244
  s_nop 0
  s_and_saveexec_b64 s[94:95], vcc
  s_cbranch_execz adaLN_cond__spectral_fnet__mixer_gmlp__prompt_kernel_ctn7
  global_load_dword v245, v244, s[92:93]
adaLN_cond__spectral_fnet__mixer_gmlp__prompt_kernel_ctn7:
  s_mov_b64 exec, s[94:95]
  s_cmp_eq_u32 s65, 1
  s_cbranch_scc1 adaLN_cond__spectral_fnet__mixer_gmlp__prompt_kernel_skp8
  s_add_u32 s40, s36, s52
  s_add_u32 m0, s38, 0
  s_nop 0
  buffer_load_dwordx4 v5, s[8:11], s40 offen lds
  s_add_u32 s40, s36, s52
  s_add_u32 s40, s40, 65536
  s_add_u32 m0, s38, 1024
  s_nop 0
  buffer_load_dwordx4 v6, s[8:11], s40 offen lds
  s_add_u32 s40, s36, s53
  s_add_u32 m0, s38, 8192
  s_nop 0
  buffer_load_dwordx4 v5, s[8:11], s40 offen lds
  s_add_u32 s40, s36, s53
  s_add_u32 s40, s40, 65536
  s_add_u32 m0, s38, 9216
  s_nop 0
  buffer_load_dwordx4 v6, s[8:11], s40 offen lds
  s_add_u32 s40, s36, s54
  s_add_u32 m0, s38, 16384
  s_nop 0
  buffer_load_dwordx4 v5, s[8:11], s40 offen lds
  s_add_u32 s40, s36, s54
  s_add_u32 s40, s40, 65536
  s_add_u32 m0, s38, 17408
  s_nop 0
  buffer_load_dwordx4 v6, s[8:11], s40 offen lds
  s_add_u32 s40, s36, s55
  s_add_u32 m0, s38, 24576
  s_nop 0
  buffer_load_dwordx4 v5, s[8:11], s40 offen lds
  s_add_u32 s40, s36, s55
  s_add_u32 s40, s40, 65536
  s_add_u32 m0, s38, 25600
  s_nop 0
  buffer_load_dwordx4 v6, s[8:11], s40 offen lds
  s_add_u32 s40, s36, s56
  s_add_u32 m0, s38, 32768
  s_nop 0
  buffer_load_dwordx4 v5, s[8:11], s40 offen lds
  s_add_u32 s40, s36, s56
  s_add_u32 s40, s40, 65536
  s_add_u32 m0, s38, 33792
  s_nop 0
  buffer_load_dwordx4 v6, s[8:11], s40 offen lds
  s_add_u32 s40, s36, s57
  s_add_u32 m0, s38, 40960
  s_nop 0
  buffer_load_dwordx4 v5, s[8:11], s40 offen lds
  s_add_u32 s40, s36, s57
  s_add_u32 s40, s40, 65536
  s_add_u32 m0, s38, 41984
  s_nop 0
  buffer_load_dwordx4 v6, s[8:11], s40 offen lds
  s_add_u32 s40, s36, s58
  s_add_u32 m0, s38, 49152
  s_nop 0
  buffer_load_dwordx4 v5, s[8:11], s40 offen lds
  s_add_u32 s40, s36, s58
  s_add_u32 s40, s40, 65536
  s_add_u32 m0, s38, 50176
  s_nop 0
  buffer_load_dwordx4 v6, s[8:11], s40 offen lds
  s_add_u32 s40, s36, s59
  s_add_u32 m0, s38, 57344
  s_nop 0
  buffer_load_dwordx4 v5, s[8:11], s40 offen lds
  s_add_u32 s40, s36, s59
  s_add_u32 s40, s40, 65536
  s_add_u32 m0, s38, 58368
  s_nop 0
  buffer_load_dwordx4 v6, s[8:11], s40 offen lds
  s_add_u32 s40, s36, s60
  s_add_u32 m0, s38, 65536
  s_nop 0
  buffer_load_dwordx4 v5, s[8:11], s40 offen lds
  s_add_u32 s40, s36, s60
  s_add_u32 s40, s40, 65536
  s_add_u32 m0, s38, 66560
  s_nop 0
  buffer_load_dwordx4 v6, s[8:11], s40 offen lds
  s_lshl_b32 s40, s2, 2
  s_add_u32 s40, s40, s3
  s_mul_i32 s41, s40, 896
  buffer_load_dword v233, v231, s[20:23], s41 offen
  s_cmp_eq_u32 s3, 1
  s_cbranch_scc1 adaLN_cond__spectral_fnet__mixer_gmlp__prompt_kernel_alt10
  s_cmp_eq_u32 s3, 2
  s_cbranch_scc1 adaLN_cond__spectral_fnet__mixer_gmlp__prompt_kernel_alt11
  s_add_u32 s40, s66, s52
  s_add_u32 m0, s67, 0
  s_nop 0
  buffer_load_dwordx4 v5, s[8:11], s40 offen lds
  s_add_u32 s40, s66, s53
  s_add_u32 s40, s40, 65536
  s_add_u32 m0, s67, 9216
  s_nop 0
  buffer_load_dwordx4 v6, s[8:11], s40 offen lds
  s_add_u32 s40, s66, s55
  s_add_u32 m0, s67, 24576
  s_nop 0
  buffer_load_dwordx4 v5, s[8:11], s40 offen lds
  s_add_u32 s40, s66, s56
  s_add_u32 s40, s40, 65536
  s_add_u32 m0, s67, 33792
  s_nop 0
  buffer_load_dwordx4 v6, s[8:11], s40 offen lds
  s_add_u32 s40, s66, s58
  s_add_u32 m0, s67, 49152
  s_nop 0
  buffer_load_dwordx4 v5, s[8:11], s40 offen lds
  s_add_u32 s40, s66, s59
  s_add_u32 s40, s40, 65536
  s_add_u32 m0, s67, 58368
  s_nop 0
  buffer_load_dwordx4 v6, s[8:11], s40 offen lds
  s_add_u32 s40, s42, s52
  s_mov_b32 m0, 73728
  s_nop 0
  buffer_load_dwordx4 v5, s[8:11], s40 offen lds
  s_add_u32 s40, s42, s55
  s_mov_b32 m0, 76800
  s_nop 0
  buffer_load_dwordx4 v5, s[8:11], s40 offen lds
  s_add_u32 s40, s42, s58
  s_mov_b32 m0, 79872
  s_nop 0
  buffer_load_dwordx4 v5, s[8:11], s40 offen lds
  s_lshl_b32 s40, s2, 2
  s_add_u32 s40, s40, 3
  s_mul_i32 s41, s40, 896
  buffer_load_dword v233, v231, s[20:23], s41 offen
  s_branch adaLN_cond__spectral_fnet__mixer_gmlp__prompt_kernel_join2b12
adaLN_cond__spectral_fnet__mixer_gmlp__prompt_kernel_alt10:
  s_add_u32 s40, s66, s52
  s_add_u32 s40, s40, 65536
  s_add_u32 m0, s67, 1024
  s_nop 0
  buffer_load_dwordx4 v6, s[8:11], s40 offen lds
  s_add_u32 s40, s66, s54
  s_add_u32 m0, s67, 16384
  s_nop 0
  buffer_load_dwordx4 v5, s[8:11], s40 offen lds
  s_add_u32 s40, s66, s55
  s_add_u32 s40, s40, 65536
  s_add_u32 m0, s67, 25600
  s_nop 0
  buffer_load_dwordx4 v6, s[8:11], s40 offen lds
  s_add_u32 s40, s66, s57
  s_add_u32 m0, s67, 40960
  s_nop 0
  buffer_load_dwordx4 v5, s[8:11], s40 offen lds
  s_add_u32 s40, s66, s58
  s_add_u32 s40, s40, 65536
  s_add_u32 m0, s67, 50176
  s_nop 0
  buffer_load_dwordx4 v6, s[8:11], s40 offen lds
  s_add_u32 s40, s66, s60
  s_add_u32 m0, s67, 65536
  s_nop 0
  buffer_load_dwordx4 v5, s[8:11], s40 offen lds
  s_add_u32 s40, s42, s53
  s_mov_b32 m0, 74752
  s_nop 0
  buffer_load_dwordx4 v5, s[8:11], s40 offen lds
  s_add_u32 s40, s42, s56
  s_mov_b32 m0, 77824
  s_nop 0
  buffer_load_dwordx4 v5, s[8:11], s40 offen lds
  s_add_u32 s40, s42, s59
  s_mov_b32 m0, 80896
  s_nop 0
  buffer_load_dwordx4 v5, s[8:11], s40 offen lds
  s_branch adaLN_cond__spectral_fnet__mixer_gmlp__prompt_kernel_join2b12
adaLN_cond__spectral_fnet__mixer_gmlp__prompt_kernel_alt11:
  s_add_u32 s40, s66, s53
  s_add_u32 m0, s67, 8192
  s_nop 0
  buffer_load_dwordx4 v5, s[8:11], s40 offen lds
  s_add_u32 s40, s66, s54
  s_add_u32 s40, s40, 65536
  s_add_u32 m0, s67, 17408
  s_nop 0
  buffer_load_dwordx4 v6, s[8:11], s40 offen lds
  s_add_u32 s40, s66, s56
  s_add_u32 m0, s67, 32768
  s_nop 0
  buffer_load_dwordx4 v5, s[8:11], s40 offen lds
  s_add_u32 s40, s66, s57
  s_add_u32 s40, s40, 65536
  s_add_u32 m0, s67, 41984
  s_nop 0
  buffer_load_dwordx4 v6, s[8:11], s40 offen lds
  s_add_u32 s40, s66, s59
  s_add_u32 m0, s67, 57344
  s_nop 0
  buffer_load_dwordx4 v5, s[8:11], s40 offen lds
  s_add_u32 s40, s66, s60
  s_add_u32 s40, s40, 65536
  s_add_u32 m0, s67, 66560
  s_nop 0
  buffer_load_dwordx4 v6, s[8:11], s40 offen lds
  s_add_u32 s40, s42, s54
  s_mov_b32 m0, 75776
  s_nop 0
  buffer_load_dwordx4 v5, s[8:11], s40 offen lds
  s_add_u32 s40, s42, s57
  s_mov_b32 m0, 78848
  s_nop 0
  buffer_load_dwordx4 v5, s[8:11], s40 offen lds
  s_add_u32 s40, s42, s60
  s_mov_b32 m0, 81920
  s_nop 0
  buffer_load_dwordx4 v5, s[8:11], s40 offen lds
adaLN_cond__spectral_fnet__mixer_gmlp__prompt_kernel_join2b12:
adaLN_cond__spectral_fnet__mixer_gmlp__prompt_kernel_skp8:
adaLN_cond__spectral_fnet__mixer_gmlp__prompt_kernel_join25:
  s_barrier
  s_cmp_eq_u32 s61, 1
  s_cbranch_scc1 p2_sp
  s_lshl_b32 s41, s52, 4
  s_add_u32 s41, s41, s39
  buffer_load_dwordx4 v[32:35], v7, s[12:15], s41 offen offset:0 sc1
  buffer_load_dwordx4 v[36:39], v7, s[12:15], s41 offen offset:1024 sc1
  s_lshl_b32 s41, s53, 4
  s_add_u32 s41, s41, s39
  buffer_load_dwordx4 v[40:43], v7, s[12:15], s41 offen offset:0 sc1
  buffer_load_dwordx4 v[44:47], v7, s[12:15], s41 offen offset:1024 sc1
  s_lshl_b32 s41, s54, 4
  s_add_u32 s41, s41, s39
  buffer_load_dwordx4 v[48:51], v7, s[12:15], s41 offen offset:0 sc1
  buffer_load_dwordx4 v[52:55], v7, s[12:15], s41 offen offset:1024 sc1
  s_lshl_b32 s41, s55, 4
  s_add_u32 s41, s41, s39
  buffer_load_dwordx4 v[56:59], v7, s[12:15], s41 offen offset:0 sc1
  buffer_load_dwordx4 v[60:63], v7, s[12:15], s41 offen offset:1024 sc1
  s_lshl_b32 s41, s56, 4
  s_add_u32 s41, s41, s39
  buffer_load_dwordx4 v[64:67], v7, s[12:15], s41 offen offset:0 sc1
  buffer_load_dwordx4 v[68:71], v7, s[12:15], s41 offen offset:1024 sc1
  s_lshl_b32 s41, s57, 4
  s_add_u32 s41, s41, s39
  buffer_load_dwordx4 v[72:75], v7, s[12:15], s41 offen offset:0 sc1
  buffer_load_dwordx4 v[76:79], v7, s[12:15], s41 offen offset:1024 sc1
  s_lshl_b32 s41, s58, 4
  s_add_u32 s41, s41, s39
  buffer_load_dwordx4 v[80:83], v7, s[12:15], s41 offen offset:0 sc1
  buffer_load_dwordx4 v[84:87], v7, s[12:15], s41 offen offset:1024 sc1
  s_lshl_b32 s41, s59, 4
  s_add_u32 s41, s41, s39
  buffer_load_dwordx4 v[88:91], v7, s[12:15], s41 offen offset:0 sc1
  buffer_load_dwordx4 v[92:95], v7, s[12:15], s41 offen offset:1024 sc1
  s_lshl_b32 s41, s60, 4
  s_add_u32 s41, s41, s39
  buffer_load_dwordx4 v[96:99], v7, s[12:15], s41 offen offset:0 sc1
  v_lshlrev_b32 v220, 7, v1
  v_add_u32 v220, 8320, v220
  v_add_u32 v221, 8192, v220
  v_add_u32 v222, 8192, v221
  v_mov_b32 v223, 0x40000000
  v_cmp_gt_u32 vcc, 24, v1
  s_nop 1
  v_cndmask_b32 v222, v223, v222, vcc
  s_mov_b32 s62, 23068672
  buffer_load_dword v224, v220, s[96:99], s62 offen sc1
  buffer_load_dword v225, v221, s[96:99], s62 offen sc1
  buffer_load_dword v226, v222, s[96:99], s62 offen sc1
  v_mov_b32 v227, s101
  s_waitcnt vmcnt(21)
  s_barrier
  ds_read_b128 v[100:103], v20 offset:0
  ds_read_b128 v[104:107], v20 offset:2048
  ds_read_b128 v[108:111], v20 offset:4096
  ds_read_b128 v[112:115], v20 offset:6144
  ds_read_b128 v[120:123], v21 offset:0
  ds_read_b128 v[124:127], v21 offset:2048
  ds_read_b128 v[128:131], v21 offset:4096
  ds_read_b128 v[132:135], v21 offset:6144
  s_waitcnt lgkmcnt(4)
  s_waitcnt vmcnt(18)
  v_mfma_f32_16x16x32_bf16 v[160:163], v[32:35], v[100:103], 0
  ds_read_b128 v[140:143], v20 offset:8192
  v_mfma_f32_16x16x32_bf16 v[164:167], v[32:35], v[104:107], 0
  ds_read_b128 v[144:147], v20 offset:10240
  v_mfma_f32_16x16x32_bf16 v[168:171], v[32:35], v[108:111], 0
  ds_read_b128 v[148:151], v20 offset:12288
  v_mfma_f32_16x16x32_bf16 v[172:175], v[32:35], v[112:115], 0
  ds_read_b128 v[152:155], v20 offset:14336
  s_waitcnt lgkmcnt(4)
  v_mfma_f32_16x16x32_bf16 v[160:163], v[36:39], v[120:123], v[160:163]
  ds_read_b128 v[100:103], v21 offset:8192
  v_mfma_f32_16x16x32_bf16 v[164:167], v[36:39], v[124:127], v[164:167]
  ds_read_b128 v[104:107], v21 offset:10240
  v_mfma_f32_16x16x32_bf16 v[168:171], v[36:39], v[128:131], v[168:171]
  ds_read_b128 v[108:111], v21 offset:12288
  v_mfma_f32_16x16x32_bf16 v[172:175], v[36:39], v[132:135], v[172:175]
  ds_read_b128 v[112:115], v21 offset:14336
  s_waitcnt lgkmcnt(4)
  s_waitcnt vmcnt(16)
  v_mfma_f32_16x16x32_bf16 v[160:163], v[40:43], v[140:143], v[160:163]
  ds_read_b128 v[120:123], v20 offset:16384
  v_mfma_f32_16x16x32_bf16 v[164:167], v[40:43], v[144:147], v[164:167]
  ds_read_b128 v[124:127], v20 offset:18432
  v_mfma_f32_16x16x32_bf16 v[168:171], v[40:43], v[148:151], v[168:171]
  ds_read_b128 v[128:131], v20 offset:20480
  v_mfma_f32_16x16x32_bf16 v[172:175], v[40:43], v[152:155], v[172:175]
  ds_read_b128 v[132:135], v20 offset:22528
  s_waitcnt lgkmcnt(4)
  v_mfma_f32_16x16x32_bf16 v[160:163], v[44:47], v[100:103], v[160:163]
  ds_read_b128 v[140:143], v21 offset:16384
  v_mfma_f32_16x16x32_bf16 v[164:167], v[44:47], v[104:107], v[164:167]
  ds_read_b128 v[144:147], v21 offset:18432
  v_mfma_f32_16x16x32_bf16 v[168:171], v[44:47], v[108:111], v[168:171]
  ds_read_b128 v[148:151], v21 offset:20480
  v_mfma_f32_16x16x32_bf16 v[172:175], v[44:47], v[112:115], v[172:175]
  ds_read_b128 v[152:155], v21 offset:22528
  s_waitcnt lgkmcnt(4)
  s_waitcnt vmcnt(14)
  v_mfma_f32_16x16x32_bf16 v[160:163], v[48:51], v[120:123], v[160:163]
  ds_read_b128 v[100:103], v20 offset:24576
  v_mfma_f32_16x16x32_bf16 v[164:167], v[48:51], v[124:127], v[164:167]
  ds_read_b128 v[104:107], v20 offset:26624
  v_mfma_f32_16x16x32_bf16 v[168:171], v[48:51], v[128:131], v[168:171]
  ds_read_b128 v[108:111], v20 offset:28672
  v_mfma_f32_16x16x32_bf16 v[172:175], v[48:51], v[132:135], v[172:175]
  ds_read_b128 v[112:115], v20 offset:30720
  s_waitcnt lgkmcnt(4)
  v_mfma_f32_16x16x32_bf16 v[160:163], v[52:55], v[140:143], v[160:163]
  ds_read_b128 v[120:123], v21 offset:24576
  v_mfma_f32_16x16x32_bf16 v[164:167], v[52:55], v[144:147], v[164:167]
  ds_read_b128 v[124:127], v21 offset:26624
  v_mfma_f32_16x16x32_bf16 v[168:171], v[52:55], v[148:151], v[168:171]
  ds_read_b128 v[128:131], v21 offset:28672
  v_mfma_f32_16x16x32_bf16 v[172:175], v[52:55], v[152:155], v[172:175]
  ds_read_b128 v[132:135], v21 offset:30720
  s_waitcnt lgkmcnt(4)
  s_waitcnt vmcnt(12)
  v_mfma_f32_16x16x32_bf16 v[160:163], v[56:59], v[100:103], v[160:163]
  ds_read_b128 v[140:143], v20 offset:32768
  v_mfma_f32_16x16x32_bf16 v[164:167], v[56:59], v[104:107], v[164:167]
  ds_read_b128 v[144:147], v20 offset:34816
  v_mfma_f32_16x16x32_bf16 v[168:171], v[56:59], v[108:111], v[168:171]
  ds_read_b128 v[148:151], v20 offset:36864
  v_mfma_f32_16x16x32_bf16 v[172:175], v[56:59], v[112:115], v[172:175]
  ds_read_b128 v[152:155], v20 offset:38912
  s_waitcnt lgkmcnt(4)
  v_mfma_f32_16x16x32_bf16 v[160:163], v[60:63], v[120:123], v[160:163]
  ds_read_b128 v[100:103], v21 offset:32768
  v_mfma_f32_16x16x32_bf16 v[164:167], v[60:63], v[124:127], v[164:167]
  ds_read_b128 v[104:107], v21 offset:34816
  v_mfma_f32_16x16x32_bf16 v[168:171], v[60:63], v[128:131], v[168:171]
  ds_read_b128 v[108:111], v21 offset:36864
  v_mfma_f32_16x16x32_bf16 v[172:175], v[60:63], v[132:135], v[172:175]
  ds_read_b128 v[112:115], v21 offset:38912
  s_waitcnt lgkmcnt(4)
  s_waitcnt vmcnt(10)
  v_mfma_f32_16x16x32_bf16 v[160:163], v[64:67], v[140:143], v[160:163]
  ds_read_b128 v[120:123], v20 offset:40960
  v_mfma_f32_16x16x32_bf16 v[164:167], v[64:67], v[144:147], v[164:167]
  ds_read_b128 v[124:127], v20 offset:43008
  v_mfma_f32_16x16x32_bf16 v[168:171], v[64:67], v[148:151], v[168:171]
  ds_read_b128 v[128:131], v20 offset:45056
  v_mfma_f32_16x16x32_bf16 v[172:175], v[64:67], v[152:155], v[172:175]
  ds_read_b128 v[132:135], v20 offset:47104
  s_waitcnt lgkmcnt(4)
  s_mov_b32 s63, 0x40000
  s_waitcnt vmcnt(0)
adaLN_cond__spectral_fnet__mixer_gmlp__prompt_kernel_lp14:
  v_cmp_gt_u32 vcc, 24, v1
  s_nop 1
  v_cndmask_b32 v226, v227, v226, vcc
  v_xor_b32 v224, v224, v227
  v_xor_b32 v225, v225, v227
  v_xor_b32 v226, v226, v227
  v_or_b32 v224, v224, v225
  v_or_b32 v224, v224, v226
  v_cmp_ne_u32 vcc, 0, v224
  s_nop 4
  s_cbranch_vccz adaLN_cond__spectral_fnet__mixer_gmlp__prompt_kernel_lpd15
  buffer_load_dword v224, v220, s[96:99], s62 offen sc1
  buffer_load_dword v225, v221, s[96:99], s62 offen sc1
  buffer_load_dword v226, v222, s[96:99], s62 offen sc1
  s_waitcnt vmcnt(0)
  s_sub_u32 s63, s63, 1
  s_cmp_lg_u32 s63, 0
  s_cbranch_scc1 adaLN_cond__spectral_fnet__mixer_gmlp__prompt_kernel_lp14
adaLN_cond__spectral_fnet__mixer_gmlp__prompt_kernel_lpd15:
  buffer_load_dwordx4 v[12:15], v10, s[12:15], s35 offen offset:2048 sc1
  buffer_load_dwordx4 v[16:19], v10, s[12:15], s35 offen offset:0 sc1
  s_lshl_b32 s40, s2, 14
  s_lshl_b32 s41, s3, 12
  s_add_u32 s40, s40, s41
  s_add_u32 s40, s40, 20512768
  s_cmp_lt_u32 s2, 112
  s_cselect_b32 s40, s40, 0x40000000
  s_lshl_b32 s41, s3, 8
  s_add_u32 s41, s41, 12288
  v_lshlrev_b32 v28, 10, v9
  v_lshl_add_u32 v28, v8, 4, v28
  v_mov_b32 v29, 0x40000000
  v_cmp_gt_u32 vcc, 2, v9
  s_nop 1
  v_cndmask_b32 v28, v29, v28, vcc
  buffer_load_dwordx4 v[184:187], v7, s[12:15], s40 offen offset:0 sc1
  buffer_load_dwordx4 v[200:203], v28, s[12:15], s41 offen offset:0 sc1
  buffer_load_dwordx4 v[188:191], v7, s[12:15], s40 offen offset:1024 sc1
  buffer_load_dwordx4 v[204:207], v28, s[12:15], s41 offen offset:64 sc1
  buffer_load_dwordx4 v[192:195], v7, s[12:15], s40 offen offset:2048 sc1
  buffer_load_dwordx4 v[208:211], v28, s[12:15], s41 offen offset:128 sc1
  buffer_load_dwordx4 v[196:199], v7, s[12:15], s40 offen offset:3072 sc1
  buffer_load_dwordx4 v[212:215], v28, s[12:15], s41 offen offset:192 sc1
  v_mfma_f32_16x16x32_bf16 v[160:163], v[68:71], v[100:103], v[160:163]
  ds_read_b128 v[140:143], v21 offset:40960
  v_mfma_f32_16x16x32_bf16 v[164:167], v[68:71], v[104:107], v[164:167]
  ds_read_b128 v[144:147], v21 offset:43008
  v_mfma_f32_16x16x32_bf16 v[168:171], v[68:71], v[108:111], v[168:171]
  ds_read_b128 v[148:151], v21 offset:45056
  v_mfma_f32_16x16x32_bf16 v[172:175], v[68:71], v[112:115], v[172:175]
  ds_read_b128 v[152:155], v21 offset:47104
  s_waitcnt lgkmcnt(4)
  v_mfma_f32_16x16x32_bf16 v[160:163], v[72:75], v[120:123], v[160:163]
  ds_read_b128 v[100:103], v20 offset:49152
  v_mfma_f32_16x16x32_bf16 v[164:167], v[72:75], v[124:127], v[164:167]
  ds_read_b128 v[104:107], v20 offset:51200
  v_mfma_f32_16x16x32_bf16 v[168:171], v[72:75], v[128:131], v[168:171]
  ds_read_b128 v[108:111], v20 offset:53248
  v_mfma_f32_16x16x32_bf16 v[172:175], v[72:75], v[132:135], v[172:175]
  ds_read_b128 v[112:115], v20 offset:55296
  s_waitcnt lgkmcnt(4)
  v_mfma_f32_16x16x32_bf16 v[160:163], v[76:79], v[140:143], v[160:163]
  ds_read_b128 v[120:123], v21 offset:49152
  v_mfma_f32_16x16x32_bf16 v[164:167], v[76:79], v[144:147], v[164:167]
  ds_read_b128 v[124:127], v21 offset:51200
  v_mfma_f32_16x16x32_bf16 v[168:171], v[76:79], v[148:151], v[168:171]
  ds_read_b128 v[128:131], v21 offset:53248
  v_mfma_f32_16x16x32_bf16 v[172:175], v[76:79], v[152:155], v[172:175]
  ds_read_b128 v[132:135], v21 offset:55296
  s_waitcnt lgkmcnt(4)
  v_mfma_f32_16x16x32_bf16 v[160:163], v[80:83], v[100:103], v[160:163]
  ds_read_b128 v[140:143], v20 offset:57344
  v_mfma_f32_16x16x32_bf16 v[164:167], v[80:83], v[104:107], v[164:167]
  ds_read_b128 v[144:147], v20 offset:59392
  v_mfma_f32_16x16x32_bf16 v[168:171], v[80:83], v[108:111], v[168:171]
  ds_read_b128 v[148:151], v20 offset:61440
  v_mfma_f32_16x16x32_bf16 v[172:175], v[80:83], v[112:115], v[172:175]
  ds_read_b128 v[152:155], v20 offset:63488
  s_waitcnt lgkmcnt(4)
  v_mfma_f32_16x16x32_bf16 v[160:163], v[84:87], v[120:123], v[160:163]
  ds_read_b128 v[100:103], v21 offset:57344
  v_mfma_f32_16x16x32_bf16 v[164:167], v[84:87], v[124:127], v[164:167]
  ds_read_b128 v[104:107], v21 offset:59392
  v_mfma_f32_16x16x32_bf16 v[168:171], v[84:87], v[128:131], v[168:171]
  ds_read_b128 v[108:111], v21 offset:61440
  v_mfma_f32_16x16x32_bf16 v[172:175], v[84:87], v[132:135], v[172:175]
  ds_read_b128 v[112:115], v21 offset:63488
  s_waitcnt lgkmcnt(4)
  v_mfma_f32_16x16x32_bf16 v[160:163], v[88:91], v[140:143], v[160:163]
  ds_read_b128 v[120:123], v22 offset:0
  v_mfma_f32_16x16x32_bf16 v[164:167], v[88:91], v[144:147], v[164:167]
  ds_read_b128 v[124:127], v22 offset:2048
  v_mfma_f32_16x16x32_bf16 v[168:171], v[88:91], v[148:151], v[168:171]
  ds_read_b128 v[128:131], v22 offset:4096
  v_mfma_f32_16x16x32_bf16 v[172:175], v[88:91], v[152:155], v[172:175]
  ds_read_b128 v[132:135], v22 offset:6144
  s_waitcnt lgkmcnt(4)
  v_mfma_f32_16x16x32_bf16 v[160:163], v[92:95], v[100:103], v[160:163]
  v_mfma_f32_16x16x32_bf16 v[164:167], v[92:95], v[104:107], v[164:167]
  v_mfma_f32_16x16x32_bf16 v[168:171], v[92:95], v[108:111], v[168:171]
  v_mfma_f32_16x16x32_bf16 v[172:175], v[92:95], v[112:115], v[172:175]
  s_waitcnt lgkmcnt(0)
  v_mfma_f32_16x16x32_bf16 v[160:163], v[96:99], v[120:123], v[160:163]
  v_mfma_f32_16x16x32_bf16 v[164:167], v[96:99], v[124:127], v[164:167]
  v_mfma_f32_16x16x32_bf16 v[168:171], v[96:99], v[128:131], v[168:171]
  v_mfma_f32_16x16x32_bf16 v[172:175], v[96:99], v[132:135], v[172:175]
  s_waitcnt vmcnt(0)
  v_mfma_f32_16x16x32_bf16 v[216:219], v[200:203], v[184:187], 0
  v_mfma_f32_16x16x32_bf16 v[216:219], v[204:207], v[188:191], v[216:219]
  v_mfma_f32_16x16x32_bf16 v[216:219], v[208:211], v[192:195], v[216:219]
  v_mfma_f32_16x16x32_bf16 v[216:219], v[212:215], v[196:199], v[216:219]
  s_or_b32 s40, s30, s31
  s_cmp_eq_u32 s40, 0
  s_cselect_b32 s40, 0x45000000, 0
  v_mov_b32 v23, s40
  v_cmp_eq_u32 vcc, 0, v9
  s_nop 1
  v_cndmask_b32 v23, 0, v23, vcc
  v_mul_f32 v16, v16, v23
  v_mul_f32 v17, v17, v23
  v_mul_f32 v18, v18, v23
  v_mul_f32 v19, v19, v23
  v_fma_f32 v160, v160, v12, v16
  v_fma_f32 v161, v161, v13, v17
  v_fma_f32 v162, v162, v14, v18
  v_fma_f32 v163, v163, v15, v19
  v_mul_f32 v164, v164, v12
  v_mul_f32 v165, v165, v13
  v_mul_f32 v166, v166, v14
  v_mul_f32 v167, v167, v15
  v_mul_f32 v168, v168, v12
  v_mul_f32 v169, v169, v13
  v_mul_f32 v170, v170, v14
  v_mul_f32 v171, v171, v15
  v_mul_f32 v172, v172, v12
  v_mul_f32 v173, v173, v13
  v_mul_f32 v174, v174, v14
  v_mul_f32 v175, v175, v15
  v_cvt_pk_bf16_f32 v32, v160, v161
  v_cvt_pk_bf16_f32 v33, v162, v163
  v_cvt_pk_bf16_f32 v34, v164, v165
  v_cvt_pk_bf16_f32 v35, v166, v167
  v_cvt_pk_bf16_f32 v36, v168, v169
  v_cvt_pk_bf16_f32 v37, v170, v171
  v_cvt_pk_bf16_f32 v38, v172, v173
  v_cvt_pk_bf16_f32 v39, v174, v175
  v_permlane16_swap_b32 v32, v34
  v_permlane16_swap_b32 v33, v35
  v_permlane16_swap_b32 v36, v38
  v_permlane16_swap_b32 v37, v39
  v_and_b32 v10, 1, v8
  v_lshlrev_b32 v10, 14, v10
  v_lshrrev_b32 v11, 1, v8
  v_lshl_add_u32 v11, v11, 4, v9
  v_lshl_add_u32 v10, v11, 4, v10
  s_mul_i32 s40, s33, 1179648
  s_mul_i32 s41, s34, 36
  s_lshl_b32 s42, s31, 2
  s_add_u32 s41, s41, s42
  s_lshl_b32 s41, s41, 14
  s_add_u32 s40, s40, s41
  s_lshl_b32 s41, s32, 11
  s_add_u32 s40, s40, s41
  s_lshr_b32 s41, s3, 1
  s_lshl_b32 s41, s41, 10
  s_add_u32 s40, s40, s41
  s_and_b32 s41, s3, 1
  s_lshl_b32 s41, s41, 9
  s_add_u32 s40, s40, s41
  s_add_u32 s40, s40, 2818048
  buffer_store_dwordx4 v[32:35], v10, s[12:15], s40 offen sc1
  s_add_u32 s40, s40, 32768
  buffer_store_dwordx4 v[36:39], v10, s[12:15], s40 offen sc1
  v_lshlrev_b32 v10, 3, v1
  s_lshl_b32 s40, s3, 7
  s_add_u32 s40, s40, 83968
  v_add_u32 v10, s40, v10
  v_cmp_gt_u32 vcc, 16, v1
  s_nop 0
  s_and_saveexec_b64 s[44:45], vcc
  ds_write_b64 v10, v[216:217]
  s_mov_b64 exec, s[44:45]
  s_waitcnt lgkmcnt(0)
  s_barrier
  s_cmp_lg_u32 s3, 0
  s_cbranch_scc1 adaLN_cond__spectral_fnet__mixer_gmlp__prompt_kernel_nocs16
  s_cmp_ge_u32 s2, 112
  s_cbranch_scc1 adaLN_cond__spectral_fnet__mixer_gmlp__prompt_kernel_nocs16
  v_and_b32 v10, 15, v1
  v_lshlrev_b32 v11, 3, v10
  v_add_u32 v11, 83968, v11
  ds_read_b64 v[200:201], v11 offset:0
  ds_read_b64 v[202:203], v11 offset:128
  ds_read_b64 v[204:205], v11 offset:256
  ds_read_b64 v[206:207], v11 offset:384
  s_waitcnt lgkmcnt(0)
  v_add_f32 v200, v200, v202
  v_add_f32 v201, v201, v203
  v_add_f32 v200, v200, v204
  v_add_f32 v201, v201, v205
  v_add_f32 v200, v200, v206
  v_add_f32 v201, v201, v207
  v_lshlrev_b32 v10, 2, v10
  v_mov_b32 v11, 0x40000000
  v_cmp_gt_u32 vcc, 16, v1
  s_nop 1
  v_cndmask_b32 v10, v11, v10, vcc
  s_lshl_b32 s40, s2, 6
  s_add_u32 s40, s40, 16384
  buffer_store_dword v200, v10, s[12:15], s40 offen sc1
  s_add_u32 s40, s40, 7168
  buffer_store_dword v201, v10, s[12:15], s40 offen sc1
adaLN_cond__spectral_fnet__mixer_gmlp__prompt_kernel_nocs16:
  s_branch p2_end
p2_sp:
  s_lshl_b32 s41, s52, 4
  s_add_u32 s41, s41, s39
  buffer_load_dwordx4 v[32:35], v7, s[12:15], s41 offen offset:0 sc1
  buffer_load_dwordx4 v[36:39], v7, s[12:15], s41 offen offset:1024 sc1
  s_lshl_b32 s41, s53, 4
  s_add_u32 s41, s41, s39
  buffer_load_dwordx4 v[40:43], v7, s[12:15], s41 offen offset:0 sc1
  buffer_load_dwordx4 v[44:47], v7, s[12:15], s41 offen offset:1024 sc1
  s_lshl_b32 s41, s54, 4
  s_add_u32 s41, s41, s39
  buffer_load_dwordx4 v[48:51], v7, s[12:15], s41 offen offset:0 sc1
  buffer_load_dwordx4 v[52:55], v7, s[12:15], s41 offen offset:1024 sc1
  s_lshl_b32 s41, s55, 4
  s_add_u32 s41, s41, s39
  buffer_load_dwordx4 v[56:59], v7, s[12:15], s41 offen offset:0 sc1
  buffer_load_dwordx4 v[60:63], v7, s[12:15], s41 offen offset:1024 sc1
  s_lshl_b32 s41, s56, 4
  s_add_u32 s41, s41, s39
  buffer_load_dwordx4 v[64:67], v7, s[12:15], s41 offen offset:0 sc1
  buffer_load_dwordx4 v[68:71], v7, s[12:15], s41 offen offset:1024 sc1
  s_lshl_b32 s41, s57, 4
  s_add_u32 s41, s41, s39
  buffer_load_dwordx4 v[72:75], v7, s[12:15], s41 offen offset:0 sc1
  buffer_load_dwordx4 v[76:79], v7, s[12:15], s41 offen offset:1024 sc1
  s_lshl_b32 s41, s58, 4
  s_add_u32 s41, s41, s39
  buffer_load_dwordx4 v[80:83], v7, s[12:15], s41 offen offset:0 sc1
  buffer_load_dwordx4 v[84:87], v7, s[12:15], s41 offen offset:1024 sc1
  s_lshl_b32 s41, s59, 4
  s_add_u32 s41, s41, s39
  buffer_load_dwordx4 v[88:91], v7, s[12:15], s41 offen offset:0 sc1
  buffer_load_dwordx4 v[92:95], v7, s[12:15], s41 offen offset:1024 sc1
  s_lshl_b32 s41, s60, 4
  s_add_u32 s41, s41, s39
  buffer_load_dwordx4 v[96:99], v7, s[12:15], s41 offen offset:0 sc1
  v_lshlrev_b32 v220, 7, v1
  v_add_u32 v220, 8320, v220
  v_add_u32 v221, 8192, v220
  v_add_u32 v222, 8192, v221
  v_mov_b32 v223, 0x40000000
  v_cmp_gt_u32 vcc, 24, v1
  s_nop 1
  v_cndmask_b32 v222, v223, v222, vcc
  s_mov_b32 s62, 23068672
  buffer_load_dword v224, v220, s[96:99], s62 offen sc1
  buffer_load_dword v225, v221, s[96:99], s62 offen sc1
  buffer_load_dword v226, v222, s[96:99], s62 offen sc1
  v_mov_b32 v227, s101
  s_waitcnt vmcnt(21)
  s_barrier
  ds_read_b128 v[100:103], v20 offset:0
  ds_read_b128 v[104:107], v20 offset:2048
  ds_read_b128 v[108:111], v20 offset:4096
  ds_read_b128 v[112:115], v20 offset:6144
  ds_read_b128 v[116:119], v23 offset:0
  ds_read_b128 v[120:123], v21 offset:0
  ds_read_b128 v[124:127], v21 offset:2048
  ds_read_b128 v[128:131], v21 offset:4096
  ds_read_b128 v[132:135], v21 offset:6144
  ds_read_b128 v[136:139], v24 offset:0
  s_waitcnt lgkmcnt(5)
  s_waitcnt vmcnt(18)
  v_mfma_f32_16x16x32_bf16 v[160:163], v[32:35], v[100:103], 0
  ds_read_b128 v[140:143], v20 offset:8192
  v_mfma_f32_16x16x32_bf16 v[164:167], v[32:35], v[104:107], 0
  ds_read_b128 v[144:147], v20 offset:10240
  v_mfma_f32_16x16x32_bf16 v[168:171], v[32:35], v[108:111], 0
  ds_read_b128 v[148:151], v20 offset:12288
  v_mfma_f32_16x16x32_bf16 v[172:175], v[32:35], v[112:115], 0
  ds_read_b128 v[152:155], v20 offset:14336
  v_mfma_f32_16x16x32_bf16 v[176:179], v[32:35], v[116:119], 0
  ds_read_b128 v[156:159], v23 offset:1024
  s_waitcnt lgkmcnt(5)
  v_mfma_f32_16x16x32_bf16 v[160:163], v[36:39], v[120:123], v[160:163]
  ds_read_b128 v[100:103], v21 offset:8192
  v_mfma_f32_16x16x32_bf16 v[164:167], v[36:39], v[124:127], v[164:167]
  ds_read_b128 v[104:107], v21 offset:10240
  v_mfma_f32_16x16x32_bf16 v[168:171], v[36:39], v[128:131], v[168:171]
  ds_read_b128 v[108:111], v21 offset:12288
  v_mfma_f32_16x16x32_bf16 v[172:175], v[36:39], v[132:135], v[172:175]
  ds_read_b128 v[112:115], v21 offset:14336
  v_mfma_f32_16x16x32_bf16 v[176:179], v[36:39], v[136:139], v[176:179]
  ds_read_b128 v[116:119], v24 offset:1024
  s_waitcnt lgkmcnt(5)
  s_waitcnt vmcnt(16)
  v_mfma_f32_16x16x32_bf16 v[160:163], v[40:43], v[140:143], v[160:163]
  ds_read_b128 v[120:123], v20 offset:16384
  v_mfma_f32_16x16x32_bf16 v[164:167], v[40:43], v[144:147], v[164:167]
  ds_read_b128 v[124:127], v20 offset:18432
  v_mfma_f32_16x16x32_bf16 v[168:171], v[40:43], v[148:151], v[168:171]
  ds_read_b128 v[128:131], v20 offset:20480
  v_mfma_f32_16x16x32_bf16 v[172:175], v[40:43], v[152:155], v[172:175]
  ds_read_b128 v[132:135], v20 offset:22528
  v_mfma_f32_16x16x32_bf16 v[176:179], v[40:43], v[156:159], v[176:179]
  ds_read_b128 v[136:139], v23 offset:2048
  s_waitcnt lgkmcnt(5)
  v_mfma_f32_16x16x32_bf16 v[160:163], v[44:47], v[100:103], v[160:163]
  ds_read_b128 v[140:143], v21 offset:16384
  v_mfma_f32_16x16x32_bf16 v[164:167], v[44:47], v[104:107], v[164:167]
  ds_read_b128 v[144:147], v21 offset:18432
  v_mfma_f32_16x16x32_bf16 v[168:171], v[44:47], v[108:111], v[168:171]
  ds_read_b128 v[148:151], v21 offset:20480
  v_mfma_f32_16x16x32_bf16 v[172:175], v[44:47], v[112:115], v[172:175]
  ds_read_b128 v[152:155], v21 offset:22528
  v_mfma_f32_16x16x32_bf16 v[176:179], v[44:47], v[116:119], v[176:179]
  ds_read_b128 v[156:159], v24 offset:2048
  s_waitcnt lgkmcnt(5)
  s_waitcnt vmcnt(14)
  v_mfma_f32_16x16x32_bf16 v[160:163], v[48:51], v[120:123], v[160:163]
  ds_read_b128 v[100:103], v20 offset:24576
  v_mfma_f32_16x16x32_bf16 v[164:167], v[48:51], v[124:127], v[164:167]
  ds_read_b128 v[104:107], v20 offset:26624
  v_mfma_f32_16x16x32_bf16 v[168:171], v[48:51], v[128:131], v[168:171]
  ds_read_b128 v[108:111], v20 offset:28672
  v_mfma_f32_16x16x32_bf16 v[172:175], v[48:51], v[132:135], v[172:175]
  ds_read_b128 v[112:115], v20 offset:30720
  v_mfma_f32_16x16x32_bf16 v[176:179], v[48:51], v[136:139], v[176:179]
  ds_read_b128 v[116:119], v23 offset:3072
  s_waitcnt lgkmcnt(5)
  v_mfma_f32_16x16x32_bf16 v[160:163], v[52:55], v[140:143], v[160:163]
  ds_read_b128 v[120:123], v21 offset:24576
  v_mfma_f32_16x16x32_bf16 v[164:167], v[52:55], v[144:147], v[164:167]
  ds_read_b128 v[124:127], v21 offset:26624
  v_mfma_f32_16x16x32_bf16 v[168:171], v[52:55], v[148:151], v[168:171]
  ds_read_b128 v[128:131], v21 offset:28672
  v_mfma_f32_16x16x32_bf16 v[172:175], v[52:55], v[152:155], v[172:175]
  ds_read_b128 v[132:135], v21 offset:30720
  v_mfma_f32_16x16x32_bf16 v[176:179], v[52:55], v[156:159], v[176:179]
  ds_read_b128 v[136:139], v24 offset:3072
  s_waitcnt lgkmcnt(5)
  s_waitcnt vmcnt(12)
  v_mfma_f32_16x16x32_bf16 v[160:163], v[56:59], v[100:103], v[160:163]
  ds_read_b128 v[140:143], v20 offset:32768
  v_mfma_f32_16x16x32_bf16 v[164:167], v[56:59], v[104:107], v[164:167]
  ds_read_b128 v[144:147], v20 offset:34816
  v_mfma_f32_16x16x32_bf16 v[168:171], v[56:59], v[108:111], v[168:171]
  ds_read_b128 v[148:151], v20 offset:36864
  v_mfma_f32_16x16x32_bf16 v[172:175], v[56:59], v[112:115], v[172:175]
  ds_read_b128 v[152:155], v20 offset:38912
  v_mfma_f32_16x16x32_bf16 v[176:179], v[56:59], v[116:119], v[176:179]
  ds_read_b128 v[156:159], v23 offset:4096
  s_waitcnt lgkmcnt(5)
  v_mfma_f32_16x16x32_bf16 v[160:163], v[60:63], v[120:123], v[160:163]
  ds_read_b128 v[100:103], v21 offset:32768
  v_mfma_f32_16x16x32_bf16 v[164:167], v[60:63], v[124:127], v[164:167]
  ds_read_b128 v[104:107], v21 offset:34816
  v_mfma_f32_16x16x32_bf16 v[168:171], v[60:63], v[128:131], v[168:171]
  ds_read_b128 v[108:111], v21 offset:36864
  v_mfma_f32_16x16x32_bf16 v[172:175], v[60:63], v[132:135], v[172:175]
  ds_read_b128 v[112:115], v21 offset:38912
  v_mfma_f32_16x16x32_bf16 v[176:179], v[60:63], v[136:139], v[176:179]
  ds_read_b128 v[116:119], v24 offset:4096
  s_waitcnt lgkmcnt(5)
  s_waitcnt vmcnt(10)
  v_mfma_f32_16x16x32_bf16 v[160:163], v[64:67], v[140:143], v[160:163]
  ds_read_b128 v[120:123], v20 offset:40960
  v_mfma_f32_16x16x32_bf16 v[164:167], v[64:67], v[144:147], v[164:167]
  ds_read_b128 v[124:127], v20 offset:43008
  v_mfma_f32_16x16x32_bf16 v[168:171], v[64:67], v[148:151], v[168:171]
  ds_read_b128 v[128:131], v20 offset:45056
  v_mfma_f32_16x16x32_bf16 v[172:175], v[64:67], v[152:155], v[172:175]
  ds_read_b128 v[132:135], v20 offset:47104
  v_mfma_f32_16x16x32_bf16 v[176:179], v[64:67], v[156:159], v[176:179]
  ds_read_b128 v[136:139], v23 offset:5120
  s_waitcnt lgkmcnt(5)
  s_mov_b32 s63, 0x40000
  s_waitcnt vmcnt(0)
adaLN_cond__spectral_fnet__mixer_gmlp__prompt_kernel_lp17:
  v_cmp_gt_u32 vcc, 24, v1
  s_nop 1
  v_cndmask_b32 v226, v227, v226, vcc
  v_xor_b32 v224, v224, v227
  v_xor_b32 v225, v225, v227
  v_xor_b32 v226, v226, v227
  v_or_b32 v224, v224, v225
  v_or_b32 v224, v224, v226
  v_cmp_ne_u32 vcc, 0, v224
  s_nop 4
  s_cbranch_vccz adaLN_cond__spectral_fnet__mixer_gmlp__prompt_kernel_lpd18
  buffer_load_dword v224, v220, s[96:99], s62 offen sc1
  buffer_load_dword v225, v221, s[96:99], s62 offen sc1
  buffer_load_dword v226, v222, s[96:99], s62 offen sc1
  s_waitcnt vmcnt(0)
  s_sub_u32 s63, s63, 1
  s_cmp_lg_u32 s63, 0
  s_cbranch_scc1 adaLN_cond__spectral_fnet__mixer_gmlp__prompt_kernel_lp17
adaLN_cond__spectral_fnet__mixer_gmlp__prompt_kernel_lpd18:
  buffer_load_dwordx4 v[12:15], v10, s[12:15], s35 offen offset:2048 sc1
  buffer_load_dwordx4 v[16:19], v10, s[12:15], s35 offen offset:0 sc1
  s_lshl_b32 s40, s2, 14
  s_lshl_b32 s41, s3, 12
  s_add_u32 s40, s40, s41
  s_add_u32 s40, s40, 20512768
  s_cmp_lt_u32 s2, 112
  s_cselect_b32 s40, s40, 0x40000000
  s_lshl_b32 s41, s3, 8
  s_add_u32 s41, s41, 12288
  v_lshlrev_b32 v28, 10, v9
  v_lshl_add_u32 v28, v8, 4, v28
  v_mov_b32 v29, 0x40000000
  v_cmp_gt_u32 vcc, 2, v9
  s_nop 1
  v_cndmask_b32 v28, v29, v28, vcc
  buffer_load_dwordx4 v[184:187], v7, s[12:15], s40 offen offset:0 sc1
  buffer_load_dwordx4 v[200:203], v28, s[12:15], s41 offen offset:0 sc1
  buffer_load_dwordx4 v[188:191], v7, s[12:15], s40 offen offset:1024 sc1
  buffer_load_dwordx4 v[204:207], v28, s[12:15], s41 offen offset:64 sc1
  buffer_load_dwordx4 v[192:195], v7, s[12:15], s40 offen offset:2048 sc1
  buffer_load_dwordx4 v[208:211], v28, s[12:15], s41 offen offset:128 sc1
  buffer_load_dwordx4 v[196:199], v7, s[12:15], s40 offen offset:3072 sc1
  buffer_load_dwordx4 v[212:215], v28, s[12:15], s41 offen offset:192 sc1
  v_mfma_f32_16x16x32_bf16 v[160:163], v[68:71], v[100:103], v[160:163]
  ds_read_b128 v[140:143], v21 offset:40960
  v_mfma_f32_16x16x32_bf16 v[164:167], v[68:71], v[104:107], v[164:167]
  ds_read_b128 v[144:147], v21 offset:43008
  v_mfma_f32_16x16x32_bf16 v[168:171], v[68:71], v[108:111], v[168:171]
  ds_read_b128 v[148:151], v21 offset:45056
  v_mfma_f32_16x16x32_bf16 v[172:175], v[68:71], v[112:115], v[172:175]
  ds_read_b128 v[152:155], v21 offset:47104
  v_mfma_f32_16x16x32_bf16 v[176:179], v[68:71], v[116:119], v[176:179]
  ds_read_b128 v[156:159], v24 offset:5120
  s_waitcnt lgkmcnt(5)
  v_mfma_f32_16x16x32_bf16 v[160:163], v[72:75], v[120:123], v[160:163]
  ds_read_b128 v[100:103], v20 offset:49152
  v_mfma_f32_16x16x32_bf16 v[164:167], v[72:75], v[124:127], v[164:167]
  ds_read_b128 v[104:107], v20 offset:51200
  v_mfma_f32_16x16x32_bf16 v[168:171], v[72:75], v[128:131], v[168:171]
  ds_read_b128 v[108:111], v20 offset:53248
  v_mfma_f32_16x16x32_bf16 v[172:175], v[72:75], v[132:135], v[172:175]
  ds_read_b128 v[112:115], v20 offset:55296
  v_mfma_f32_16x16x32_bf16 v[176:179], v[72:75], v[136:139], v[176:179]
  ds_read_b128 v[116:119], v23 offset:6144
  s_waitcnt lgkmcnt(5)
  v_mfma_f32_16x16x32_bf16 v[160:163], v[76:79], v[140:143], v[160:163]
  ds_read_b128 v[120:123], v21 offset:49152
  v_mfma_f32_16x16x32_bf16 v[164:167], v[76:79], v[144:147], v[164:167]
  ds_read_b128 v[124:127], v21 offset:51200
  v_mfma_f32_16x16x32_bf16 v[168:171], v[76:79], v[148:151], v[168:171]
  ds_read_b128 v[128:131], v21 offset:53248
  v_mfma_f32_16x16x32_bf16 v[172:175], v[76:79], v[152:155], v[172:175]
  ds_read_b128 v[132:135], v21 offset:55296
  v_mfma_f32_16x16x32_bf16 v[176:179], v[76:79], v[156:159], v[176:179]
  ds_read_b128 v[136:139], v24 offset:6144
  s_waitcnt lgkmcnt(5)
  v_mfma_f32_16x16x32_bf16 v[160:163], v[80:83], v[100:103], v[160:163]
  ds_read_b128 v[140:143], v20 offset:57344
  v_mfma_f32_16x16x32_bf16 v[164:167], v[80:83], v[104:107], v[164:167]
  ds_read_b128 v[144:147], v20 offset:59392
  v_mfma_f32_16x16x32_bf16 v[168:171], v[80:83], v[108:111], v[168:171]
  ds_read_b128 v[148:151], v20 offset:61440
  v_mfma_f32_16x16x32_bf16 v[172:175], v[80:83], v[112:115], v[172:175]
  ds_read_b128 v[152:155], v20 offset:63488
  v_mfma_f32_16x16x32_bf16 v[176:179], v[80:83], v[116:119], v[176:179]
  ds_read_b128 v[156:159], v23 offset:7168
  s_waitcnt lgkmcnt(5)
  v_mfma_f32_16x16x32_bf16 v[160:163], v[84:87], v[120:123], v[160:163]
  ds_read_b128 v[100:103], v21 offset:57344
  v_mfma_f32_16x16x32_bf16 v[164:167], v[84:87], v[124:127], v[164:167]
  ds_read_b128 v[104:107], v21 offset:59392
  v_mfma_f32_16x16x32_bf16 v[168:171], v[84:87], v[128:131], v[168:171]
  ds_read_b128 v[108:111], v21 offset:61440
  v_mfma_f32_16x16x32_bf16 v[172:175], v[84:87], v[132:135], v[172:175]
  ds_read_b128 v[112:115], v21 offset:63488
  v_mfma_f32_16x16x32_bf16 v[176:179], v[84:87], v[136:139], v[176:179]
  ds_read_b128 v[116:119], v24 offset:7168
  s_waitcnt lgkmcnt(5)
  v_mfma_f32_16x16x32_bf16 v[160:163], v[88:91], v[140:143], v[160:163]
  ds_read_b128 v[120:123], v22 offset:0
  v_mfma_f32_16x16x32_bf16 v[164:167], v[88:91], v[144:147], v[164:167]
  ds_read_b128 v[124:127], v22 offset:2048
  v_mfma_f32_16x16x32_bf16 v[168:171], v[88:91], v[148:151], v[168:171]
  ds_read_b128 v[128:131], v22 offset:4096
  v_mfma_f32_16x16x32_bf16 v[172:175], v[88:91], v[152:155], v[172:175]
  ds_read_b128 v[132:135], v22 offset:6144
  v_mfma_f32_16x16x32_bf16 v[176:179], v[88:91], v[156:159], v[176:179]
  ds_read_b128 v[136:139], v23 offset:8192
  s_waitcnt lgkmcnt(5)
  v_mfma_f32_16x16x32_bf16 v[160:163], v[92:95], v[100:103], v[160:163]
  v_mfma_f32_16x16x32_bf16 v[164:167], v[92:95], v[104:107], v[164:167]
  v_mfma_f32_16x16x32_bf16 v[168:171], v[92:95], v[108:111], v[168:171]
  v_mfma_f32_16x16x32_bf16 v[172:175], v[92:95], v[112:115], v[172:175]
  v_mfma_f32_16x16x32_bf16 v[176:179], v[92:95], v[116:119], v[176:179]
  s_waitcnt lgkmcnt(0)
  v_mfma_f32_16x16x32_bf16 v[160:163], v[96:99], v[120:123], v[160:163]
  v_mfma_f32_16x16x32_bf16 v[164:167], v[96:99], v[124:127], v[164:167]
  v_mfma_f32_16x16x32_bf16 v[168:171], v[96:99], v[128:131], v[168:171]
  v_mfma_f32_16x16x32_bf16 v[172:175], v[96:99], v[132:135], v[172:175]
  v_mfma_f32_16x16x32_bf16 v[176:179], v[96:99], v[136:139], v[176:179]
  s_waitcnt vmcnt(0)
  v_mfma_f32_16x16x32_bf16 v[216:219], v[200:203], v[184:187], 0
  v_mfma_f32_16x16x32_bf16 v[216:219], v[204:207], v[188:191], v[216:219]
  v_mfma_f32_16x16x32_bf16 v[216:219], v[208:211], v[192:195], v[216:219]
  v_mfma_f32_16x16x32_bf16 v[216:219], v[212:215], v[196:199], v[216:219]
  s_or_b32 s40, s30, s31
  s_cmp_eq_u32 s40, 0
  s_cselect_b32 s40, 0x45000000, 0
  v_mov_b32 v23, s40
  v_cmp_eq_u32 vcc, 0, v9
  s_nop 1
  v_cndmask_b32 v23, 0, v23, vcc
  v_mul_f32 v16, v16, v23
  v_mul_f32 v17, v17, v23
  v_mul_f32 v18, v18, v23
  v_mul_f32 v19, v19, v23
  v_fma_f32 v160, v160, v12, v16
  v_fma_f32 v161, v161, v13, v17
  v_fma_f32 v162, v162, v14, v18
  v_fma_f32 v163, v163, v15, v19
  v_mul_f32 v164, v164, v12
  v_mul_f32 v165, v165, v13
  v_mul_f32 v166, v166, v14
  v_mul_f32 v167, v167, v15
  v_mul_f32 v168, v168, v12
  v_mul_f32 v169, v169, v13
  v_mul_f32 v170, v170, v14
  v_mul_f32 v171, v171, v15
  v_mul_f32 v172, v172, v12
  v_mul_f32 v173, v173, v13
  v_mul_f32 v174, v174, v14
  v_mul_f32 v175, v175, v15
  v_mul_f32 v176, v176, v12
  v_mul_f32 v177, v177, v13
  v_mul_f32 v178, v178, v14
  v_mul_f32 v179, v179, v15
  v_cvt_pk_bf16_f32 v32, v160, v161
  v_cvt_pk_bf16_f32 v33, v162, v163
  v_cvt_pk_bf16_f32 v34, v164, v165
  v_cvt_pk_bf16_f32 v35, v166, v167
  v_cvt_pk_bf16_f32 v36, v168, v169
  v_cvt_pk_bf16_f32 v37, v170, v171
  v_cvt_pk_bf16_f32 v38, v172, v173
  v_cvt_pk_bf16_f32 v39, v174, v175
  v_cvt_pk_bf16_f32 v40, v176, v177
  v_cvt_pk_bf16_f32 v41, v178, v179
  v_permlane16_swap_b32 v32, v34
  v_permlane16_swap_b32 v33, v35
  v_permlane16_swap_b32 v36, v38
  v_permlane16_swap_b32 v37, v39
  v_and_b32 v10, 1, v8
  v_lshlrev_b32 v10, 14, v10
  v_lshrrev_b32 v11, 1, v8
  v_lshl_add_u32 v11, v11, 4, v9
  v_lshl_add_u32 v10, v11, 4, v10
  s_mul_i32 s40, s33, 1179648
  s_mul_i32 s41, s34, 36
  s_lshl_b32 s42, s31, 2
  s_add_u32 s41, s41, s42
  s_lshl_b32 s41, s41, 14
  s_add_u32 s40, s40, s41
  s_lshl_b32 s41, s32, 11
  s_add_u32 s40, s40, s41
  s_lshr_b32 s41, s3, 1
  s_lshl_b32 s41, s41, 10
  s_add_u32 s40, s40, s41
  s_and_b32 s41, s3, 1
  s_lshl_b32 s41, s41, 9
  s_add_u32 s40, s40, s41
  s_add_u32 s40, s40, 2818048
  buffer_store_dwordx4 v[32:35], v10, s[12:15], s40 offen sc1
  s_add_u32 s40, s40, 32768
  buffer_store_dwordx4 v[36:39], v10, s[12:15], s40 offen sc1
  v_lshlrev_b32 v10, 4, v11
  v_and_b32 v11, 1, v8
  v_lshl_add_u32 v10, v11, 3, v10
  s_add_u32 s40, s40, 32768
  buffer_store_dwordx2 v[40:41], v10, s[12:15], s40 offen sc1
  v_lshlrev_b32 v10, 3, v1
  s_lshl_b32 s40, s3, 7
  s_add_u32 s40, s40, 83968
  v_add_u32 v10, s40, v10
  v_cmp_gt_u32 vcc, 16, v1
  s_nop 0
  s_and_saveexec_b64 s[44:45], vcc
  ds_write_b64 v10, v[216:217]
  s_mov_b64 exec, s[44:45]
  s_waitcnt lgkmcnt(0)
  s_barrier
  s_cmp_lg_u32 s3, 0
  s_cbranch_scc1 adaLN_cond__spectral_fnet__mixer_gmlp__prompt_kernel_nocs19
  s_cmp_ge_u32 s2, 112
  s_cbranch_scc1 adaLN_cond__spectral_fnet__mixer_gmlp__prompt_kernel_nocs19
  v_and_b32 v10, 15, v1
  v_lshlrev_b32 v11, 3, v10
  v_add_u32 v11, 83968, v11
  ds_read_b64 v[200:201], v11 offset:0
  ds_read_b64 v[202:203], v11 offset:128
  ds_read_b64 v[204:205], v11 offset:256
  ds_read_b64 v[206:207], v11 offset:384
  s_waitcnt lgkmcnt(0)
  v_add_f32 v200, v200, v202
  v_add_f32 v201, v201, v203
  v_add_f32 v200, v200, v204
  v_add_f32 v201, v201, v205
  v_add_f32 v200, v200, v206
  v_add_f32 v201, v201, v207
  v_lshlrev_b32 v10, 2, v10
  v_mov_b32 v11, 0x40000000
  v_cmp_gt_u32 vcc, 16, v1
  s_nop 1
  v_cndmask_b32 v10, v11, v10, vcc
  s_lshl_b32 s40, s2, 6
  s_add_u32 s40, s40, 16384
  buffer_store_dword v200, v10, s[12:15], s40 offen sc1
  s_add_u32 s40, s40, 7168
  buffer_store_dword v201, v10, s[12:15], s40 offen sc1
adaLN_cond__spectral_fnet__mixer_gmlp__prompt_kernel_nocs19:
p2_end:
  s_load_dwordx2 s[4:5], s[0:1], 24
  s_load_dwordx2 s[6:7], s[0:1], 112
  s_load_dwordx2 s[24:25], s[0:1], 32
  s_load_dwordx2 s[26:27], s[0:1], 0
  v_and_b32 v1, 63, v0
  s_and_b32 s28, s2, 7
  s_lshr_b32 s29, s2, 3
  s_lshr_b32 s30, s28, 1
  s_lshl_b32 s30, s30, 2
  s_lshr_b32 s31, s29, 3
  s_lshl_b32 s43, s31, 1
  s_add_u32 s30, s30, s31
  s_and_b32 s31, s28, 1
  s_lshl_b32 s31, s31, 3
  s_and_b32 s32, s29, 7
  s_add_u32 s43, s43, s32
  s_add_u32 s31, s31, s32
  s_and_b32 s33, s3, 1
  s_lshr_b32 s34, s3, 1
  s_add_u32 s52, s43, 0
  s_and_b32 s52, s52, 7
  s_lshl_b32 s52, s52, 7
  s_add_u32 s53, s43, 1
  s_and_b32 s53, s53, 7
  s_lshl_b32 s53, s53, 7
  s_add_u32 s54, s43, 2
  s_and_b32 s54, s54, 7
  s_lshl_b32 s54, s54, 7
  s_add_u32 s55, s43, 3
  s_and_b32 s55, s55, 7
  s_lshl_b32 s55, s55, 7
  s_add_u32 s56, s43, 4
  s_and_b32 s56, s56, 7
  s_lshl_b32 s56, s56, 7
  s_add_u32 s57, s43, 5
  s_and_b32 s57, s57, 7
  s_lshl_b32 s57, s57, 7
  s_add_u32 s58, s43, 6
  s_and_b32 s58, s58, 7
  s_lshl_b32 s58, s58, 7
  s_add_u32 s59, s43, 7
  s_and_b32 s59, s59, 7
  s_lshl_b32 s59, s59, 7
  v_lshrrev_b32 v224, 4, v1
  v_and_b32 v225, 15, v1
  s_lshl_b32 s35, s30, 1
  s_add_u32 s35, s35, s34
  s_lshl_b32 s35, s35, 5
  s_add_u32 s35, s35, s33
  v_lshl_add_u32 v226, v225, 1, s35
  v_sub_u32 v227, 2048, v226
  v_mov_b32 v235, 1024
  v_cmp_eq_u32 vcc, 0, v226
  s_nop 1
  v_cndmask_b32 v227, v227, v235, vcc
  s_lshl_b32 s36, s31, 6
  v_lshl_add_u32 v228, v224, 4, s36
  v_lshl_add_u32 v229, v226, 10, v228
  v_lshl_add_u32 v230, v227, 10, v228
  v_lshlrev_b32 v231, 1, v228
  v_lshrrev_b32 v2, 3, v1
  v_and_b32 v3, 7, v1
  v_bfe_u32 v4, v2, 1, 1
  v_mov_b32 v243, v4
  s_lshl_b32 s37, s3, 1
  v_add_u32 v4, s37, v4
  v_xor_b32 v5, v3, v4
  v_lshlrev_b32 v5, 4, v5
  v_lshl_add_u32 v5, v2, 10, v5
  v_add_u32 v4, 6, v243
  v_xor_b32 v6, v3, v4
  v_lshlrev_b32 v6, 4, v6
  v_lshl_add_u32 v6, v2, 10, v6
  v_lshlrev_b32 v7, 4, v1
  s_lshl_b32 s38, s31, 15
  s_add_u32 s66, s38, 24576
  s_mov_b32 s67, 89088
  s_lshl_b32 s39, s3, 13
  s_add_u32 s38, s38, s39
  s_lshl_b32 s39, s3, 10
  s_add_u32 s39, s39, 86016
  s_mul_i32 s40, s33, 36
  s_lshl_b32 s41, s30, 1
  s_add_u32 s40, s40, s41
  s_add_u32 s40, s40, s34
  s_lshl_b32 s40, s40, 14
  s_add_u32 s40, s40, 2818048
  s_add_u32 s41, s40, 1179648
  v_lshrrev_b32 v2, 2, v225
  v_and_b32 v3, 3, v225
  v_lshl_add_u32 v2, v2, 3, v3
  v_lshrrev_b32 v3, 1, v225
  v_xor_b32 v3, v3, v224
  v_lshlrev_b32 v3, 4, v3
  v_lshl_add_u32 v232, v2, 7, v3
  v_add_u32 v232, 86016, v232
  v_xor_b32 v233, 64, v232
  s_waitcnt lgkmcnt(0)
  s_mov_b32 s8, s4
  s_mov_b32 s9, s5
  s_mov_b32 s10, 0x80000
  s_mov_b32 s11, 0x20000
  s_mov_b32 s16, s24
  s_mov_b32 s17, s25
  s_mov_b32 s18, 0x80000
  s_mov_b32 s19, 0x20000
  s_mov_b32 s12, s6
  s_mov_b32 s13, s7
  s_mov_b32 s14, 0x2000000
  s_mov_b32 s15, 0x20000
  s_mov_b32 s20, s26
  s_mov_b32 s21, s27
  s_mov_b32 s22, 0x200000
  s_mov_b32 s23, 0x20000
  s_waitcnt vmcnt(0) lgkmcnt(0)
  s_barrier
  s_cmp_lg_u32 s3, 3
  s_cbranch_scc1 adaLN_cond__spectral_fnet__mixer_gmlp__prompt_kernel_join21
  v_mov_b32 v254, s101
  v_mov_b32 v255, 0
  s_lshl_b32 s88, s2, 7
  s_add_u32 s88, s88, 23101440
  s_mov_b64 s[90:91], exec
  s_mov_b64 exec, 1
  buffer_store_dword v254, v255, s[96:99], s88 offen sc1
  s_mov_b64 exec, s[90:91]
  v_and_b32 v250, 63, v0
  v_lshrrev_b32 v251, 3, v250
  v_lshlrev_b32 v251, 1, v251
  v_and_b32 v252, 7, v250
  v_lshl_add_u32 v251, v252, 3, v251
  s_lshr_b32 s88, s30, 1
  s_lshr_b32 s89, s88, 2
  s_and_b32 s88, s88, 3
  s_lshl_b32 s88, s88, 6
  s_add_u32 s88, s88, s89
  v_add_u32 v251, s88, v251
  v_lshlrev_b32 v251, 7, v251
  v_add_u32 v251, 32768, v251
  v_lshlrev_b32 v253, 3, v250
  v_add_u32 v253, -63, v253
  v_lshlrev_b32 v253, 7, v253
  v_add_u32 v253, 32768, v253
  v_cmp_gt_u32 vcc, 32, v250
  s_nop 1
  v_cndmask_b32 v251, v253, v251, vcc
  s_cmp_eq_u32 s30, 0
  s_cselect_b32 s88, 40, 32
  v_mov_b32 v252, 0x40000000
  v_cmp_gt_u32 vcc, s88, v250
  s_nop 1
  v_cndmask_b32 v250, v252, v251, vcc
  s_mov_b32 s88, 23068672
  s_mov_b32 s89, 0x40000
adaLN_cond__spectral_fnet__mixer_gmlp__prompt_kernel_gb22:
  buffer_load_dword v244, v250, s[96:99], s88 offen sc1
  s_waitcnt vmcnt(0)
  v_cmp_le_u32 vcc, 0x40000000, v250
  s_nop 1
  v_cndmask_b32 v244, v244, v254, vcc
  v_xor_b32 v244, v244, v254
  v_cmp_ne_u32 vcc, 0, v244
  s_nop 4
  s_cbranch_vccz adaLN_cond__spectral_fnet__mixer_gmlp__prompt_kernel_gbd23
  s_sub_u32 s89, s89, 1
  s_cmp_lg_u32 s89, 0
  s_cbranch_scc1 adaLN_cond__spectral_fnet__mixer_gmlp__prompt_kernel_gb22
adaLN_cond__spectral_fnet__mixer_gmlp__prompt_kernel_gbd23:
  s_mov_b64 s[90:91], exec
  s_branch adaLN_cond__spectral_fnet__mixer_gmlp__prompt_kernel_join224
adaLN_cond__spectral_fnet__mixer_gmlp__prompt_kernel_join21:
  s_getpc_b64 s[92:93]
adaLN_cond__spectral_fnet__mixer_gmlp__prompt_kernel_ct25:
  s_lshl_b32 s94, s3, 13
  v_and_b32 v244, 63, v0
  v_lshlrev_b32 v244, 7, v244
  v_add_u32 v244, s94, v244
  v_cmp_gt_u32 vcc, code_end-adaLN_cond__spectral_fnet__mixer_gmlp__prompt_kernel_ct25, v244
  s_nop 0
  s_and_saveexec_b64 s[94:95], vcc
  s_cbranch_execz adaLN_cond__spectral_fnet__mixer_gmlp__prompt_kernel_ctn26
  global_load_dword v245, v244, s[92:93]
adaLN_cond__spectral_fnet__mixer_gmlp__prompt_kernel_ctn26:
  s_mov_b64 exec, s[94:95]
  s_add_u32 s42, s38, s52
  s_add_u32 m0, s39, 0
  s_nop 0
  buffer_load_dwordx4 v5, s[8:11], s42 offen lds
  s_add_u32 s42, s38, s52
  s_add_u32 m0, s39, 32768
  s_nop 0
  buffer_load_dwordx4 v5, s[16:19], s42 offen lds
  s_add_u32 s42, s38, s53
  s_add_u32 m0, s39, 4096
  s_nop 0
  buffer_load_dwordx4 v5, s[8:11], s42 offen lds
  s_add_u32 s42, s38, s53
  s_add_u32 m0, s39, 36864
  s_nop 0
  buffer_load_dwordx4 v5, s[16:19], s42 offen lds
  s_add_u32 s42, s38, s54
  s_add_u32 m0, s39, 8192
  s_nop 0
  buffer_load_dwordx4 v5, s[8:11], s42 offen lds
  s_add_u32 s42, s38, s54
  s_add_u32 m0, s39, 40960
  s_nop 0
  buffer_load_dwordx4 v5, s[16:19], s42 offen lds
  s_add_u32 s42, s38, s55
  s_add_u32 m0, s39, 12288
  s_nop 0
  buffer_load_dwordx4 v5, s[8:11], s42 offen lds
  s_add_u32 s42, s38, s55
  s_add_u32 m0, s39, 45056
  s_nop 0
  buffer_load_dwordx4 v5, s[16:19], s42 offen lds
  s_add_u32 s42, s38, s56
  s_add_u32 m0, s39, 16384
  s_nop 0
  buffer_load_dwordx4 v5, s[8:11], s42 offen lds
  s_add_u32 s42, s38, s56
  s_add_u32 m0, s39, 49152
  s_nop 0
  buffer_load_dwordx4 v5, s[16:19], s42 offen lds
  s_add_u32 s42, s38, s57
  s_add_u32 m0, s39, 20480
  s_nop 0
  buffer_load_dwordx4 v5, s[8:11], s42 offen lds
  s_add_u32 s42, s38, s57
  s_add_u32 m0, s39, 53248
  s_nop 0
  buffer_load_dwordx4 v5, s[16:19], s42 offen lds
  s_add_u32 s42, s38, s58
  s_add_u32 m0, s39, 24576
  s_nop 0
  buffer_load_dwordx4 v5, s[8:11], s42 offen lds
  s_add_u32 s42, s38, s58
  s_add_u32 m0, s39, 57344
  s_nop 0
  buffer_load_dwordx4 v5, s[16:19], s42 offen lds
  s_add_u32 s42, s38, s59
  s_add_u32 m0, s39, 28672
  s_nop 0
  buffer_load_dwordx4 v5, s[8:11], s42 offen lds
  s_add_u32 s42, s38, s59
  s_add_u32 m0, s39, 61440
  s_nop 0
  buffer_load_dwordx4 v5, s[16:19], s42 offen lds
  s_cmp_eq_u32 s3, 1
  s_cbranch_scc1 adaLN_cond__spectral_fnet__mixer_gmlp__prompt_kernel_alt28
  s_cmp_eq_u32 s3, 2
  s_cbranch_scc1 adaLN_cond__spectral_fnet__mixer_gmlp__prompt_kernel_alt29
  s_add_u32 s42, s66, s52
  s_add_u32 m0, s67, 0
  s_nop 0
  buffer_load_dwordx4 v6, s[8:11], s42 offen lds
  s_add_u32 s42, s66, s53
  s_add_u32 m0, s67, 36864
  s_nop 0
  buffer_load_dwordx4 v6, s[16:19], s42 offen lds
  s_add_u32 s42, s66, s55
  s_add_u32 m0, s67, 12288
  s_nop 0
  buffer_load_dwordx4 v6, s[8:11], s42 offen lds
  s_add_u32 s42, s66, s56
  s_add_u32 m0, s67, 49152
  s_nop 0
  buffer_load_dwordx4 v6, s[16:19], s42 offen lds
  s_add_u32 s42, s66, s58
  s_add_u32 m0, s67, 24576
  s_nop 0
  buffer_load_dwordx4 v6, s[8:11], s42 offen lds
  s_add_u32 s42, s66, s59
  s_add_u32 m0, s67, 61440
  s_nop 0
  buffer_load_dwordx4 v6, s[16:19], s42 offen lds
  s_branch adaLN_cond__spectral_fnet__mixer_gmlp__prompt_kernel_join2b30
adaLN_cond__spectral_fnet__mixer_gmlp__prompt_kernel_alt28:
  s_add_u32 s42, s66, s52
  s_add_u32 m0, s67, 32768
  s_nop 0
  buffer_load_dwordx4 v6, s[16:19], s42 offen lds
  s_add_u32 s42, s66, s54
  s_add_u32 m0, s67, 8192
  s_nop 0
  buffer_load_dwordx4 v6, s[8:11], s42 offen lds
  s_add_u32 s42, s66, s55
  s_add_u32 m0, s67, 45056
  s_nop 0
  buffer_load_dwordx4 v6, s[16:19], s42 offen lds
  s_add_u32 s42, s66, s57
  s_add_u32 m0, s67, 20480
  s_nop 0
  buffer_load_dwordx4 v6, s[8:11], s42 offen lds
  s_add_u32 s42, s66, s58
  s_add_u32 m0, s67, 57344
  s_nop 0
  buffer_load_dwordx4 v6, s[16:19], s42 offen lds
  s_branch adaLN_cond__spectral_fnet__mixer_gmlp__prompt_kernel_join2b30
adaLN_cond__spectral_fnet__mixer_gmlp__prompt_kernel_alt29:
  s_add_u32 s42, s66, s53
  s_add_u32 m0, s67, 4096
  s_nop 0
  buffer_load_dwordx4 v6, s[8:11], s42 offen lds
  s_add_u32 s42, s66, s54
  s_add_u32 m0, s67, 40960
  s_nop 0
  buffer_load_dwordx4 v6, s[16:19], s42 offen lds
  s_add_u32 s42, s66, s56
  s_add_u32 m0, s67, 16384
  s_nop 0
  buffer_load_dwordx4 v6, s[8:11], s42 offen lds
  s_add_u32 s42, s66, s57
  s_add_u32 m0, s67, 53248
  s_nop 0
  buffer_load_dwordx4 v6, s[16:19], s42 offen lds
  s_add_u32 s42, s66, s59
  s_add_u32 m0, s67, 28672
  s_nop 0
  buffer_load_dwordx4 v6, s[8:11], s42 offen lds
adaLN_cond__spectral_fnet__mixer_gmlp__prompt_kernel_join2b30:
adaLN_cond__spectral_fnet__mixer_gmlp__prompt_kernel_join224:
  s_barrier
  s_cmp_eq_u32 s30, 0
  s_cbranch_scc0 p3_norm
  s_mov_b32 s47, 3342336
  s_lshl_b32 s50, s3, 1
  s_add_u32 s50, s50, 0
  s_add_u32 s50, s50, s43
  s_and_b32 s50, s50, 7
  s_lshl_b32 s50, s50, 11
  s_add_u32 s50, s50, s47
  buffer_load_dwordx4 a[0:3], v7, s[12:15], s50 offen offset:0 sc1
  buffer_load_dwordx4 a[4:7], v7, s[12:15], s50 offen offset:1024 sc1
  s_lshl_b32 s50, s3, 1
  s_add_u32 s50, s50, 1
  s_add_u32 s50, s50, s43
  s_and_b32 s50, s50, 7
  s_lshl_b32 s50, s50, 11
  s_add_u32 s50, s50, s47
  buffer_load_dwordx4 a[8:11], v7, s[12:15], s50 offen offset:0 sc1
  buffer_load_dwordx4 a[12:15], v7, s[12:15], s50 offen offset:1024 sc1
  s_lshl_b32 s48, s52, 4
  s_add_u32 s49, s48, s41
  s_add_u32 s48, s48, s40
  buffer_load_dwordx4 v[32:35], v7, s[12:15], s48 offen offset:0 sc1
  buffer_load_dwordx4 v[96:99], v7, s[12:15], s49 offen offset:0 sc1
  buffer_load_dwordx4 v[36:39], v7, s[12:15], s48 offen offset:1024 sc1
  buffer_load_dwordx4 v[100:103], v7, s[12:15], s49 offen offset:1024 sc1
  s_lshl_b32 s48, s53, 4
  s_add_u32 s49, s48, s41
  s_add_u32 s48, s48, s40
  buffer_load_dwordx4 v[40:43], v7, s[12:15], s48 offen offset:0 sc1
  buffer_load_dwordx4 v[104:107], v7, s[12:15], s49 offen offset:0 sc1
  buffer_load_dwordx4 v[44:47], v7, s[12:15], s48 offen offset:1024 sc1
  buffer_load_dwordx4 v[108:111], v7, s[12:15], s49 offen offset:1024 sc1
  s_lshl_b32 s48, s54, 4
  s_add_u32 s49, s48, s41
  s_add_u32 s48, s48, s40
  buffer_load_dwordx4 v[48:51], v7, s[12:15], s48 offen offset:0 sc1
  buffer_load_dwordx4 v[112:115], v7, s[12:15], s49 offen offset:0 sc1
  buffer_load_dwordx4 v[52:55], v7, s[12:15], s48 offen offset:1024 sc1
  buffer_load_dwordx4 v[116:119], v7, s[12:15], s49 offen offset:1024 sc1
  s_lshl_b32 s48, s55, 4
  s_add_u32 s49, s48, s41
  s_add_u32 s48, s48, s40
  buffer_load_dwordx4 v[56:59], v7, s[12:15], s48 offen offset:0 sc1
  buffer_load_dwordx4 v[120:123], v7, s[12:15], s49 offen offset:0 sc1
  buffer_load_dwordx4 v[60:63], v7, s[12:15], s48 offen offset:1024 sc1
  buffer_load_dwordx4 v[124:127], v7, s[12:15], s49 offen offset:1024 sc1
  s_mov_b32 s37, 4096
  s_mov_b32 s51, 8192
  s_waitcnt vmcnt(20)
  s_barrier
  ds_read_b128 v[160:163], v232 offset:0
  ds_read_b128 v[164:167], v232 offset:512
  ds_read_b128 v[168:171], v232 offset:32768
  ds_read_b128 v[172:175], v232 offset:33280
  ds_read_b128 v[176:179], v233 offset:0
  ds_read_b128 v[180:183], v233 offset:512
  ds_read_b128 v[184:187], v233 offset:32768
  ds_read_b128 v[188:191], v233 offset:33280
  s_waitcnt lgkmcnt(4)
  s_waitcnt vmcnt(12)
  v_mfma_f32_16x16x32_bf16 v[208:211], v[160:163], v[32:35], 0
  s_lshl_b32 s48, s56, 4
  s_add_u32 s49, s48, s41
  s_add_u32 s48, s48, s40
  buffer_load_dwordx4 v[64:67], v7, s[12:15], s48 offen offset:0 sc1
  v_mfma_f32_16x16x32_bf16 v[212:215], v[164:167], v[32:35], 0
  buffer_load_dwordx4 v[128:131], v7, s[12:15], s49 offen offset:0 sc1
  ds_read_b128 v[192:195], v232 offset:4096
  v_mfma_f32_16x16x32_bf16 v[216:219], v[168:171], v[96:99], 0
  buffer_load_dwordx4 v[68:71], v7, s[12:15], s48 offen offset:1024 sc1
  ds_read_b128 v[196:199], v232 offset:4608
  v_mfma_f32_16x16x32_bf16 v[220:223], v[172:175], v[96:99], 0
  buffer_load_dwordx4 v[132:135], v7, s[12:15], s49 offen offset:1024 sc1
  ds_read_b128 v[200:203], v232 offset:36864
  s_cmp_eq_u32 s3, 0
  s_cbranch_scc0 adaLN_cond__spectral_fnet__mixer_gmlp__prompt_kernel_xs32
  v_mfma_f32_16x16x32_bf16 v[244:247], v[160:163], a[0:3], 0
  v_mfma_f32_16x16x32_bf16 v[248:251], v[164:167], a[0:3], 0
adaLN_cond__spectral_fnet__mixer_gmlp__prompt_kernel_xs32:
  s_lshl_b32 s48, s57, 4
  s_add_u32 s49, s48, s41
  s_add_u32 s48, s48, s40
  buffer_load_dwordx4 v[72:75], v7, s[12:15], s48 offen offset:0 sc1
  ds_read_b128 v[204:207], v232 offset:37376
  s_waitcnt lgkmcnt(4)
  v_mfma_f32_16x16x32_bf16 v[208:211], v[176:179], v[36:39], v[208:211]
  buffer_load_dwordx4 v[136:139], v7, s[12:15], s49 offen offset:0 sc1
  v_mfma_f32_16x16x32_bf16 v[212:215], v[180:183], v[36:39], v[212:215]
  buffer_load_dwordx4 v[76:79], v7, s[12:15], s48 offen offset:1024 sc1
  ds_read_b128 v[160:163], v233 offset:4096
  v_mfma_f32_16x16x32_bf16 v[216:219], v[184:187], v[100:103], v[216:219]
  buffer_load_dwordx4 v[140:143], v7, s[12:15], s49 offen offset:1024 sc1
  ds_read_b128 v[164:167], v233 offset:4608
  v_mfma_f32_16x16x32_bf16 v[220:223], v[188:191], v[100:103], v[220:223]
  s_lshl_b32 s48, s58, 4
  s_add_u32 s49, s48, s41
  s_add_u32 s48, s48, s40
  buffer_load_dwordx4 v[80:83], v7, s[12:15], s48 offen offset:0 sc1
  ds_read_b128 v[168:171], v233 offset:36864
  s_cmp_eq_u32 s3, 0
  s_cbranch_scc0 adaLN_cond__spectral_fnet__mixer_gmlp__prompt_kernel_xs33
  v_mfma_f32_16x16x32_bf16 v[244:247], v[176:179], a[4:7], v[244:247]
  v_mfma_f32_16x16x32_bf16 v[248:251], v[180:183], a[4:7], v[248:251]
adaLN_cond__spectral_fnet__mixer_gmlp__prompt_kernel_xs33:
  buffer_load_dwordx4 v[144:147], v7, s[12:15], s49 offen offset:0 sc1
  ds_read_b128 v[172:175], v233 offset:37376
  s_waitcnt lgkmcnt(4)
  s_waitcnt vmcnt(18)
  v_mfma_f32_16x16x32_bf16 v[208:211], v[192:195], v[40:43], v[208:211]
  buffer_load_dwordx4 v[84:87], v7, s[12:15], s48 offen offset:1024 sc1
  v_mfma_f32_16x16x32_bf16 v[212:215], v[196:199], v[40:43], v[212:215]
  buffer_load_dwordx4 v[148:151], v7, s[12:15], s49 offen offset:1024 sc1
  ds_read_b128 v[176:179], v232 offset:8192
  v_mfma_f32_16x16x32_bf16 v[216:219], v[200:203], v[104:107], v[216:219]
  s_lshl_b32 s48, s59, 4
  s_add_u32 s49, s48, s41
  s_add_u32 s48, s48, s40
  buffer_load_dwordx4 v[88:91], v7, s[12:15], s48 offen offset:0 sc1
  ds_read_b128 v[180:183], v232 offset:8704
  v_mfma_f32_16x16x32_bf16 v[220:223], v[204:207], v[104:107], v[220:223]
  buffer_load_dwordx4 v[152:155], v7, s[12:15], s49 offen offset:0 sc1
  ds_read_b128 v[184:187], v232 offset:40960
  s_cmp_eq_u32 s3, 0
  s_cbranch_scc0 adaLN_cond__spectral_fnet__mixer_gmlp__prompt_kernel_xs34
  v_mfma_f32_16x16x32_bf16 v[244:247], v[192:195], a[8:11], v[244:247]
  v_mfma_f32_16x16x32_bf16 v[248:251], v[196:199], a[8:11], v[248:251]
adaLN_cond__spectral_fnet__mixer_gmlp__prompt_kernel_xs34:
  buffer_load_dwordx4 v[92:95], v7, s[12:15], s48 offen offset:1024 sc1
  ds_read_b128 v[188:191], v232 offset:41472
  s_waitcnt lgkmcnt(4)
  v_mfma_f32_16x16x32_bf16 v[208:211], v[160:163], v[44:47], v[208:211]
  buffer_load_dwordx4 v[156:159], v7, s[12:15], s49 offen offset:1024 sc1
  v_mfma_f32_16x16x32_bf16 v[212:215], v[164:167], v[44:47], v[212:215]
  buffer_load_dwordx4 v[8:11], v229, s[20:23], 0 offen
  ds_read_b128 v[192:195], v233 offset:8192
  v_mfma_f32_16x16x32_bf16 v[216:219], v[168:171], v[108:111], v[216:219]
  buffer_load_dwordx4 v[12:15], v230, s[20:23], 0 offen
  ds_read_b128 v[196:199], v233 offset:8704
  v_mfma_f32_16x16x32_bf16 v[220:223], v[172:175], v[108:111], v[220:223]
  buffer_load_dwordx4 v[16:19], v231, s[12:15], s37 offen sc1
  ds_read_b128 v[200:203], v233 offset:40960
  s_cmp_eq_u32 s3, 0
  s_cbranch_scc0 adaLN_cond__spectral_fnet__mixer_gmlp__prompt_kernel_xs35
  v_mfma_f32_16x16x32_bf16 v[244:247], v[160:163], a[12:15], v[244:247]
  v_mfma_f32_16x16x32_bf16 v[248:251], v[164:167], a[12:15], v[248:251]
adaLN_cond__spectral_fnet__mixer_gmlp__prompt_kernel_xs35:
  buffer_load_dwordx4 v[20:23], v231, s[12:15], s37 offen offset:16 sc1
  ds_read_b128 v[204:207], v233 offset:41472
  s_waitcnt lgkmcnt(4)
  s_waitcnt vmcnt(24)
  v_mfma_f32_16x16x32_bf16 v[208:211], v[176:179], v[48:51], v[208:211]
  buffer_load_dwordx4 v[24:27], v231, s[12:15], s51 offen sc1
  v_mfma_f32_16x16x32_bf16 v[212:215], v[180:183], v[48:51], v[212:215]
  buffer_load_dwordx4 v[28:31], v231, s[12:15], s51 offen offset:16 sc1
  ds_read_b128 v[160:163], v232 offset:12288
  v_mfma_f32_16x16x32_bf16 v[216:219], v[184:187], v[112:115], v[216:219]
  ds_read_b128 v[164:167], v232 offset:12800
  v_mfma_f32_16x16x32_bf16 v[220:223], v[188:191], v[112:115], v[220:223]
  ds_read_b128 v[168:171], v232 offset:45056
  s_cmp_eq_u32 s3, 1
  s_cbranch_scc0 adaLN_cond__spectral_fnet__mixer_gmlp__prompt_kernel_xs36
  v_mfma_f32_16x16x32_bf16 v[244:247], v[176:179], a[0:3], 0
  v_mfma_f32_16x16x32_bf16 v[248:251], v[180:183], a[0:3], 0
adaLN_cond__spectral_fnet__mixer_gmlp__prompt_kernel_xs36:
  ds_read_b128 v[172:175], v232 offset:45568
  s_waitcnt lgkmcnt(4)
  v_mfma_f32_16x16x32_bf16 v[208:211], v[192:195], v[52:55], v[208:211]
  v_mfma_f32_16x16x32_bf16 v[212:215], v[196:199], v[52:55], v[212:215]
  ds_read_b128 v[176:179], v233 offset:12288
  v_mfma_f32_16x16x32_bf16 v[216:219], v[200:203], v[116:119], v[216:219]
  ds_read_b128 v[180:183], v233 offset:12800
  v_mfma_f32_16x16x32_bf16 v[220:223], v[204:207], v[116:119], v[220:223]
  ds_read_b128 v[184:187], v233 offset:45056
  s_cmp_eq_u32 s3, 1
  s_cbranch_scc0 adaLN_cond__spectral_fnet__mixer_gmlp__prompt_kernel_xs37
  v_mfma_f32_16x16x32_bf16 v[244:247], v[192:195], a[4:7], v[244:247]
  v_mfma_f32_16x16x32_bf16 v[248:251], v[196:199], a[4:7], v[248:251]
adaLN_cond__spectral_fnet__mixer_gmlp__prompt_kernel_xs37:
  ds_read_b128 v[188:191], v233 offset:45568
  s_waitcnt lgkmcnt(4)
  s_waitcnt vmcnt(22)
  v_mfma_f32_16x16x32_bf16 v[208:211], v[160:163], v[56:59], v[208:211]
  v_mfma_f32_16x16x32_bf16 v[212:215], v[164:167], v[56:59], v[212:215]
  ds_read_b128 v[192:195], v232 offset:16384
  v_mfma_f32_16x16x32_bf16 v[216:219], v[168:171], v[120:123], v[216:219]
  ds_read_b128 v[196:199], v232 offset:16896
  v_mfma_f32_16x16x32_bf16 v[220:223], v[172:175], v[120:123], v[220:223]
  ds_read_b128 v[200:203], v232 offset:49152
  s_cmp_eq_u32 s3, 1
  s_cbranch_scc0 adaLN_cond__spectral_fnet__mixer_gmlp__prompt_kernel_xs38
  v_mfma_f32_16x16x32_bf16 v[244:247], v[160:163], a[8:11], v[244:247]
  v_mfma_f32_16x16x32_bf16 v[248:251], v[164:167], a[8:11], v[248:251]
adaLN_cond__spectral_fnet__mixer_gmlp__prompt_kernel_xs38:
  ds_read_b128 v[204:207], v232 offset:49664
  s_waitcnt lgkmcnt(4)
  v_mfma_f32_16x16x32_bf16 v[208:211], v[176:179], v[60:63], v[208:211]
  v_mfma_f32_16x16x32_bf16 v[212:215], v[180:183], v[60:63], v[212:215]
  ds_read_b128 v[160:163], v233 offset:16384
  v_mfma_f32_16x16x32_bf16 v[216:219], v[184:187], v[124:127], v[216:219]
  ds_read_b128 v[164:167], v233 offset:16896
  v_mfma_f32_16x16x32_bf16 v[220:223], v[188:191], v[124:127], v[220:223]
  ds_read_b128 v[168:171], v233 offset:49152
  s_cmp_eq_u32 s3, 1
  s_cbranch_scc0 adaLN_cond__spectral_fnet__mixer_gmlp__prompt_kernel_xs39
  v_mfma_f32_16x16x32_bf16 v[244:247], v[176:179], a[12:15], v[244:247]
  v_mfma_f32_16x16x32_bf16 v[248:251], v[180:183], a[12:15], v[248:251]
adaLN_cond__spectral_fnet__mixer_gmlp__prompt_kernel_xs39:
  ds_read_b128 v[172:175], v233 offset:49664
  s_waitcnt lgkmcnt(4)
  s_waitcnt vmcnt(18)
  v_mfma_f32_16x16x32_bf16 v[208:211], v[192:195], v[64:67], v[208:211]
  v_mfma_f32_16x16x32_bf16 v[212:215], v[196:199], v[64:67], v[212:215]
  ds_read_b128 v[176:179], v232 offset:20480
  v_mfma_f32_16x16x32_bf16 v[216:219], v[200:203], v[128:131], v[216:219]
  ds_read_b128 v[180:183], v232 offset:20992
  v_mfma_f32_16x16x32_bf16 v[220:223], v[204:207], v[128:131], v[220:223]
  ds_read_b128 v[184:187], v232 offset:53248
  s_cmp_eq_u32 s3, 2
  s_cbranch_scc0 adaLN_cond__spectral_fnet__mixer_gmlp__prompt_kernel_xs40
  v_mfma_f32_16x16x32_bf16 v[244:247], v[192:195], a[0:3], 0
  v_mfma_f32_16x16x32_bf16 v[248:251], v[196:199], a[0:3], 0
adaLN_cond__spectral_fnet__mixer_gmlp__prompt_kernel_xs40:
  ds_read_b128 v[188:191], v232 offset:53760
  s_waitcnt lgkmcnt(4)
  v_mfma_f32_16x16x32_bf16 v[208:211], v[160:163], v[68:71], v[208:211]
  v_mfma_f32_16x16x32_bf16 v[212:215], v[164:167], v[68:71], v[212:215]
  ds_read_b128 v[192:195], v233 offset:20480
  v_mfma_f32_16x16x32_bf16 v[216:219], v[168:171], v[132:135], v[216:219]
  ds_read_b128 v[196:199], v233 offset:20992
  v_mfma_f32_16x16x32_bf16 v[220:223], v[172:175], v[132:135], v[220:223]
  ds_read_b128 v[200:203], v233 offset:53248
  s_cmp_eq_u32 s3, 2
  s_cbranch_scc0 adaLN_cond__spectral_fnet__mixer_gmlp__prompt_kernel_xs41
  v_mfma_f32_16x16x32_bf16 v[244:247], v[160:163], a[4:7], v[244:247]
  v_mfma_f32_16x16x32_bf16 v[248:251], v[164:167], a[4:7], v[248:251]
adaLN_cond__spectral_fnet__mixer_gmlp__prompt_kernel_xs41:
  ds_read_b128 v[204:207], v233 offset:53760
  s_waitcnt lgkmcnt(4)
  s_waitcnt vmcnt(14)
  v_mfma_f32_16x16x32_bf16 v[208:211], v[176:179], v[72:75], v[208:211]
  v_mfma_f32_16x16x32_bf16 v[212:215], v[180:183], v[72:75], v[212:215]
  ds_read_b128 v[160:163], v232 offset:24576
  v_mfma_f32_16x16x32_bf16 v[216:219], v[184:187], v[136:139], v[216:219]
  ds_read_b128 v[164:167], v232 offset:25088
  v_mfma_f32_16x16x32_bf16 v[220:223], v[188:191], v[136:139], v[220:223]
  ds_read_b128 v[168:171], v232 offset:57344
  s_cmp_eq_u32 s3, 2
  s_cbranch_scc0 adaLN_cond__spectral_fnet__mixer_gmlp__prompt_kernel_xs42
  v_mfma_f32_16x16x32_bf16 v[244:247], v[176:179], a[8:11], v[244:247]
  v_mfma_f32_16x16x32_bf16 v[248:251], v[180:183], a[8:11], v[248:251]
adaLN_cond__spectral_fnet__mixer_gmlp__prompt_kernel_xs42:
  ds_read_b128 v[172:175], v232 offset:57856
  s_waitcnt lgkmcnt(4)
  v_mfma_f32_16x16x32_bf16 v[208:211], v[192:195], v[76:79], v[208:211]
  v_mfma_f32_16x16x32_bf16 v[212:215], v[196:199], v[76:79], v[212:215]
  ds_read_b128 v[176:179], v233 offset:24576
  v_mfma_f32_16x16x32_bf16 v[216:219], v[200:203], v[140:143], v[216:219]
  ds_read_b128 v[180:183], v233 offset:25088
  v_mfma_f32_16x16x32_bf16 v[220:223], v[204:207], v[140:143], v[220:223]
  ds_read_b128 v[184:187], v233 offset:57344
  s_cmp_eq_u32 s3, 2
  s_cbranch_scc0 adaLN_cond__spectral_fnet__mixer_gmlp__prompt_kernel_xs43
  v_mfma_f32_16x16x32_bf16 v[244:247], v[192:195], a[12:15], v[244:247]
  v_mfma_f32_16x16x32_bf16 v[248:251], v[196:199], a[12:15], v[248:251]
adaLN_cond__spectral_fnet__mixer_gmlp__prompt_kernel_xs43:
  ds_read_b128 v[188:191], v233 offset:57856
  s_waitcnt lgkmcnt(4)
  s_waitcnt vmcnt(10)
  v_mfma_f32_16x16x32_bf16 v[208:211], v[160:163], v[80:83], v[208:211]
  v_mfma_f32_16x16x32_bf16 v[212:215], v[164:167], v[80:83], v[212:215]
  ds_read_b128 v[192:195], v232 offset:28672
  v_mfma_f32_16x16x32_bf16 v[216:219], v[168:171], v[144:147], v[216:219]
  ds_read_b128 v[196:199], v232 offset:29184
  v_mfma_f32_16x16x32_bf16 v[220:223], v[172:175], v[144:147], v[220:223]
  ds_read_b128 v[200:203], v232 offset:61440
  s_cmp_eq_u32 s3, 3
  s_cbranch_scc0 adaLN_cond__spectral_fnet__mixer_gmlp__prompt_kernel_xs44
  v_mfma_f32_16x16x32_bf16 v[244:247], v[160:163], a[0:3], 0
  v_mfma_f32_16x16x32_bf16 v[248:251], v[164:167], a[0:3], 0
adaLN_cond__spectral_fnet__mixer_gmlp__prompt_kernel_xs44:
  ds_read_b128 v[204:207], v232 offset:61952
  s_waitcnt lgkmcnt(4)
  v_mfma_f32_16x16x32_bf16 v[208:211], v[176:179], v[84:87], v[208:211]
  v_mfma_f32_16x16x32_bf16 v[212:215], v[180:183], v[84:87], v[212:215]
  ds_read_b128 v[160:163], v233 offset:28672
  v_mfma_f32_16x16x32_bf16 v[216:219], v[184:187], v[148:151], v[216:219]
  ds_read_b128 v[164:167], v233 offset:29184
  v_mfma_f32_16x16x32_bf16 v[220:223], v[188:191], v[148:151], v[220:223]
  ds_read_b128 v[168:171], v233 offset:61440
  s_cmp_eq_u32 s3, 3
  s_cbranch_scc0 adaLN_cond__spectral_fnet__mixer_gmlp__prompt_kernel_xs45
  v_mfma_f32_16x16x32_bf16 v[244:247], v[176:179], a[4:7], v[244:247]
  v_mfma_f32_16x16x32_bf16 v[248:251], v[180:183], a[4:7], v[248:251]
adaLN_cond__spectral_fnet__mixer_gmlp__prompt_kernel_xs45:
  ds_read_b128 v[172:175], v233 offset:61952
  s_waitcnt lgkmcnt(4)
  s_waitcnt vmcnt(6)
  v_mfma_f32_16x16x32_bf16 v[208:211], v[192:195], v[88:91], v[208:211]
  v_mfma_f32_16x16x32_bf16 v[212:215], v[196:199], v[88:91], v[212:215]
  v_mfma_f32_16x16x32_bf16 v[216:219], v[200:203], v[152:155], v[216:219]
  v_mfma_f32_16x16x32_bf16 v[220:223], v[204:207], v[152:155], v[220:223]
  s_cmp_eq_u32 s3, 3
  s_cbranch_scc0 adaLN_cond__spectral_fnet__mixer_gmlp__prompt_kernel_xs46
  v_mfma_f32_16x16x32_bf16 v[244:247], v[192:195], a[8:11], v[244:247]
  v_mfma_f32_16x16x32_bf16 v[248:251], v[196:199], a[8:11], v[248:251]
adaLN_cond__spectral_fnet__mixer_gmlp__prompt_kernel_xs46:
  s_waitcnt lgkmcnt(0)
  v_mfma_f32_16x16x32_bf16 v[208:211], v[160:163], v[92:95], v[208:211]
  v_mfma_f32_16x16x32_bf16 v[212:215], v[164:167], v[92:95], v[212:215]
  v_mfma_f32_16x16x32_bf16 v[216:219], v[168:171], v[156:159], v[216:219]
  v_mfma_f32_16x16x32_bf16 v[220:223], v[172:175], v[156:159], v[220:223]
  s_cmp_eq_u32 s3, 3
  s_cbranch_scc0 adaLN_cond__spectral_fnet__mixer_gmlp__prompt_kernel_xs47
  v_mfma_f32_16x16x32_bf16 v[244:247], v[160:163], a[12:15], v[244:247]
  v_mfma_f32_16x16x32_bf16 v[248:251], v[164:167], a[12:15], v[248:251]
adaLN_cond__spectral_fnet__mixer_gmlp__prompt_kernel_xs47:
  s_nop 7
  v_lshlrev_b32 v91, 5, v224
  s_lshl_b32 s47, s3, 7
  s_add_u32 s47, s47, 84992
  v_add_u32 v91, s47, v91
  v_cmp_eq_u32 vcc, 0, v225
  s_nop 0
  s_and_saveexec_b64 s[48:49], vcc
  ds_write_b128 v91, v[244:247]
  ds_write_b128 v91, v[248:251] offset:16
  s_mov_b64 exec, s[48:49]
  s_waitcnt vmcnt(0)
  v_sub_f32 v32, v208, v216
  v_add_f32 v40, v208, v216
  v_sub_f32 v33, v209, v217
  v_add_f32 v41, v209, v217
  v_sub_f32 v34, v210, v218
  v_add_f32 v42, v210, v218
  v_sub_f32 v35, v211, v219
  v_add_f32 v43, v211, v219
  v_sub_f32 v36, v212, v220
  v_add_f32 v44, v212, v220
  v_sub_f32 v37, v213, v221
  v_add_f32 v45, v213, v221
  v_sub_f32 v38, v214, v222
  v_add_f32 v46, v214, v222
  v_sub_f32 v39, v215, v223
  v_add_f32 v47, v215, v223
  s_lshl_b32 s47, s3, 12
  v_lshlrev_b32 v92, 6, v225
  v_lshl_add_u32 v92, v224, 4, v92
  v_add_u32 v92, s47, v92
  v_lshlrev_b32 v93, 4, v1
  v_add_u32 v93, s47, v93
  v_lshrrev_b32 v94, 2, v1
  v_lshl_add_u32 v94, v94, 1, s35
  v_sub_u32 v95, 2048, v94
  v_mov_b32 v234, 1024
  v_cmp_eq_u32 vcc, 0, v94
  s_nop 1
  v_cndmask_b32 v95, v95, v234, vcc
  v_and_b32 v234, 3, v1
  v_lshl_add_u32 v234, v234, 4, s36
  v_lshl_add_u32 v94, v94, 10, v234
  v_lshl_add_u32 v95, v95, 10, v234
  v_mov_b32 v234, 0x40000000
  s_mov_b32 s44, 5177344
  s_mov_b32 s45, 7340032
  s_lshl_b32 s46, s31, 14
  s_lshl_b32 s47, s30, 9
  s_add_u32 s46, s46, s47
  s_lshl_b32 s47, s3, 7
  s_add_u32 s46, s46, s47
  s_add_u32 s46, s46, 294912
  v_lshlrev_b32 v88, 3, v225
  v_add_u32 v89, 8192, v88
  v_cmp_eq_u32 vcc, 0, v224
  s_nop 1
  v_cndmask_b32 v88, v234, v88, vcc
  v_cndmask_b32 v89, v234, v89, vcc
  v_lshlrev_b32 v48, 16, v8
  v_and_b32 v49, 0xffff0000, v8
  v_lshlrev_b32 v50, 16, v9
  v_and_b32 v51, 0xffff0000, v9
  v_lshlrev_b32 v52, 16, v10
  v_and_b32 v53, 0xffff0000, v10
  v_lshlrev_b32 v54, 16, v11
  v_and_b32 v55, 0xffff0000, v11
  v_fmac_f32 v48, v16, v32
  v_fmac_f32 v49, v17, v33
  v_fmac_f32 v50, v18, v34
  v_fmac_f32 v51, v19, v35
  v_fmac_f32 v52, v20, v36
  v_fmac_f32 v53, v21, v37
  v_fmac_f32 v54, v22, v38
  v_fmac_f32 v55, v23, v39
  v_cvt_pk_bf16_f32 v64, v48, v49
  v_cvt_pk_bf16_f32 v65, v50, v51
  v_cvt_pk_bf16_f32 v66, v52, v53
  v_cvt_pk_bf16_f32 v67, v54, v55
  ds_write_b128 v92, v[64:67] offset:0
  v_lshlrev_b32 v48, 16, v64
  v_and_b32 v49, 0xffff0000, v64
  v_lshlrev_b32 v50, 16, v65
  v_and_b32 v51, 0xffff0000, v65
  v_lshlrev_b32 v52, 16, v66
  v_and_b32 v53, 0xffff0000, v66
  v_lshlrev_b32 v54, 16, v67
  v_and_b32 v55, 0xffff0000, v67
  v_mul_f32 v32, v48, v24
  v_mul_f32 v33, v49, v25
  v_mul_f32 v34, v50, v26
  v_mul_f32 v35, v51, v27
  v_mul_f32 v36, v52, v28
  v_mul_f32 v37, v53, v29
  v_mul_f32 v38, v54, v30
  v_mul_f32 v39, v55, v31
  v_cvt_pk_bf16_f32 v68, v32, v33
  v_cvt_pk_bf16_f32 v69, v34, v35
  v_cvt_pk_bf16_f32 v70, v36, v37
  v_cvt_pk_bf16_f32 v71, v38, v39
  ds_write_b128 v92, v[68:71] offset:1024
  v_add_f32 v80, v48, v49
  v_mul_f32 v81, v48, v48
  v_fmac_f32 v81, v49, v49
  v_add_f32 v80, v80, v50
  v_fmac_f32 v81, v50, v50
  v_add_f32 v80, v80, v51
  v_fmac_f32 v81, v51, v51
  v_add_f32 v80, v80, v52
  v_fmac_f32 v81, v52, v52
  v_add_f32 v80, v80, v53
  v_fmac_f32 v81, v53, v53
  v_add_f32 v80, v80, v54
  v_fmac_f32 v81, v54, v54
  v_add_f32 v80, v80, v55
  v_fmac_f32 v81, v55, v55
  s_waitcnt lgkmcnt(0)
  ds_read_b128 v[64:67], v93 offset:0
  ds_read_b128 v[68:71], v93 offset:1024
  v_mov_b32 v84, v80
  v_mov_b32 v85, v81
  s_nop 0
  v_permlane16_swap_b32 v80, v84
  v_permlane16_swap_b32 v81, v85
  v_add_f32 v80, v80, v84
  v_add_f32 v81, v81, v85
  v_mov_b32 v84, v80
  v_mov_b32 v85, v81
  s_nop 0
  v_permlane32_swap_b32 v80, v84
  v_permlane32_swap_b32 v81, v85
  v_add_f32 v80, v80, v84
  v_add_f32 v81, v81, v85
  buffer_store_dwordx2 v[80:81], v88, s[12:15], s46 offen sc1
  s_waitcnt lgkmcnt(0)
  buffer_store_dwordx4 v[64:67], v94, s[12:15], s44 offen sc1
  buffer_store_dwordx4 v[68:71], v94, s[12:15], s45 offen sc1
  s_waitcnt lgkmcnt(0)
  s_barrier
  v_lshlrev_b32 v91, 5, v224
  v_add_u32 v91, 84992, v91
  ds_read_b128 v[96:99], v91 offset:0
  ds_read_b128 v[100:103], v91 offset:16
  ds_read_b128 v[104:107], v91 offset:128
  ds_read_b128 v[108:111], v91 offset:144
  ds_read_b128 v[112:115], v91 offset:256
  ds_read_b128 v[116:119], v91 offset:272
  ds_read_b128 v[120:123], v91 offset:384
  ds_read_b128 v[124:127], v91 offset:400
  s_waitcnt lgkmcnt(0)
  v_cmp_eq_u32 vcc, 0, v226
  v_add_f32 v96, v96, v104
  v_add_f32 v112, v112, v120
  v_add_f32 v97, v97, v105
  v_add_f32 v113, v113, v121
  v_add_f32 v98, v98, v106
  v_add_f32 v114, v114, v122
  v_add_f32 v99, v99, v107
  v_add_f32 v115, v115, v123
  v_add_f32 v100, v100, v108
  v_add_f32 v116, v116, v124
  v_add_f32 v101, v101, v109
  v_add_f32 v117, v117, v125
  v_add_f32 v102, v102, v110
  v_add_f32 v118, v118, v126
  v_add_f32 v103, v103, v111
  v_add_f32 v119, v119, v127
  v_add_f32 v96, v96, v112
  v_add_f32 v97, v97, v113
  v_add_f32 v98, v98, v114
  v_add_f32 v99, v99, v115
  v_add_f32 v100, v100, v116
  v_add_f32 v101, v101, v117
  v_add_f32 v102, v102, v118
  v_add_f32 v103, v103, v119
  v_cndmask_b32 v40, v40, v96, vcc
  v_cndmask_b32 v41, v41, v97, vcc
  v_cndmask_b32 v42, v42, v98, vcc
  v_cndmask_b32 v43, v43, v99, vcc
  v_cndmask_b32 v44, v44, v100, vcc
  v_cndmask_b32 v45, v45, v101, vcc
  v_cndmask_b32 v46, v46, v102, vcc
  v_cndmask_b32 v47, v47, v103, vcc
  v_lshlrev_b32 v48, 16, v12
  v_and_b32 v49, 0xffff0000, v12
  v_lshlrev_b32 v50, 16, v13
  v_and_b32 v51, 0xffff0000, v13
  v_lshlrev_b32 v52, 16, v14
  v_and_b32 v53, 0xffff0000, v14
  v_lshlrev_b32 v54, 16, v15
  v_and_b32 v55, 0xffff0000, v15
  v_fmac_f32 v48, v16, v40
  v_fmac_f32 v49, v17, v41
  v_fmac_f32 v50, v18, v42
  v_fmac_f32 v51, v19, v43
  v_fmac_f32 v52, v20, v44
  v_fmac_f32 v53, v21, v45
  v_fmac_f32 v54, v22, v46
  v_fmac_f32 v55, v23, v47
  v_cvt_pk_bf16_f32 v72, v48, v49
  v_cvt_pk_bf16_f32 v73, v50, v51
  v_cvt_pk_bf16_f32 v74, v52, v53
  v_cvt_pk_bf16_f32 v75, v54, v55
  ds_write_b128 v92, v[72:75] offset:2048
  v_lshlrev_b32 v48, 16, v72
  v_and_b32 v49, 0xffff0000, v72
  v_lshlrev_b32 v50, 16, v73
  v_and_b32 v51, 0xffff0000, v73
  v_lshlrev_b32 v52, 16, v74
  v_and_b32 v53, 0xffff0000, v74
  v_lshlrev_b32 v54, 16, v75
  v_and_b32 v55, 0xffff0000, v75
  v_mul_f32 v40, v48, v24
  v_mul_f32 v41, v49, v25
  v_mul_f32 v42, v50, v26
  v_mul_f32 v43, v51, v27
  v_mul_f32 v44, v52, v28
  v_mul_f32 v45, v53, v29
  v_mul_f32 v46, v54, v30
  v_mul_f32 v47, v55, v31
  v_cvt_pk_bf16_f32 v76, v40, v41
  v_cvt_pk_bf16_f32 v77, v42, v43
  v_cvt_pk_bf16_f32 v78, v44, v45
  v_cvt_pk_bf16_f32 v79, v46, v47
  ds_write_b128 v92, v[76:79] offset:3072
  v_add_f32 v82, v48, v49
  v_mul_f32 v83, v48, v48
  v_fmac_f32 v83, v49, v49
  v_add_f32 v82, v82, v50
  v_fmac_f32 v83, v50, v50
  v_add_f32 v82, v82, v51
  v_fmac_f32 v83, v51, v51
  v_add_f32 v82, v82, v52
  v_fmac_f32 v83, v52, v52
  v_add_f32 v82, v82, v53
  v_fmac_f32 v83, v53, v53
  v_add_f32 v82, v82, v54
  v_fmac_f32 v83, v54, v54
  v_add_f32 v82, v82, v55
  v_fmac_f32 v83, v55, v55
  s_waitcnt lgkmcnt(0)
  ds_read_b128 v[72:75], v93 offset:2048
  ds_read_b128 v[76:79], v93 offset:3072
  v_mov_b32 v84, v82
  v_mov_b32 v85, v83
  s_nop 0
  v_permlane16_swap_b32 v82, v84
  v_permlane16_swap_b32 v83, v85
  v_add_f32 v82, v82, v84
  v_add_f32 v83, v83, v85
  v_mov_b32 v84, v82
  v_mov_b32 v85, v83
  s_nop 0
  v_permlane32_swap_b32 v82, v84
  v_permlane32_swap_b32 v83, v85
  v_add_f32 v82, v82, v84
  v_add_f32 v83, v83, v85
  buffer_store_dwordx2 v[82:83], v89, s[12:15], s46 offen sc1
  s_waitcnt lgkmcnt(0)
  buffer_store_dwordx4 v[72:75], v95, s[12:15], s44 offen sc1
  buffer_store_dwordx4 v[76:79], v95, s[12:15], s45 offen sc1
  s_branch p3_end
p3_norm:
  s_lshl_b32 s48, s52, 4
  s_add_u32 s49, s48, s41
  s_add_u32 s48, s48, s40
  buffer_load_dwordx4 v[32:35], v7, s[12:15], s48 offen offset:0 sc1
  buffer_load_dwordx4 v[96:99], v7, s[12:15], s49 offen offset:0 sc1
  buffer_load_dwordx4 v[36:39], v7, s[12:15], s48 offen offset:1024 sc1
  buffer_load_dwordx4 v[100:103], v7, s[12:15], s49 offen offset:1024 sc1
  s_lshl_b32 s48, s53, 4
  s_add_u32 s49, s48, s41
  s_add_u32 s48, s48, s40
  buffer_load_dwordx4 v[40:43], v7, s[12:15], s48 offen offset:0 sc1
  buffer_load_dwordx4 v[104:107], v7, s[12:15], s49 offen offset:0 sc1
  buffer_load_dwordx4 v[44:47], v7, s[12:15], s48 offen offset:1024 sc1
  buffer_load_dwordx4 v[108:111], v7, s[12:15], s49 offen offset:1024 sc1
  s_lshl_b32 s48, s54, 4
  s_add_u32 s49, s48, s41
  s_add_u32 s48, s48, s40
  buffer_load_dwordx4 v[48:51], v7, s[12:15], s48 offen offset:0 sc1
  buffer_load_dwordx4 v[112:115], v7, s[12:15], s49 offen offset:0 sc1
  buffer_load_dwordx4 v[52:55], v7, s[12:15], s48 offen offset:1024 sc1
  buffer_load_dwordx4 v[116:119], v7, s[12:15], s49 offen offset:1024 sc1
  s_lshl_b32 s48, s55, 4
  s_add_u32 s49, s48, s41
  s_add_u32 s48, s48, s40
  buffer_load_dwordx4 v[56:59], v7, s[12:15], s48 offen offset:0 sc1
  buffer_load_dwordx4 v[120:123], v7, s[12:15], s49 offen offset:0 sc1
  buffer_load_dwordx4 v[60:63], v7, s[12:15], s48 offen offset:1024 sc1
  buffer_load_dwordx4 v[124:127], v7, s[12:15], s49 offen offset:1024 sc1
  s_mov_b32 s37, 4096
  s_mov_b32 s51, 8192
  s_waitcnt vmcnt(16)
  s_barrier
  ds_read_b128 v[160:163], v232 offset:0
  ds_read_b128 v[164:167], v232 offset:512
  ds_read_b128 v[168:171], v232 offset:32768
  ds_read_b128 v[172:175], v232 offset:33280
  ds_read_b128 v[176:179], v233 offset:0
  ds_read_b128 v[180:183], v233 offset:512
  ds_read_b128 v[184:187], v233 offset:32768
  ds_read_b128 v[188:191], v233 offset:33280
  s_waitcnt lgkmcnt(4)
  s_waitcnt vmcnt(12)
  v_mfma_f32_16x16x32_bf16 v[208:211], v[160:163], v[32:35], 0
  s_lshl_b32 s48, s56, 4
  s_add_u32 s49, s48, s41
  s_add_u32 s48, s48, s40
  buffer_load_dwordx4 v[64:67], v7, s[12:15], s48 offen offset:0 sc1
  ds_read_b128 v[192:195], v232 offset:4096
  v_mfma_f32_16x16x32_bf16 v[212:215], v[164:167], v[32:35], 0
  buffer_load_dwordx4 v[128:131], v7, s[12:15], s49 offen offset:0 sc1
  ds_read_b128 v[196:199], v232 offset:4608
  v_mfma_f32_16x16x32_bf16 v[216:219], v[168:171], v[96:99], 0
  buffer_load_dwordx4 v[68:71], v7, s[12:15], s48 offen offset:1024 sc1
  ds_read_b128 v[200:203], v232 offset:36864
  v_mfma_f32_16x16x32_bf16 v[220:223], v[172:175], v[96:99], 0
  buffer_load_dwordx4 v[132:135], v7, s[12:15], s49 offen offset:1024 sc1
  ds_read_b128 v[204:207], v232 offset:37376
  s_waitcnt lgkmcnt(4)
  v_mfma_f32_16x16x32_bf16 v[208:211], v[176:179], v[36:39], v[208:211]
  s_lshl_b32 s48, s57, 4
  s_add_u32 s49, s48, s41
  s_add_u32 s48, s48, s40
  buffer_load_dwordx4 v[72:75], v7, s[12:15], s48 offen offset:0 sc1
  ds_read_b128 v[160:163], v233 offset:4096
  v_mfma_f32_16x16x32_bf16 v[212:215], v[180:183], v[36:39], v[212:215]
  buffer_load_dwordx4 v[136:139], v7, s[12:15], s49 offen offset:0 sc1
  ds_read_b128 v[164:167], v233 offset:4608
  v_mfma_f32_16x16x32_bf16 v[216:219], v[184:187], v[100:103], v[216:219]
  buffer_load_dwordx4 v[76:79], v7, s[12:15], s48 offen offset:1024 sc1
  ds_read_b128 v[168:171], v233 offset:36864
  v_mfma_f32_16x16x32_bf16 v[220:223], v[188:191], v[100:103], v[220:223]
  buffer_load_dwordx4 v[140:143], v7, s[12:15], s49 offen offset:1024 sc1
  ds_read_b128 v[172:175], v233 offset:37376
  s_waitcnt lgkmcnt(4)
  s_waitcnt vmcnt(16)
  v_mfma_f32_16x16x32_bf16 v[208:211], v[192:195], v[40:43], v[208:211]
  s_lshl_b32 s48, s58, 4
  s_add_u32 s49, s48, s41
  s_add_u32 s48, s48, s40
  buffer_load_dwordx4 v[80:83], v7, s[12:15], s48 offen offset:0 sc1
  ds_read_b128 v[176:179], v232 offset:8192
  v_mfma_f32_16x16x32_bf16 v[212:215], v[196:199], v[40:43], v[212:215]
  buffer_load_dwordx4 v[144:147], v7, s[12:15], s49 offen offset:0 sc1
  ds_read_b128 v[180:183], v232 offset:8704
  v_mfma_f32_16x16x32_bf16 v[216:219], v[200:203], v[104:107], v[216:219]
  buffer_load_dwordx4 v[84:87], v7, s[12:15], s48 offen offset:1024 sc1
  ds_read_b128 v[184:187], v232 offset:40960
  v_mfma_f32_16x16x32_bf16 v[220:223], v[204:207], v[104:107], v[220:223]
  buffer_load_dwordx4 v[148:151], v7, s[12:15], s49 offen offset:1024 sc1
  ds_read_b128 v[188:191], v232 offset:41472
  s_waitcnt lgkmcnt(4)
  v_mfma_f32_16x16x32_bf16 v[208:211], v[160:163], v[44:47], v[208:211]
  s_lshl_b32 s48, s59, 4
  s_add_u32 s49, s48, s41
  s_add_u32 s48, s48, s40
  buffer_load_dwordx4 v[88:91], v7, s[12:15], s48 offen offset:0 sc1
  ds_read_b128 v[192:195], v233 offset:8192
  v_mfma_f32_16x16x32_bf16 v[212:215], v[164:167], v[44:47], v[212:215]
  buffer_load_dwordx4 v[152:155], v7, s[12:15], s49 offen offset:0 sc1
  ds_read_b128 v[196:199], v233 offset:8704
  v_mfma_f32_16x16x32_bf16 v[216:219], v[168:171], v[108:111], v[216:219]
  buffer_load_dwordx4 v[92:95], v7, s[12:15], s48 offen offset:1024 sc1
  ds_read_b128 v[200:203], v233 offset:40960
  v_mfma_f32_16x16x32_bf16 v[220:223], v[172:175], v[108:111], v[220:223]
  buffer_load_dwordx4 v[156:159], v7, s[12:15], s49 offen offset:1024 sc1
  ds_read_b128 v[204:207], v233 offset:41472
  s_waitcnt lgkmcnt(4)
  s_waitcnt vmcnt(20)
  v_mfma_f32_16x16x32_bf16 v[208:211], v[176:179], v[48:51], v[208:211]
  buffer_load_dwordx4 v[8:11], v229, s[20:23], 0 offen
  ds_read_b128 v[160:163], v232 offset:12288
  v_mfma_f32_16x16x32_bf16 v[212:215], v[180:183], v[48:51], v[212:215]
  buffer_load_dwordx4 v[12:15], v230, s[20:23], 0 offen
  ds_read_b128 v[164:167], v232 offset:12800
  v_mfma_f32_16x16x32_bf16 v[216:219], v[184:187], v[112:115], v[216:219]
  buffer_load_dwordx4 v[16:19], v231, s[12:15], s37 offen sc1
  ds_read_b128 v[168:171], v232 offset:45056
  v_mfma_f32_16x16x32_bf16 v[220:223], v[188:191], v[112:115], v[220:223]
  buffer_load_dwordx4 v[20:23], v231, s[12:15], s37 offen offset:16 sc1
  ds_read_b128 v[172:175], v232 offset:45568
  s_waitcnt lgkmcnt(4)
  v_mfma_f32_16x16x32_bf16 v[208:211], v[192:195], v[52:55], v[208:211]
  buffer_load_dwordx4 v[24:27], v231, s[12:15], s51 offen sc1
  ds_read_b128 v[176:179], v233 offset:12288
  v_mfma_f32_16x16x32_bf16 v[212:215], v[196:199], v[52:55], v[212:215]
  buffer_load_dwordx4 v[28:31], v231, s[12:15], s51 offen offset:16 sc1
  ds_read_b128 v[180:183], v233 offset:12800
  v_mfma_f32_16x16x32_bf16 v[216:219], v[200:203], v[116:119], v[216:219]
  ds_read_b128 v[184:187], v233 offset:45056
  v_mfma_f32_16x16x32_bf16 v[220:223], v[204:207], v[116:119], v[220:223]
  ds_read_b128 v[188:191], v233 offset:45568
  s_waitcnt lgkmcnt(4)
  s_waitcnt vmcnt(22)
  v_mfma_f32_16x16x32_bf16 v[208:211], v[160:163], v[56:59], v[208:211]
  ds_read_b128 v[192:195], v232 offset:16384
  v_mfma_f32_16x16x32_bf16 v[212:215], v[164:167], v[56:59], v[212:215]
  ds_read_b128 v[196:199], v232 offset:16896
  v_mfma_f32_16x16x32_bf16 v[216:219], v[168:171], v[120:123], v[216:219]
  ds_read_b128 v[200:203], v232 offset:49152
  v_mfma_f32_16x16x32_bf16 v[220:223], v[172:175], v[120:123], v[220:223]
  ds_read_b128 v[204:207], v232 offset:49664
  s_waitcnt lgkmcnt(4)
  v_mfma_f32_16x16x32_bf16 v[208:211], v[176:179], v[60:63], v[208:211]
  ds_read_b128 v[160:163], v233 offset:16384
  v_mfma_f32_16x16x32_bf16 v[212:215], v[180:183], v[60:63], v[212:215]
  ds_read_b128 v[164:167], v233 offset:16896
  v_mfma_f32_16x16x32_bf16 v[216:219], v[184:187], v[124:127], v[216:219]
  ds_read_b128 v[168:171], v233 offset:49152
  v_mfma_f32_16x16x32_bf16 v[220:223], v[188:191], v[124:127], v[220:223]
  ds_read_b128 v[172:175], v233 offset:49664
  s_waitcnt lgkmcnt(4)
  s_waitcnt vmcnt(18)
  v_mfma_f32_16x16x32_bf16 v[208:211], v[192:195], v[64:67], v[208:211]
  ds_read_b128 v[176:179], v232 offset:20480
  v_mfma_f32_16x16x32_bf16 v[212:215], v[196:199], v[64:67], v[212:215]
  ds_read_b128 v[180:183], v232 offset:20992
  v_mfma_f32_16x16x32_bf16 v[216:219], v[200:203], v[128:131], v[216:219]
  ds_read_b128 v[184:187], v232 offset:53248
  v_mfma_f32_16x16x32_bf16 v[220:223], v[204:207], v[128:131], v[220:223]
  ds_read_b128 v[188:191], v232 offset:53760
  s_waitcnt lgkmcnt(4)
  v_mfma_f32_16x16x32_bf16 v[208:211], v[160:163], v[68:71], v[208:211]
  ds_read_b128 v[192:195], v233 offset:20480
  v_mfma_f32_16x16x32_bf16 v[212:215], v[164:167], v[68:71], v[212:215]
  ds_read_b128 v[196:199], v233 offset:20992
  v_mfma_f32_16x16x32_bf16 v[216:219], v[168:171], v[132:135], v[216:219]
  ds_read_b128 v[200:203], v233 offset:53248
  v_mfma_f32_16x16x32_bf16 v[220:223], v[172:175], v[132:135], v[220:223]
  ds_read_b128 v[204:207], v233 offset:53760
  s_waitcnt lgkmcnt(4)
  s_waitcnt vmcnt(14)
  v_mfma_f32_16x16x32_bf16 v[208:211], v[176:179], v[72:75], v[208:211]
  ds_read_b128 v[160:163], v232 offset:24576
  v_mfma_f32_16x16x32_bf16 v[212:215], v[180:183], v[72:75], v[212:215]
  ds_read_b128 v[164:167], v232 offset:25088
  v_mfma_f32_16x16x32_bf16 v[216:219], v[184:187], v[136:139], v[216:219]
  ds_read_b128 v[168:171], v232 offset:57344
  v_mfma_f32_16x16x32_bf16 v[220:223], v[188:191], v[136:139], v[220:223]
  ds_read_b128 v[172:175], v232 offset:57856
  s_waitcnt lgkmcnt(4)
  v_mfma_f32_16x16x32_bf16 v[208:211], v[192:195], v[76:79], v[208:211]
  ds_read_b128 v[176:179], v233 offset:24576
  v_mfma_f32_16x16x32_bf16 v[212:215], v[196:199], v[76:79], v[212:215]
  ds_read_b128 v[180:183], v233 offset:25088
  v_mfma_f32_16x16x32_bf16 v[216:219], v[200:203], v[140:143], v[216:219]
  ds_read_b128 v[184:187], v233 offset:57344
  v_mfma_f32_16x16x32_bf16 v[220:223], v[204:207], v[140:143], v[220:223]
  ds_read_b128 v[188:191], v233 offset:57856
  s_waitcnt lgkmcnt(4)
  s_waitcnt vmcnt(10)
  v_mfma_f32_16x16x32_bf16 v[208:211], v[160:163], v[80:83], v[208:211]
  ds_read_b128 v[192:195], v232 offset:28672
  v_mfma_f32_16x16x32_bf16 v[212:215], v[164:167], v[80:83], v[212:215]
  ds_read_b128 v[196:199], v232 offset:29184
  v_mfma_f32_16x16x32_bf16 v[216:219], v[168:171], v[144:147], v[216:219]
  ds_read_b128 v[200:203], v232 offset:61440
  v_mfma_f32_16x16x32_bf16 v[220:223], v[172:175], v[144:147], v[220:223]
  ds_read_b128 v[204:207], v232 offset:61952
  s_waitcnt lgkmcnt(4)
  v_mfma_f32_16x16x32_bf16 v[208:211], v[176:179], v[84:87], v[208:211]
  ds_read_b128 v[160:163], v233 offset:28672
  v_mfma_f32_16x16x32_bf16 v[212:215], v[180:183], v[84:87], v[212:215]
  ds_read_b128 v[164:167], v233 offset:29184
  v_mfma_f32_16x16x32_bf16 v[216:219], v[184:187], v[148:151], v[216:219]
  ds_read_b128 v[168:171], v233 offset:61440
  v_mfma_f32_16x16x32_bf16 v[220:223], v[188:191], v[148:151], v[220:223]
  ds_read_b128 v[172:175], v233 offset:61952
  s_waitcnt lgkmcnt(4)
  s_waitcnt vmcnt(6)
  v_mfma_f32_16x16x32_bf16 v[208:211], v[192:195], v[88:91], v[208:211]
  v_mfma_f32_16x16x32_bf16 v[212:215], v[196:199], v[88:91], v[212:215]
  v_mfma_f32_16x16x32_bf16 v[216:219], v[200:203], v[152:155], v[216:219]
  v_mfma_f32_16x16x32_bf16 v[220:223], v[204:207], v[152:155], v[220:223]
  s_waitcnt lgkmcnt(0)
  v_mfma_f32_16x16x32_bf16 v[208:211], v[160:163], v[92:95], v[208:211]
  v_mfma_f32_16x16x32_bf16 v[212:215], v[164:167], v[92:95], v[212:215]
  v_mfma_f32_16x16x32_bf16 v[216:219], v[168:171], v[156:159], v[216:219]
  v_mfma_f32_16x16x32_bf16 v[220:223], v[172:175], v[156:159], v[220:223]
  s_waitcnt vmcnt(0)
  s_nop 5
  v_sub_f32 v32, v208, v216
  v_add_f32 v40, v208, v216
  v_sub_f32 v33, v209, v217
  v_add_f32 v41, v209, v217
  v_sub_f32 v34, v210, v218
  v_add_f32 v42, v210, v218
  v_sub_f32 v35, v211, v219
  v_add_f32 v43, v211, v219
  v_sub_f32 v36, v212, v220
  v_add_f32 v44, v212, v220
  v_sub_f32 v37, v213, v221
  v_add_f32 v45, v213, v221
  v_sub_f32 v38, v214, v222
  v_add_f32 v46, v214, v222
  v_sub_f32 v39, v215, v223
  v_add_f32 v47, v215, v223
  s_lshl_b32 s47, s3, 12
  v_lshlrev_b32 v92, 6, v225
  v_lshl_add_u32 v92, v224, 4, v92
  v_add_u32 v92, s47, v92
  v_lshlrev_b32 v93, 4, v1
  v_add_u32 v93, s47, v93
  v_lshrrev_b32 v94, 2, v1
  v_lshl_add_u32 v94, v94, 1, s35
  v_sub_u32 v95, 2048, v94
  v_mov_b32 v234, 1024
  v_cmp_eq_u32 vcc, 0, v94
  s_nop 1
  v_cndmask_b32 v95, v95, v234, vcc
  v_and_b32 v234, 3, v1
  v_lshl_add_u32 v234, v234, 4, s36
  v_lshl_add_u32 v94, v94, 10, v234
  v_lshl_add_u32 v95, v95, 10, v234
  v_mov_b32 v234, 0x40000000
  s_mov_b32 s44, 5177344
  s_mov_b32 s45, 7340032
  s_lshl_b32 s46, s31, 14
  s_lshl_b32 s47, s30, 9
  s_add_u32 s46, s46, s47
  s_lshl_b32 s47, s3, 7
  s_add_u32 s46, s46, s47
  s_add_u32 s46, s46, 294912
  v_lshlrev_b32 v88, 3, v225
  v_add_u32 v89, 8192, v88
  v_cmp_eq_u32 vcc, 0, v224
  s_nop 1
  v_cndmask_b32 v88, v234, v88, vcc
  v_cndmask_b32 v89, v234, v89, vcc
  v_lshlrev_b32 v48, 16, v8
  v_and_b32 v49, 0xffff0000, v8
  v_lshlrev_b32 v50, 16, v9
  v_and_b32 v51, 0xffff0000, v9
  v_lshlrev_b32 v52, 16, v10
  v_and_b32 v53, 0xffff0000, v10
  v_lshlrev_b32 v54, 16, v11
  v_and_b32 v55, 0xffff0000, v11
  v_fmac_f32 v48, v16, v32
  v_fmac_f32 v49, v17, v33
  v_fmac_f32 v50, v18, v34
  v_fmac_f32 v51, v19, v35
  v_fmac_f32 v52, v20, v36
  v_fmac_f32 v53, v21, v37
  v_fmac_f32 v54, v22, v38
  v_fmac_f32 v55, v23, v39
  v_cvt_pk_bf16_f32 v64, v48, v49
  v_cvt_pk_bf16_f32 v65, v50, v51
  v_cvt_pk_bf16_f32 v66, v52, v53
  v_cvt_pk_bf16_f32 v67, v54, v55
  ds_write_b128 v92, v[64:67] offset:0
  v_lshlrev_b32 v48, 16, v64
  v_and_b32 v49, 0xffff0000, v64
  v_lshlrev_b32 v50, 16, v65
  v_and_b32 v51, 0xffff0000, v65
  v_lshlrev_b32 v52, 16, v66
  v_and_b32 v53, 0xffff0000, v66
  v_lshlrev_b32 v54, 16, v67
  v_and_b32 v55, 0xffff0000, v67
  v_mul_f32 v32, v48, v24
  v_mul_f32 v33, v49, v25
  v_mul_f32 v34, v50, v26
  v_mul_f32 v35, v51, v27
  v_mul_f32 v36, v52, v28
  v_mul_f32 v37, v53, v29
  v_mul_f32 v38, v54, v30
  v_mul_f32 v39, v55, v31
  v_cvt_pk_bf16_f32 v68, v32, v33
  v_cvt_pk_bf16_f32 v69, v34, v35
  v_cvt_pk_bf16_f32 v70, v36, v37
  v_cvt_pk_bf16_f32 v71, v38, v39
  ds_write_b128 v92, v[68:71] offset:1024
  v_add_f32 v80, v48, v49
  v_mul_f32 v81, v48, v48
  v_fmac_f32 v81, v49, v49
  v_add_f32 v80, v80, v50
  v_fmac_f32 v81, v50, v50
  v_add_f32 v80, v80, v51
  v_fmac_f32 v81, v51, v51
  v_add_f32 v80, v80, v52
  v_fmac_f32 v81, v52, v52
  v_add_f32 v80, v80, v53
  v_fmac_f32 v81, v53, v53
  v_add_f32 v80, v80, v54
  v_fmac_f32 v81, v54, v54
  v_add_f32 v80, v80, v55
  v_fmac_f32 v81, v55, v55
  s_waitcnt lgkmcnt(0)
  ds_read_b128 v[64:67], v93 offset:0
  ds_read_b128 v[68:71], v93 offset:1024
  v_mov_b32 v84, v80
  v_mov_b32 v85, v81
  s_nop 0
  v_permlane16_swap_b32 v80, v84
  v_permlane16_swap_b32 v81, v85
  v_add_f32 v80, v80, v84
  v_add_f32 v81, v81, v85
  v_mov_b32 v84, v80
  v_mov_b32 v85, v81
  s_nop 0
  v_permlane32_swap_b32 v80, v84
  v_permlane32_swap_b32 v81, v85
  v_add_f32 v80, v80, v84
  v_add_f32 v81, v81, v85
  buffer_store_dwordx2 v[80:81], v88, s[12:15], s46 offen sc1
  s_waitcnt lgkmcnt(0)
  buffer_store_dwordx4 v[64:67], v94, s[12:15], s44 offen sc1
  buffer_store_dwordx4 v[68:71], v94, s[12:15], s45 offen sc1
  v_lshlrev_b32 v48, 16, v12
  v_and_b32 v49, 0xffff0000, v12
  v_lshlrev_b32 v50, 16, v13
  v_and_b32 v51, 0xffff0000, v13
  v_lshlrev_b32 v52, 16, v14
  v_and_b32 v53, 0xffff0000, v14
  v_lshlrev_b32 v54, 16, v15
  v_and_b32 v55, 0xffff0000, v15
  v_fmac_f32 v48, v16, v40
  v_fmac_f32 v49, v17, v41
  v_fmac_f32 v50, v18, v42
  v_fmac_f32 v51, v19, v43
  v_fmac_f32 v52, v20, v44
  v_fmac_f32 v53, v21, v45
  v_fmac_f32 v54, v22, v46
  v_fmac_f32 v55, v23, v47
  v_cvt_pk_bf16_f32 v72, v48, v49
  v_cvt_pk_bf16_f32 v73, v50, v51
  v_cvt_pk_bf16_f32 v74, v52, v53
  v_cvt_pk_bf16_f32 v75, v54, v55
  ds_write_b128 v92, v[72:75] offset:2048
  v_lshlrev_b32 v48, 16, v72
  v_and_b32 v49, 0xffff0000, v72
  v_lshlrev_b32 v50, 16, v73
  v_and_b32 v51, 0xffff0000, v73
  v_lshlrev_b32 v52, 16, v74
  v_and_b32 v53, 0xffff0000, v74
  v_lshlrev_b32 v54, 16, v75
  v_and_b32 v55, 0xffff0000, v75
  v_mul_f32 v40, v48, v24
  v_mul_f32 v41, v49, v25
  v_mul_f32 v42, v50, v26
  v_mul_f32 v43, v51, v27
  v_mul_f32 v44, v52, v28
  v_mul_f32 v45, v53, v29
  v_mul_f32 v46, v54, v30
  v_mul_f32 v47, v55, v31
  v_cvt_pk_bf16_f32 v76, v40, v41
  v_cvt_pk_bf16_f32 v77, v42, v43
  v_cvt_pk_bf16_f32 v78, v44, v45
  v_cvt_pk_bf16_f32 v79, v46, v47
  ds_write_b128 v92, v[76:79] offset:3072
  v_add_f32 v82, v48, v49
  v_mul_f32 v83, v48, v48
  v_fmac_f32 v83, v49, v49
  v_add_f32 v82, v82, v50
  v_fmac_f32 v83, v50, v50
  v_add_f32 v82, v82, v51
  v_fmac_f32 v83, v51, v51
  v_add_f32 v82, v82, v52
  v_fmac_f32 v83, v52, v52
  v_add_f32 v82, v82, v53
  v_fmac_f32 v83, v53, v53
  v_add_f32 v82, v82, v54
  v_fmac_f32 v83, v54, v54
  v_add_f32 v82, v82, v55
  v_fmac_f32 v83, v55, v55
  s_waitcnt lgkmcnt(0)
  ds_read_b128 v[72:75], v93 offset:2048
  ds_read_b128 v[76:79], v93 offset:3072
  v_mov_b32 v84, v82
  v_mov_b32 v85, v83
  s_nop 0
  v_permlane16_swap_b32 v82, v84
  v_permlane16_swap_b32 v83, v85
  v_add_f32 v82, v82, v84
  v_add_f32 v83, v83, v85
  v_mov_b32 v84, v82
  v_mov_b32 v85, v83
  s_nop 0
  v_permlane32_swap_b32 v82, v84
  v_permlane32_swap_b32 v83, v85
  v_add_f32 v82, v82, v84
  v_add_f32 v83, v83, v85
  buffer_store_dwordx2 v[82:83], v89, s[12:15], s46 offen sc1
  s_waitcnt lgkmcnt(0)
  buffer_store_dwordx4 v[72:75], v95, s[12:15], s44 offen sc1
  buffer_store_dwordx4 v[76:79], v95, s[12:15], s45 offen sc1
p3_end:
  s_load_dwordx2 s[6:7], s[0:1], 112
  s_load_dwordx2 s[24:25], s[0:1], 56
  v_and_b32 v1, 63, v0
  s_and_b32 s28, s2, 7
  s_lshr_b32 s29, s2, 3
  s_lshr_b32 s30, s28, 1
  s_lshl_b32 s30, s30, 3
  s_lshr_b32 s31, s29, 2
  s_add_u32 s30, s30, s31
  s_and_b32 s31, s28, 1
  s_lshl_b32 s31, s31, 2
  s_and_b32 s32, s29, 3
  s_add_u32 s31, s31, s32
  v_lshrrev_b32 v2, 4, v1
  v_and_b32 v3, 15, v1
  s_and_b32 s43, s31, 3
  s_lshl_b32 s43, s43, 1
  s_add_u32 s43, s43, s30
  s_add_u32 s52, s43, 0
  s_and_b32 s52, s52, 7
  s_lshl_b32 s52, s52, 7
  s_add_u32 s53, s43, 1
  s_and_b32 s53, s53, 7
  s_lshl_b32 s53, s53, 7
  s_add_u32 s54, s43, 2
  s_and_b32 s54, s54, 7
  s_lshl_b32 s54, s54, 7
  s_add_u32 s55, s43, 3
  s_and_b32 s55, s55, 7
  s_lshl_b32 s55, s55, 7
  s_add_u32 s56, s43, 4
  s_and_b32 s56, s56, 7
  s_lshl_b32 s56, s56, 7
  s_add_u32 s57, s43, 5
  s_and_b32 s57, s57, 7
  s_lshl_b32 s57, s57, 7
  s_add_u32 s58, s43, 6
  s_and_b32 s58, s58, 7
  s_lshl_b32 s58, s58, 7
  s_add_u32 s59, s43, 7
  s_and_b32 s59, s59, 7
  s_lshl_b32 s59, s59, 7
  v_and_b32 v4, 8, v1
  v_cmp_ne_u32 s[20:21], 0, v4
  v_and_b32 v4, 4, v1
  v_cmp_ne_u32 s[22:23], 0, v4
  v_and_b32 v4, 2, v1
  v_cmp_ne_u32 s[26:27], 0, v4
  v_and_b32 v4, 1, v1
  v_cmp_ne_u32 s[44:45], 0, v4
  v_lshrrev_b32 v4, 2, v0
  s_lshl_b32 s35, s30, 6
  v_add_u32 v4, s35, v4
  v_sub_u32 v5, 2048, v4
  v_and_b32 v5, 1023, v5
  v_cmp_gt_u32 vcc, 1024, v4
  s_nop 1
  v_cndmask_b32 v5, v5, v4, vcc
  v_mov_b32 v6, 8192
  v_cndmask_b32 v6, v6, 0, vcc
  v_and_b32 v7, 63, v5
  v_lshrrev_b32 v8, 5, v7
  v_lshlrev_b32 v8, 1, v8
  v_and_b32 v9, 1, v5
  v_add_u32 v8, v8, v9
  v_bfe_u32 v9, v5, 1, 4
  v_lshl_add_u32 v8, v8, 4, v9
  v_lshrrev_b32 v9, 6, v5
  v_lshl_add_u32 v8, v9, 6, v8
  v_lshl_add_u32 v6, v8, 3, v6
  v_and_b32 v5, 3, v0
  v_lshl_add_u32 v6, v5, 16, v6
  s_mov_b32 s35, 294912
  v_lshrrev_b32 v4, 3, v1
  v_and_b32 v5, 7, v1
  v_bfe_u32 v7, v4, 1, 1
  s_lshl_b32 s36, s3, 2
  s_and_b32 s36, s36, 7
  v_add_u32 v7, s36, v7
  v_xor_b32 v56, v5, v7
  v_lshlrev_b32 v56, 4, v56
  v_lshl_add_u32 v56, v4, 10, v56
  v_add_u32 v7, 2, v7
  v_xor_b32 v57, v5, v7
  v_lshlrev_b32 v57, 4, v57
  v_lshl_add_u32 v57, v4, 10, v57
  s_lshl_b32 s36, s30, 16
  s_lshl_b32 s37, s3, 14
  s_add_u32 s36, s36, s37
  s_add_u32 s36, s36, 7340032
  s_lshl_b32 s40, s3, 11
  v_lshlrev_b32 v58, 4, v1
  s_mul_i32 s37, s31, 7
  s_lshl_b32 s38, s3, 1
  s_add_u32 s37, s37, s38
  s_lshl_b32 s46, s37, 14
  s_add_u32 s46, s46, 20512768
  s_add_u32 s47, s46, 16384
  s_cmp_eq_u32 s3, 3
  s_cselect_b32 s47, 0x40000000, s47
  s_add_u32 s48, s46, 917504
  s_add_u32 s49, s47, 917504
  s_lshl_b32 s38, s37, 6
  s_add_u32 s38, s38, 16384
  s_add_u32 s39, s38, 64
  s_cmp_eq_u32 s3, 3
  s_cselect_b32 s39, 0x40000000, s39
  v_lshlrev_b32 v7, 2, v3
  v_lshlrev_b32 v63, 4, v2
  v_lshrrev_b32 v4, 2, v3
  v_and_b32 v5, 3, v3
  v_lshl_add_u32 v4, v4, 3, v5
  v_lshrrev_b32 v5, 1, v3
  v_xor_b32 v5, v5, v2
  v_lshlrev_b32 v5, 4, v5
  v_lshl_add_u32 v59, v4, 7, v5
  v_xor_b32 v60, 64, v59
  s_mov_b32 s50, 0xbdd2d3e8
  s_mov_b32 s51, 0xbdd2d3e8
  v_mov_b32 v54, 0xc0135761
  v_mov_b32 v55, 0xc0135761
  s_waitcnt lgkmcnt(0)
  s_mov_b32 s12, s6
  s_mov_b32 s13, s7
  s_mov_b32 s14, 0x2000000
  s_mov_b32 s15, 0x20000
  s_mov_b32 s16, s24
  s_mov_b32 s17, s25
  s_mov_b32 s18, 0x800000
  s_mov_b32 s19, 0x20000
  s_waitcnt vmcnt(0) lgkmcnt(0)
  s_barrier
  s_cmp_lg_u32 s3, 3
  s_cbranch_scc1 adaLN_cond__spectral_fnet__mixer_gmlp__prompt_kernel_join49
  v_mov_b32 v254, s101
  v_mov_b32 v255, 0
  s_lshl_b32 s88, s2, 7
  s_add_u32 s88, s88, 23134208
  s_mov_b64 s[90:91], exec
  s_mov_b64 exec, 1
  buffer_store_dword v254, v255, s[96:99], s88 offen sc1
  s_mov_b64 exec, s[90:91]
  v_and_b32 v250, 63, v0
  s_sub_u32 s88, 31, s30
  s_sub_u32 s89, 32, s30
  s_and_b32 s89, s89, 15
  s_cmp_lt_u32 s30, 16
  s_cselect_b32 s88, s30, s88
  s_cselect_b32 s89, s30, s89
  v_mov_b32 v251, s88
  v_mov_b32 v252, s89
  v_cmp_gt_u32 vcc, 16, v250
  s_nop 1
  v_cndmask_b32 v251, v252, v251, vcc
  v_and_b32 v252, 15, v250
  v_lshrrev_b32 v253, 2, v251
  v_lshlrev_b32 v253, 1, v253
  v_and_b32 v251, 3, v251
  v_lshl_add_u32 v253, v251, 6, v253
  v_lshrrev_b32 v251, 3, v252
  v_add_u32 v253, v253, v251
  v_and_b32 v252, 7, v252
  v_lshl_add_u32 v253, v252, 3, v253
  v_lshlrev_b32 v253, 7, v253
  v_add_u32 v253, 65536, v253
  v_add_u32 v251, -32, v250
  s_mul_i32 s88, s31, 7
  v_add_u32 v252, s88, v251
  v_add_u32 v248, 49, v252
  v_cmp_gt_u32 vcc, 7, v251
  s_nop 1
  v_cndmask_b32 v252, v248, v252, vcc
  v_lshlrev_b32 v252, 7, v252
  v_add_u32 v252, 32768, v252
  v_cmp_gt_u32 vcc, 32, v250
  s_nop 1
  v_cndmask_b32 v253, v252, v253, vcc
  v_mov_b32 v252, 0x40000000
  v_cmp_gt_u32 vcc, 46, v250
  s_nop 1
  v_cndmask_b32 v250, v252, v253, vcc
  s_lshl_b32 s41, s52, 4
  s_add_u32 s42, s41, s49
  s_add_u32 s41, s41, s48
  buffer_load_dwordx4 a[0:3], v58, s[12:15], s41 offen offset:0 sc1
  buffer_load_dwordx4 a[4:7], v58, s[12:15], s42 offen offset:0 sc1
  s_lshl_b32 s41, s52, 4
  s_add_u32 s42, s41, s49
  s_add_u32 s41, s41, s48
  buffer_load_dwordx4 a[8:11], v58, s[12:15], s41 offen offset:1024 sc1
  buffer_load_dwordx4 a[12:15], v58, s[12:15], s42 offen offset:1024 sc1
  s_lshl_b32 s41, s53, 4
  s_add_u32 s42, s41, s49
  s_add_u32 s41, s41, s48
  buffer_load_dwordx4 a[16:19], v58, s[12:15], s41 offen offset:0 sc1
  buffer_load_dwordx4 a[20:23], v58, s[12:15], s42 offen offset:0 sc1
  s_lshl_b32 s41, s53, 4
  s_add_u32 s42, s41, s49
  s_add_u32 s41, s41, s48
  buffer_load_dwordx4 a[24:27], v58, s[12:15], s41 offen offset:1024 sc1
  buffer_load_dwordx4 a[28:31], v58, s[12:15], s42 offen offset:1024 sc1
  s_lshl_b32 s41, s54, 4
  s_add_u32 s42, s41, s49
  s_add_u32 s41, s41, s48
  buffer_load_dwordx4 a[32:35], v58, s[12:15], s41 offen offset:0 sc1
  buffer_load_dwordx4 a[36:39], v58, s[12:15], s42 offen offset:0 sc1
  s_lshl_b32 s41, s54, 4
  s_add_u32 s42, s41, s49
  s_add_u32 s41, s41, s48
  buffer_load_dwordx4 a[40:43], v58, s[12:15], s41 offen offset:1024 sc1
  buffer_load_dwordx4 a[44:47], v58, s[12:15], s42 offen offset:1024 sc1
  s_lshl_b32 s41, s55, 4
  s_add_u32 s42, s41, s49
  s_add_u32 s41, s41, s48
  buffer_load_dwordx4 a[48:51], v58, s[12:15], s41 offen offset:0 sc1
  buffer_load_dwordx4 a[52:55], v58, s[12:15], s42 offen offset:0 sc1
  s_lshl_b32 s41, s55, 4
  s_add_u32 s42, s41, s49
  s_add_u32 s41, s41, s48
  buffer_load_dwordx4 a[56:59], v58, s[12:15], s41 offen offset:1024 sc1
  buffer_load_dwordx4 a[60:63], v58, s[12:15], s42 offen offset:1024 sc1
  s_lshl_b32 s41, s56, 4
  s_add_u32 s42, s41, s49
  s_add_u32 s41, s41, s48
  buffer_load_dwordx4 a[64:67], v58, s[12:15], s41 offen offset:0 sc1
  buffer_load_dwordx4 a[68:71], v58, s[12:15], s42 offen offset:0 sc1
  s_lshl_b32 s41, s56, 4
  s_add_u32 s42, s41, s49
  s_add_u32 s41, s41, s48
  buffer_load_dwordx4 a[72:75], v58, s[12:15], s41 offen offset:1024 sc1
  buffer_load_dwordx4 a[76:79], v58, s[12:15], s42 offen offset:1024 sc1
  s_lshl_b32 s41, s57, 4
  s_add_u32 s42, s41, s49
  s_add_u32 s41, s41, s48
  buffer_load_dwordx4 a[80:83], v58, s[12:15], s41 offen offset:0 sc1
  buffer_load_dwordx4 a[84:87], v58, s[12:15], s42 offen offset:0 sc1
  s_lshl_b32 s41, s57, 4
  s_add_u32 s42, s41, s49
  s_add_u32 s41, s41, s48
  buffer_load_dwordx4 a[88:91], v58, s[12:15], s41 offen offset:1024 sc1
  buffer_load_dwordx4 a[92:95], v58, s[12:15], s42 offen offset:1024 sc1
  s_lshl_b32 s41, s58, 4
  s_add_u32 s42, s41, s49
  s_add_u32 s41, s41, s48
  buffer_load_dwordx4 a[96:99], v58, s[12:15], s41 offen offset:0 sc1
  buffer_load_dwordx4 a[100:103], v58, s[12:15], s42 offen offset:0 sc1
  s_lshl_b32 s41, s58, 4
  s_add_u32 s42, s41, s49
  s_add_u32 s41, s41, s48
  buffer_load_dwordx4 a[104:107], v58, s[12:15], s41 offen offset:1024 sc1
  buffer_load_dwordx4 a[108:111], v58, s[12:15], s42 offen offset:1024 sc1
  s_lshl_b32 s41, s59, 4
  s_add_u32 s42, s41, s49
  s_add_u32 s41, s41, s48
  buffer_load_dwordx4 a[112:115], v58, s[12:15], s41 offen offset:0 sc1
  buffer_load_dwordx4 a[116:119], v58, s[12:15], s42 offen offset:0 sc1
  s_lshl_b32 s41, s59, 4
  s_add_u32 s42, s41, s49
  s_add_u32 s41, s41, s48
  buffer_load_dwordx4 a[120:123], v58, s[12:15], s41 offen offset:1024 sc1
  buffer_load_dwordx4 a[124:127], v58, s[12:15], s42 offen offset:1024 sc1
  s_lshl_b32 s41, s52, 4
  s_add_u32 s42, s41, s47
  s_add_u32 s41, s41, s46
  buffer_load_dwordx4 a[128:131], v58, s[12:15], s41 offen offset:0 sc1
  buffer_load_dwordx4 a[132:135], v58, s[12:15], s42 offen offset:0 sc1
  s_lshl_b32 s41, s52, 4
  s_add_u32 s42, s41, s47
  s_add_u32 s41, s41, s46
  buffer_load_dwordx4 a[136:139], v58, s[12:15], s41 offen offset:1024 sc1
  buffer_load_dwordx4 a[140:143], v58, s[12:15], s42 offen offset:1024 sc1
  s_lshl_b32 s41, s53, 4
  s_add_u32 s42, s41, s47
  s_add_u32 s41, s41, s46
  buffer_load_dwordx4 a[144:147], v58, s[12:15], s41 offen offset:0 sc1
  buffer_load_dwordx4 a[148:151], v58, s[12:15], s42 offen offset:0 sc1
  s_lshl_b32 s41, s53, 4
  s_add_u32 s42, s41, s47
  s_add_u32 s41, s41, s46
  buffer_load_dwordx4 a[152:155], v58, s[12:15], s41 offen offset:1024 sc1
  buffer_load_dwordx4 a[156:159], v58, s[12:15], s42 offen offset:1024 sc1
  s_lshl_b32 s41, s54, 4
  s_add_u32 s42, s41, s47
  s_add_u32 s41, s41, s46
  buffer_load_dwordx4 a[160:163], v58, s[12:15], s41 offen offset:0 sc1
  buffer_load_dwordx4 a[164:167], v58, s[12:15], s42 offen offset:0 sc1
  s_lshl_b32 s41, s54, 4
  s_add_u32 s42, s41, s47
  s_add_u32 s41, s41, s46
  buffer_load_dwordx4 a[168:171], v58, s[12:15], s41 offen offset:1024 sc1
  buffer_load_dwordx4 a[172:175], v58, s[12:15], s42 offen offset:1024 sc1
  s_lshl_b32 s41, s55, 4
  s_add_u32 s42, s41, s47
  s_add_u32 s41, s41, s46
  buffer_load_dwordx4 a[176:179], v58, s[12:15], s41 offen offset:0 sc1
  buffer_load_dwordx4 a[180:183], v58, s[12:15], s42 offen offset:0 sc1
  s_lshl_b32 s41, s55, 4
  s_add_u32 s42, s41, s47
  s_add_u32 s41, s41, s46
  buffer_load_dwordx4 a[184:187], v58, s[12:15], s41 offen offset:1024 sc1
  buffer_load_dwordx4 a[188:191], v58, s[12:15], s42 offen offset:1024 sc1
  s_lshl_b32 s41, s56, 4
  s_add_u32 s42, s41, s47
  s_add_u32 s41, s41, s46
  buffer_load_dwordx4 a[192:195], v58, s[12:15], s41 offen offset:0 sc1
  buffer_load_dwordx4 a[196:199], v58, s[12:15], s42 offen offset:0 sc1
  s_lshl_b32 s41, s56, 4
  s_add_u32 s42, s41, s47
  s_add_u32 s41, s41, s46
  buffer_load_dwordx4 a[200:203], v58, s[12:15], s41 offen offset:1024 sc1
  buffer_load_dwordx4 a[204:207], v58, s[12:15], s42 offen offset:1024 sc1
  s_lshl_b32 s41, s57, 4
  s_add_u32 s42, s41, s47
  s_add_u32 s41, s41, s46
  buffer_load_dwordx4 a[208:211], v58, s[12:15], s41 offen offset:0 sc1
  buffer_load_dwordx4 a[212:215], v58, s[12:15], s42 offen offset:0 sc1
  s_lshl_b32 s41, s57, 4
  s_add_u32 s42, s41, s47
  s_add_u32 s41, s41, s46
  buffer_load_dwordx4 a[216:219], v58, s[12:15], s41 offen offset:1024 sc1
  buffer_load_dwordx4 a[220:223], v58, s[12:15], s42 offen offset:1024 sc1
  s_mov_b32 s88, 23068672
  s_mov_b32 s89, 0x40000
adaLN_cond__spectral_fnet__mixer_gmlp__prompt_kernel_gb50:
  buffer_load_dword v244, v250, s[96:99], s88 offen sc1
  s_waitcnt vmcnt(0)
  v_cmp_le_u32 vcc, 0x40000000, v250
  s_nop 1
  v_cndmask_b32 v244, v244, v254, vcc
  v_xor_b32 v244, v244, v254
  v_cmp_ne_u32 vcc, 0, v244
  s_nop 4
  s_cbranch_vccz adaLN_cond__spectral_fnet__mixer_gmlp__prompt_kernel_gbd51
  s_sub_u32 s89, s89, 1
  s_cmp_lg_u32 s89, 0
  s_cbranch_scc1 adaLN_cond__spectral_fnet__mixer_gmlp__prompt_kernel_gb50
adaLN_cond__spectral_fnet__mixer_gmlp__prompt_kernel_gbd51:
  s_mov_b64 s[90:91], exec
  s_branch adaLN_cond__spectral_fnet__mixer_gmlp__prompt_kernel_join252
adaLN_cond__spectral_fnet__mixer_gmlp__prompt_kernel_join49:
  s_getpc_b64 s[92:93]
adaLN_cond__spectral_fnet__mixer_gmlp__prompt_kernel_ct53:
  s_lshl_b32 s94, s3, 13
  v_and_b32 v244, 63, v0
  v_lshlrev_b32 v244, 7, v244
  v_add_u32 v244, s94, v244
  v_cmp_gt_u32 vcc, code_end-adaLN_cond__spectral_fnet__mixer_gmlp__prompt_kernel_ct53, v244
  s_nop 0
  s_and_saveexec_b64 s[94:95], vcc
  s_cbranch_execz adaLN_cond__spectral_fnet__mixer_gmlp__prompt_kernel_ctn54
  global_load_dword v245, v244, s[92:93]
adaLN_cond__spectral_fnet__mixer_gmlp__prompt_kernel_ctn54:
  s_mov_b64 exec, s[94:95]
  s_lshl_b32 s41, s52, 4
  s_add_u32 s42, s41, s49
  s_add_u32 s41, s41, s48
  buffer_load_dwordx4 a[0:3], v58, s[12:15], s41 offen offset:0 sc1
  buffer_load_dwordx4 a[4:7], v58, s[12:15], s42 offen offset:0 sc1
  s_lshl_b32 s41, s52, 4
  s_add_u32 s42, s41, s49
  s_add_u32 s41, s41, s48
  buffer_load_dwordx4 a[8:11], v58, s[12:15], s41 offen offset:1024 sc1
  buffer_load_dwordx4 a[12:15], v58, s[12:15], s42 offen offset:1024 sc1
  s_lshl_b32 s41, s53, 4
  s_add_u32 s42, s41, s49
  s_add_u32 s41, s41, s48
  buffer_load_dwordx4 a[16:19], v58, s[12:15], s41 offen offset:0 sc1
  buffer_load_dwordx4 a[20:23], v58, s[12:15], s42 offen offset:0 sc1
  s_lshl_b32 s41, s53, 4
  s_add_u32 s42, s41, s49
  s_add_u32 s41, s41, s48
  buffer_load_dwordx4 a[24:27], v58, s[12:15], s41 offen offset:1024 sc1
  buffer_load_dwordx4 a[28:31], v58, s[12:15], s42 offen offset:1024 sc1
  s_lshl_b32 s41, s54, 4
  s_add_u32 s42, s41, s49
  s_add_u32 s41, s41, s48
  buffer_load_dwordx4 a[32:35], v58, s[12:15], s41 offen offset:0 sc1
  buffer_load_dwordx4 a[36:39], v58, s[12:15], s42 offen offset:0 sc1
  s_lshl_b32 s41, s54, 4
  s_add_u32 s42, s41, s49
  s_add_u32 s41, s41, s48
  buffer_load_dwordx4 a[40:43], v58, s[12:15], s41 offen offset:1024 sc1
  buffer_load_dwordx4 a[44:47], v58, s[12:15], s42 offen offset:1024 sc1
  s_lshl_b32 s41, s55, 4
  s_add_u32 s42, s41, s49
  s_add_u32 s41, s41, s48
  buffer_load_dwordx4 a[48:51], v58, s[12:15], s41 offen offset:0 sc1
  buffer_load_dwordx4 a[52:55], v58, s[12:15], s42 offen offset:0 sc1
  s_lshl_b32 s41, s55, 4
  s_add_u32 s42, s41, s49
  s_add_u32 s41, s41, s48
  buffer_load_dwordx4 a[56:59], v58, s[12:15], s41 offen offset:1024 sc1
  buffer_load_dwordx4 a[60:63], v58, s[12:15], s42 offen offset:1024 sc1
  s_lshl_b32 s41, s56, 4
  s_add_u32 s42, s41, s49
  s_add_u32 s41, s41, s48
  buffer_load_dwordx4 a[64:67], v58, s[12:15], s41 offen offset:0 sc1
  buffer_load_dwordx4 a[68:71], v58, s[12:15], s42 offen offset:0 sc1
  s_lshl_b32 s41, s56, 4
  s_add_u32 s42, s41, s49
  s_add_u32 s41, s41, s48
  buffer_load_dwordx4 a[72:75], v58, s[12:15], s41 offen offset:1024 sc1
  buffer_load_dwordx4 a[76:79], v58, s[12:15], s42 offen offset:1024 sc1
  s_lshl_b32 s41, s57, 4
  s_add_u32 s42, s41, s49
  s_add_u32 s41, s41, s48
  buffer_load_dwordx4 a[80:83], v58, s[12:15], s41 offen offset:0 sc1
  buffer_load_dwordx4 a[84:87], v58, s[12:15], s42 offen offset:0 sc1
  s_lshl_b32 s41, s57, 4
  s_add_u32 s42, s41, s49
  s_add_u32 s41, s41, s48
  buffer_load_dwordx4 a[88:91], v58, s[12:15], s41 offen offset:1024 sc1
  buffer_load_dwordx4 a[92:95], v58, s[12:15], s42 offen offset:1024 sc1
  s_lshl_b32 s41, s58, 4
  s_add_u32 s42, s41, s49
  s_add_u32 s41, s41, s48
  buffer_load_dwordx4 a[96:99], v58, s[12:15], s41 offen offset:0 sc1
  buffer_load_dwordx4 a[100:103], v58, s[12:15], s42 offen offset:0 sc1
  s_lshl_b32 s41, s58, 4
  s_add_u32 s42, s41, s49
  s_add_u32 s41, s41, s48
  buffer_load_dwordx4 a[104:107], v58, s[12:15], s41 offen offset:1024 sc1
  buffer_load_dwordx4 a[108:111], v58, s[12:15], s42 offen offset:1024 sc1
  s_lshl_b32 s41, s59, 4
  s_add_u32 s42, s41, s49
  s_add_u32 s41, s41, s48
  buffer_load_dwordx4 a[112:115], v58, s[12:15], s41 offen offset:0 sc1
  buffer_load_dwordx4 a[116:119], v58, s[12:15], s42 offen offset:0 sc1
  s_lshl_b32 s41, s59, 4
  s_add_u32 s42, s41, s49
  s_add_u32 s41, s41, s48
  buffer_load_dwordx4 a[120:123], v58, s[12:15], s41 offen offset:1024 sc1
  buffer_load_dwordx4 a[124:127], v58, s[12:15], s42 offen offset:1024 sc1
  s_lshl_b32 s41, s52, 4
  s_add_u32 s42, s41, s47
  s_add_u32 s41, s41, s46
  buffer_load_dwordx4 a[128:131], v58, s[12:15], s41 offen offset:0 sc1
  buffer_load_dwordx4 a[132:135], v58, s[12:15], s42 offen offset:0 sc1
  s_lshl_b32 s41, s52, 4
  s_add_u32 s42, s41, s47
  s_add_u32 s41, s41, s46
  buffer_load_dwordx4 a[136:139], v58, s[12:15], s41 offen offset:1024 sc1
  buffer_load_dwordx4 a[140:143], v58, s[12:15], s42 offen offset:1024 sc1
  s_lshl_b32 s41, s53, 4
  s_add_u32 s42, s41, s47
  s_add_u32 s41, s41, s46
  buffer_load_dwordx4 a[144:147], v58, s[12:15], s41 offen offset:0 sc1
  buffer_load_dwordx4 a[148:151], v58, s[12:15], s42 offen offset:0 sc1
  s_lshl_b32 s41, s53, 4
  s_add_u32 s42, s41, s47
  s_add_u32 s41, s41, s46
  buffer_load_dwordx4 a[152:155], v58, s[12:15], s41 offen offset:1024 sc1
  buffer_load_dwordx4 a[156:159], v58, s[12:15], s42 offen offset:1024 sc1
  s_lshl_b32 s41, s54, 4
  s_add_u32 s42, s41, s47
  s_add_u32 s41, s41, s46
  buffer_load_dwordx4 a[160:163], v58, s[12:15], s41 offen offset:0 sc1
  buffer_load_dwordx4 a[164:167], v58, s[12:15], s42 offen offset:0 sc1
  s_lshl_b32 s41, s54, 4
  s_add_u32 s42, s41, s47
  s_add_u32 s41, s41, s46
  buffer_load_dwordx4 a[168:171], v58, s[12:15], s41 offen offset:1024 sc1
  buffer_load_dwordx4 a[172:175], v58, s[12:15], s42 offen offset:1024 sc1
  s_lshl_b32 s41, s55, 4
  s_add_u32 s42, s41, s47
  s_add_u32 s41, s41, s46
  buffer_load_dwordx4 a[176:179], v58, s[12:15], s41 offen offset:0 sc1
  buffer_load_dwordx4 a[180:183], v58, s[12:15], s42 offen offset:0 sc1
  s_lshl_b32 s41, s55, 4
  s_add_u32 s42, s41, s47
  s_add_u32 s41, s41, s46
  buffer_load_dwordx4 a[184:187], v58, s[12:15], s41 offen offset:1024 sc1
  buffer_load_dwordx4 a[188:191], v58, s[12:15], s42 offen offset:1024 sc1
  s_lshl_b32 s41, s56, 4
  s_add_u32 s42, s41, s47
  s_add_u32 s41, s41, s46
  buffer_load_dwordx4 a[192:195], v58, s[12:15], s41 offen offset:0 sc1
  buffer_load_dwordx4 a[196:199], v58, s[12:15], s42 offen offset:0 sc1
  s_lshl_b32 s41, s56, 4
  s_add_u32 s42, s41, s47
  s_add_u32 s41, s41, s46
  buffer_load_dwordx4 a[200:203], v58, s[12:15], s41 offen offset:1024 sc1
  buffer_load_dwordx4 a[204:207], v58, s[12:15], s42 offen offset:1024 sc1
  s_lshl_b32 s41, s57, 4
  s_add_u32 s42, s41, s47
  s_add_u32 s41, s41, s46
  buffer_load_dwordx4 a[208:211], v58, s[12:15], s41 offen offset:0 sc1
  buffer_load_dwordx4 a[212:215], v58, s[12:15], s42 offen offset:0 sc1
  s_lshl_b32 s41, s57, 4
  s_add_u32 s42, s41, s47
  s_add_u32 s41, s41, s46
  buffer_load_dwordx4 a[216:219], v58, s[12:15], s41 offen offset:1024 sc1
  buffer_load_dwordx4 a[220:223], v58, s[12:15], s42 offen offset:1024 sc1
adaLN_cond__spectral_fnet__mixer_gmlp__prompt_kernel_join252:
  s_barrier
  s_waitcnt vmcnt(44)
  s_add_u32 s41, s36, s52
  s_lshl_b32 s42, s52, 6
  s_add_u32 m0, s40, s42
  buffer_load_dwordx4 v[64:67], v56, s[12:15], s41 offen sc1
  s_add_u32 s41, s41, 8192
  s_add_u32 m0, m0, 1024
  buffer_load_dwordx4 v[68:71], v57, s[12:15], s41 offen sc1
  s_add_u32 s41, s36, s53
  s_lshl_b32 s42, s53, 6
  s_add_u32 m0, s40, s42
  buffer_load_dwordx4 v[72:75], v56, s[12:15], s41 offen sc1
  s_add_u32 s41, s41, 8192
  s_add_u32 m0, m0, 1024
  buffer_load_dwordx4 v[76:79], v57, s[12:15], s41 offen sc1
  s_add_u32 s41, s36, s54
  s_lshl_b32 s42, s54, 6
  s_add_u32 m0, s40, s42
  buffer_load_dwordx4 v[80:83], v56, s[12:15], s41 offen sc1
  s_add_u32 s41, s41, 8192
  s_add_u32 m0, m0, 1024
  buffer_load_dwordx4 v[84:87], v57, s[12:15], s41 offen sc1
  s_add_u32 s41, s36, s55
  s_lshl_b32 s42, s55, 6
  s_add_u32 m0, s40, s42
  buffer_load_dwordx4 v[88:91], v56, s[12:15], s41 offen sc1
  s_add_u32 s41, s41, 8192
  s_add_u32 m0, m0, 1024
  buffer_load_dwordx4 v[92:95], v57, s[12:15], s41 offen sc1
  s_add_u32 s41, s36, s56
  s_lshl_b32 s42, s56, 6
  s_add_u32 m0, s40, s42
  buffer_load_dwordx4 v[96:99], v56, s[12:15], s41 offen sc1
  s_add_u32 s41, s41, 8192
  s_add_u32 m0, m0, 1024
  buffer_load_dwordx4 v[100:103], v57, s[12:15], s41 offen sc1
  s_add_u32 s41, s36, s57
  s_lshl_b32 s42, s57, 6
  s_add_u32 m0, s40, s42
  buffer_load_dwordx4 v[104:107], v56, s[12:15], s41 offen sc1
  s_add_u32 s41, s41, 8192
  s_add_u32 m0, m0, 1024
  buffer_load_dwordx4 v[108:111], v57, s[12:15], s41 offen sc1
  s_add_u32 s41, s36, s58
  s_lshl_b32 s42, s58, 6
  s_add_u32 m0, s40, s42
  buffer_load_dwordx4 v[112:115], v56, s[12:15], s41 offen sc1
  s_add_u32 s41, s41, 8192
  s_add_u32 m0, m0, 1024
  buffer_load_dwordx4 v[116:119], v57, s[12:15], s41 offen sc1
  s_add_u32 s41, s36, s59
  s_lshl_b32 s42, s59, 6
  s_add_u32 m0, s40, s42
  buffer_load_dwordx4 v[120:123], v56, s[12:15], s41 offen sc1
  s_add_u32 s41, s41, 8192
  s_add_u32 m0, m0, 1024
  buffer_load_dwordx4 v[124:127], v57, s[12:15], s41 offen sc1
  s_add_u32 s41, s35, 0
  buffer_load_dwordx2 v[8:9], v6, s[12:15], s41 offen sc1
  s_add_u32 s41, s35, 16384
  buffer_load_dwordx2 v[10:11], v6, s[12:15], s41 offen sc1
  s_add_u32 s41, s35, 32768
  buffer_load_dwordx2 v[12:13], v6, s[12:15], s41 offen sc1
  s_add_u32 s41, s35, 49152
  buffer_load_dwordx2 v[14:15], v6, s[12:15], s41 offen sc1
  s_waitcnt vmcnt(18)
  s_lshl_b32 s42, s52, 6
  s_add_u32 s42, s42, s40
  v_add_u32 v4, s42, v58
  ds_write_b128 v4, v[64:67]
  ds_write_b128 v4, v[68:71] offset:1024
  s_waitcnt vmcnt(16)
  s_lshl_b32 s42, s53, 6
  s_add_u32 s42, s42, s40
  v_add_u32 v4, s42, v58
  ds_write_b128 v4, v[72:75]
  ds_write_b128 v4, v[76:79] offset:1024
  s_waitcnt vmcnt(14)
  s_lshl_b32 s42, s54, 6
  s_add_u32 s42, s42, s40
  v_add_u32 v4, s42, v58
  ds_write_b128 v4, v[80:83]
  ds_write_b128 v4, v[84:87] offset:1024
  s_waitcnt vmcnt(12)
  s_lshl_b32 s42, s55, 6
  s_add_u32 s42, s42, s40
  v_add_u32 v4, s42, v58
  ds_write_b128 v4, v[88:91]
  ds_write_b128 v4, v[92:95] offset:1024
  s_waitcnt vmcnt(10)
  s_lshl_b32 s42, s56, 6
  s_add_u32 s42, s42, s40
  v_add_u32 v4, s42, v58
  ds_write_b128 v4, v[96:99]
  ds_write_b128 v4, v[100:103] offset:1024
  s_waitcnt vmcnt(8)
  s_lshl_b32 s42, s57, 6
  s_add_u32 s42, s42, s40
  v_add_u32 v4, s42, v58
  ds_write_b128 v4, v[104:107]
  ds_write_b128 v4, v[108:111] offset:1024
  s_waitcnt vmcnt(6)
  s_lshl_b32 s42, s58, 6
  s_add_u32 s42, s42, s40
  v_add_u32 v4, s42, v58
  ds_write_b128 v4, v[112:115]
  ds_write_b128 v4, v[116:119] offset:1024
  s_waitcnt vmcnt(4)
  s_lshl_b32 s42, s59, 6
  s_add_u32 s42, s42, s40
  v_add_u32 v4, s42, v58
  ds_write_b128 v4, v[120:123]
  ds_write_b128 v4, v[124:127] offset:1024
  s_waitcnt vmcnt(0)
  v_add_f32 v8, v8, v10
  v_add_f32 v9, v9, v11
  v_add_f32 v12, v12, v14
  v_add_f32 v13, v13, v15
  v_add_f32 v8, v8, v12
  v_add_f32 v9, v9, v13
  s_nop 0
  v_add_f32 v8, v8, v8 quad_perm:[1,0,3,2] row_mask:0xf bank_mask:0xf
  v_add_f32 v9, v9, v9 quad_perm:[1,0,3,2] row_mask:0xf bank_mask:0xf
  s_nop 0
  v_add_f32 v8, v8, v8 quad_perm:[2,3,0,1] row_mask:0xf bank_mask:0xf
  v_add_f32 v9, v9, v9 quad_perm:[2,3,0,1] row_mask:0xf bank_mask:0xf
  v_mul_f32 v8, 0x3b000000, v8
  v_mul_f32 v9, 0x3b000000, v9
  v_fma_f32 v9, -v8, v8, v9
  v_max_f32 v9, 0, v9
  v_add_f32 v9, 0x3727c5ac, v9
  v_rsq_f32 v10, v9
  s_nop 0
  v_mul_f32 v11, v10, v8
  v_lshrrev_b32 v4, 2, v0
  v_lshlrev_b32 v4, 2, v4
  v_add_u32 v4, 145408, v4
  ds_write_b32 v4, v10
  ds_write_b32 v4, v11 offset:256
  s_waitcnt lgkmcnt(0)
  s_barrier
  s_lshl_b32 s43, s52, 6
  v_add_u32 v61, s43, v59
  v_add_u32 v62, s43, v60
  ds_read_b128 v[64:67], v61 offset:0
  ds_read_b128 v[68:71], v61 offset:512
  ds_read_b128 v[72:75], v61 offset:4096
  ds_read_b128 v[76:79], v61 offset:4608
  ds_read_b128 v[80:83], v62 offset:0
  ds_read_b128 v[84:87], v62 offset:512
  ds_read_b128 v[88:91], v62 offset:4096
  ds_read_b128 v[92:95], v62 offset:4608
  s_waitcnt lgkmcnt(4)
  v_mfma_f32_16x16x32_bf16 v[112:115], v[64:67], a[0:3], 0
  v_mfma_f32_16x16x32_bf16 v[116:119], v[64:67], a[4:7], 0
  s_lshl_b32 s43, s53, 6
  v_mfma_f32_16x16x32_bf16 v[120:123], v[68:71], a[0:3], 0
  v_add_u32 v50, s43, v59
  v_mfma_f32_16x16x32_bf16 v[124:127], v[68:71], a[4:7], 0
  s_add_u32 s41, s38, 3584
  buffer_load_dword v16, v7, s[12:15], s41 offen sc1
  v_add_u32 v51, s43, v60
  v_mfma_f32_16x16x32_bf16 v[128:131], v[72:75], a[0:3], 0
  ds_read_b128 v[96:99], v50 offset:0
  v_mfma_f32_16x16x32_bf16 v[132:135], v[72:75], a[4:7], 0
  ds_read_b128 v[100:103], v50 offset:512
  v_mfma_f32_16x16x32_bf16 v[136:139], v[76:79], a[0:3], 0
  ds_read_b128 v[104:107], v50 offset:4096
  v_mfma_f32_16x16x32_bf16 v[140:143], v[76:79], a[4:7], 0
  s_add_u32 s41, s38, 10752
  buffer_load_dword v18, v7, s[12:15], s41 offen sc1
  ds_read_b128 v[108:111], v50 offset:4608
  s_waitcnt lgkmcnt(4)
  v_mfma_f32_16x16x32_bf16 v[112:115], v[80:83], a[8:11], v[112:115]
  v_mfma_f32_16x16x32_bf16 v[116:119], v[80:83], a[12:15], v[116:119]
  ds_read_b128 v[64:67], v51 offset:0
  v_mfma_f32_16x16x32_bf16 v[120:123], v[84:87], a[8:11], v[120:123]
  v_mfma_f32_16x16x32_bf16 v[124:127], v[84:87], a[12:15], v[124:127]
  buffer_load_dwordx4 v[20:23], v63, s[12:15], s38 offen sc1
  ds_read_b128 v[68:71], v51 offset:512
  v_mfma_f32_16x16x32_bf16 v[128:131], v[88:91], a[8:11], v[128:131]
  v_mfma_f32_16x16x32_bf16 v[132:135], v[88:91], a[12:15], v[132:135]
  ds_read_b128 v[72:75], v51 offset:4096
  v_mfma_f32_16x16x32_bf16 v[136:139], v[92:95], a[8:11], v[136:139]
  v_mfma_f32_16x16x32_bf16 v[140:143], v[92:95], a[12:15], v[140:143]
  s_add_u32 s41, s38, 7168
  buffer_load_dwordx4 v[28:31], v63, s[12:15], s41 offen sc1
  ds_read_b128 v[76:79], v51 offset:4608
  s_waitcnt lgkmcnt(4)
  v_mfma_f32_16x16x32_bf16 v[112:115], v[96:99], a[16:19], v[112:115]
  v_mfma_f32_16x16x32_bf16 v[116:119], v[96:99], a[20:23], v[116:119]
  s_lshl_b32 s43, s54, 6
  v_mfma_f32_16x16x32_bf16 v[120:123], v[100:103], a[16:19], v[120:123]
  v_add_u32 v61, s43, v59
  v_mfma_f32_16x16x32_bf16 v[124:127], v[100:103], a[20:23], v[124:127]
  s_add_u32 s41, s39, 3584
  buffer_load_dword v17, v7, s[12:15], s41 offen sc1
  v_add_u32 v62, s43, v60
  v_mfma_f32_16x16x32_bf16 v[128:131], v[104:107], a[16:19], v[128:131]
  ds_read_b128 v[80:83], v61 offset:0
  v_mfma_f32_16x16x32_bf16 v[132:135], v[104:107], a[20:23], v[132:135]
  ds_read_b128 v[84:87], v61 offset:512
  v_mfma_f32_16x16x32_bf16 v[136:139], v[108:111], a[16:19], v[136:139]
  ds_read_b128 v[88:91], v61 offset:4096
  v_mfma_f32_16x16x32_bf16 v[140:143], v[108:111], a[20:23], v[140:143]
  s_add_u32 s41, s39, 10752
  buffer_load_dword v19, v7, s[12:15], s41 offen sc1
  ds_read_b128 v[92:95], v61 offset:4608
  s_waitcnt lgkmcnt(4)
  v_mfma_f32_16x16x32_bf16 v[112:115], v[64:67], a[24:27], v[112:115]
  v_mfma_f32_16x16x32_bf16 v[116:119], v[64:67], a[28:31], v[116:119]
  ds_read_b128 v[96:99], v62 offset:0
  v_mfma_f32_16x16x32_bf16 v[120:123], v[68:71], a[24:27], v[120:123]
  v_mfma_f32_16x16x32_bf16 v[124:127], v[68:71], a[28:31], v[124:127]
  buffer_load_dwordx4 v[24:27], v63, s[12:15], s39 offen sc1
  ds_read_b128 v[100:103], v62 offset:512
  v_mfma_f32_16x16x32_bf16 v[128:131], v[72:75], a[24:27], v[128:131]
  v_mfma_f32_16x16x32_bf16 v[132:135], v[72:75], a[28:31], v[132:135]
  ds_read_b128 v[104:107], v62 offset:4096
  v_mfma_f32_16x16x32_bf16 v[136:139], v[76:79], a[24:27], v[136:139]
  v_mfma_f32_16x16x32_bf16 v[140:143], v[76:79], a[28:31], v[140:143]
  s_add_u32 s41, s39, 7168
  buffer_load_dwordx4 v[32:35], v63, s[12:15], s41 offen sc1
  ds_read_b128 v[108:111], v62 offset:4608
  s_waitcnt lgkmcnt(4)
  v_mfma_f32_16x16x32_bf16 v[112:115], v[80:83], a[32:35], v[112:115]
  v_mfma_f32_16x16x32_bf16 v[116:119], v[80:83], a[36:39], v[116:119]
  s_lshl_b32 s43, s55, 6
  v_mfma_f32_16x16x32_bf16 v[120:123], v[84:87], a[32:35], v[120:123]
  v_add_u32 v50, s43, v59
  v_mfma_f32_16x16x32_bf16 v[124:127], v[84:87], a[36:39], v[124:127]
  s_lshl_b32 s41, s58, 4
  s_add_u32 s42, s41, s47
  s_add_u32 s41, s41, s46
  buffer_load_dwordx4 a[224:227], v58, s[12:15], s41 offen offset:0 sc1
  v_add_u32 v51, s43, v60
  v_mfma_f32_16x16x32_bf16 v[128:131], v[88:91], a[32:35], v[128:131]
  ds_read_b128 v[64:67], v50 offset:0
  v_mfma_f32_16x16x32_bf16 v[132:135], v[88:91], a[36:39], v[132:135]
  ds_read_b128 v[68:71], v50 offset:512
  v_mfma_f32_16x16x32_bf16 v[136:139], v[92:95], a[32:35], v[136:139]
  ds_read_b128 v[72:75], v50 offset:4096
  v_mfma_f32_16x16x32_bf16 v[140:143], v[92:95], a[36:39], v[140:143]
  buffer_load_dwordx4 a[228:231], v58, s[12:15], s42 offen offset:0 sc1
  ds_read_b128 v[76:79], v50 offset:4608
  s_waitcnt lgkmcnt(4)
  v_mfma_f32_16x16x32_bf16 v[112:115], v[96:99], a[40:43], v[112:115]
  v_mfma_f32_16x16x32_bf16 v[116:119], v[96:99], a[44:47], v[116:119]
  ds_read_b128 v[80:83], v51 offset:0
  v_mfma_f32_16x16x32_bf16 v[120:123], v[100:103], a[40:43], v[120:123]
  v_mfma_f32_16x16x32_bf16 v[124:127], v[100:103], a[44:47], v[124:127]
  s_lshl_b32 s41, s58, 4
  s_add_u32 s42, s41, s47
  s_add_u32 s41, s41, s46
  buffer_load_dwordx4 a[232:235], v58, s[12:15], s41 offen offset:1024 sc1
  ds_read_b128 v[84:87], v51 offset:512
  v_mfma_f32_16x16x32_bf16 v[128:131], v[104:107], a[40:43], v[128:131]
  v_mfma_f32_16x16x32_bf16 v[132:135], v[104:107], a[44:47], v[132:135]
  ds_read_b128 v[88:91], v51 offset:4096
  v_mfma_f32_16x16x32_bf16 v[136:139], v[108:111], a[40:43], v[136:139]
  v_mfma_f32_16x16x32_bf16 v[140:143], v[108:111], a[44:47], v[140:143]
  buffer_load_dwordx4 a[236:239], v58, s[12:15], s42 offen offset:1024 sc1
  ds_read_b128 v[92:95], v51 offset:4608
  s_waitcnt lgkmcnt(4)
  v_mfma_f32_16x16x32_bf16 v[112:115], v[64:67], a[48:51], v[112:115]
  v_mfma_f32_16x16x32_bf16 v[116:119], v[64:67], a[52:55], v[116:119]
  s_lshl_b32 s43, s56, 6
  v_mfma_f32_16x16x32_bf16 v[120:123], v[68:71], a[48:51], v[120:123]
  v_add_u32 v61, s43, v59
  v_mfma_f32_16x16x32_bf16 v[124:127], v[68:71], a[52:55], v[124:127]
  s_lshl_b32 s41, s59, 4
  s_add_u32 s42, s41, s47
  s_add_u32 s41, s41, s46
  buffer_load_dwordx4 a[240:243], v58, s[12:15], s41 offen offset:0 sc1
  v_add_u32 v62, s43, v60
  v_mfma_f32_16x16x32_bf16 v[128:131], v[72:75], a[48:51], v[128:131]
  ds_read_b128 v[96:99], v61 offset:0
  v_mfma_f32_16x16x32_bf16 v[132:135], v[72:75], a[52:55], v[132:135]
  ds_read_b128 v[100:103], v61 offset:512
  v_mfma_f32_16x16x32_bf16 v[136:139], v[76:79], a[48:51], v[136:139]
  ds_read_b128 v[104:107], v61 offset:4096
  v_mfma_f32_16x16x32_bf16 v[140:143], v[76:79], a[52:55], v[140:143]
  buffer_load_dwordx4 a[244:247], v58, s[12:15], s42 offen offset:0 sc1
  ds_read_b128 v[108:111], v61 offset:4608
  s_waitcnt lgkmcnt(4)
  v_mfma_f32_16x16x32_bf16 v[112:115], v[80:83], a[56:59], v[112:115]
  v_mfma_f32_16x16x32_bf16 v[116:119], v[80:83], a[60:63], v[116:119]
  ds_read_b128 v[64:67], v62 offset:0
  v_mfma_f32_16x16x32_bf16 v[120:123], v[84:87], a[56:59], v[120:123]
  v_mfma_f32_16x16x32_bf16 v[124:127], v[84:87], a[60:63], v[124:127]
  s_lshl_b32 s41, s59, 4
  s_add_u32 s42, s41, s47
  s_add_u32 s41, s41, s46
  buffer_load_dwordx4 a[248:251], v58, s[12:15], s41 offen offset:1024 sc1
  ds_read_b128 v[68:71], v62 offset:512
  v_mfma_f32_16x16x32_bf16 v[128:131], v[88:91], a[56:59], v[128:131]
  v_mfma_f32_16x16x32_bf16 v[132:135], v[88:91], a[60:63], v[132:135]
  ds_read_b128 v[72:75], v62 offset:4096
  v_mfma_f32_16x16x32_bf16 v[136:139], v[92:95], a[56:59], v[136:139]
  v_mfma_f32_16x16x32_bf16 v[140:143], v[92:95], a[60:63], v[140:143]
  buffer_load_dwordx4 a[252:255], v58, s[12:15], s42 offen offset:1024 sc1
  ds_read_b128 v[76:79], v62 offset:4608
  s_waitcnt lgkmcnt(4)
  v_mfma_f32_16x16x32_bf16 v[112:115], v[96:99], a[64:67], v[112:115]
  v_mfma_f32_16x16x32_bf16 v[116:119], v[96:99], a[68:71], v[116:119]
  s_lshl_b32 s43, s57, 6
  v_mfma_f32_16x16x32_bf16 v[120:123], v[100:103], a[64:67], v[120:123]
  v_add_u32 v50, s43, v59
  v_mfma_f32_16x16x32_bf16 v[124:127], v[100:103], a[68:71], v[124:127]
  v_add_u32 v51, s43, v60
  v_mfma_f32_16x16x32_bf16 v[128:131], v[104:107], a[64:67], v[128:131]
  ds_read_b128 v[80:83], v50 offset:0
  v_mfma_f32_16x16x32_bf16 v[132:135], v[104:107], a[68:71], v[132:135]
  ds_read_b128 v[84:87], v50 offset:512
  v_mfma_f32_16x16x32_bf16 v[136:139], v[108:111], a[64:67], v[136:139]
  ds_read_b128 v[88:91], v50 offset:4096
  v_mfma_f32_16x16x32_bf16 v[140:143], v[108:111], a[68:71], v[140:143]
  ds_read_b128 v[92:95], v50 offset:4608
  s_waitcnt lgkmcnt(4)
  v_mfma_f32_16x16x32_bf16 v[112:115], v[64:67], a[72:75], v[112:115]
  v_mfma_f32_16x16x32_bf16 v[116:119], v[64:67], a[76:79], v[116:119]
  ds_read_b128 v[96:99], v51 offset:0
  v_mfma_f32_16x16x32_bf16 v[120:123], v[68:71], a[72:75], v[120:123]
  v_mfma_f32_16x16x32_bf16 v[124:127], v[68:71], a[76:79], v[124:127]
  ds_read_b128 v[100:103], v51 offset:512
  v_mfma_f32_16x16x32_bf16 v[128:131], v[72:75], a[72:75], v[128:131]
  v_mfma_f32_16x16x32_bf16 v[132:135], v[72:75], a[76:79], v[132:135]
  ds_read_b128 v[104:107], v51 offset:4096
  v_mfma_f32_16x16x32_bf16 v[136:139], v[76:79], a[72:75], v[136:139]
  v_mfma_f32_16x16x32_bf16 v[140:143], v[76:79], a[76:79], v[140:143]
  ds_read_b128 v[108:111], v51 offset:4608
  s_waitcnt lgkmcnt(4)
  v_mfma_f32_16x16x32_bf16 v[112:115], v[80:83], a[80:83], v[112:115]
  v_mfma_f32_16x16x32_bf16 v[116:119], v[80:83], a[84:87], v[116:119]
  s_lshl_b32 s43, s58, 6
  v_mfma_f32_16x16x32_bf16 v[120:123], v[84:87], a[80:83], v[120:123]
  v_add_u32 v61, s43, v59
  v_mfma_f32_16x16x32_bf16 v[124:127], v[84:87], a[84:87], v[124:127]
  v_add_u32 v62, s43, v60
  v_mfma_f32_16x16x32_bf16 v[128:131], v[88:91], a[80:83], v[128:131]
  ds_read_b128 v[64:67], v61 offset:0
  v_mfma_f32_16x16x32_bf16 v[132:135], v[88:91], a[84:87], v[132:135]
  ds_read_b128 v[68:71], v61 offset:512
  v_mfma_f32_16x16x32_bf16 v[136:139], v[92:95], a[80:83], v[136:139]
  ds_read_b128 v[72:75], v61 offset:4096
  v_mfma_f32_16x16x32_bf16 v[140:143], v[92:95], a[84:87], v[140:143]
  ds_read_b128 v[76:79], v61 offset:4608
  s_waitcnt lgkmcnt(4)
  v_mfma_f32_16x16x32_bf16 v[112:115], v[96:99], a[88:91], v[112:115]
  v_mfma_f32_16x16x32_bf16 v[116:119], v[96:99], a[92:95], v[116:119]
  ds_read_b128 v[80:83], v62 offset:0
  v_mfma_f32_16x16x32_bf16 v[120:123], v[100:103], a[88:91], v[120:123]
  v_mfma_f32_16x16x32_bf16 v[124:127], v[100:103], a[92:95], v[124:127]
  ds_read_b128 v[84:87], v62 offset:512
  v_mfma_f32_16x16x32_bf16 v[128:131], v[104:107], a[88:91], v[128:131]
  v_mfma_f32_16x16x32_bf16 v[132:135], v[104:107], a[92:95], v[132:135]
  ds_read_b128 v[88:91], v62 offset:4096
  v_mfma_f32_16x16x32_bf16 v[136:139], v[108:111], a[88:91], v[136:139]
  v_mfma_f32_16x16x32_bf16 v[140:143], v[108:111], a[92:95], v[140:143]
  ds_read_b128 v[92:95], v62 offset:4608
  s_waitcnt lgkmcnt(4)
  v_mfma_f32_16x16x32_bf16 v[112:115], v[64:67], a[96:99], v[112:115]
  v_mfma_f32_16x16x32_bf16 v[116:119], v[64:67], a[100:103], v[116:119]
  s_lshl_b32 s43, s59, 6
  v_mfma_f32_16x16x32_bf16 v[120:123], v[68:71], a[96:99], v[120:123]
  v_add_u32 v50, s43, v59
  v_mfma_f32_16x16x32_bf16 v[124:127], v[68:71], a[100:103], v[124:127]
  v_add_u32 v51, s43, v60
  v_mfma_f32_16x16x32_bf16 v[128:131], v[72:75], a[96:99], v[128:131]
  ds_read_b128 v[96:99], v50 offset:0
  v_mfma_f32_16x16x32_bf16 v[132:135], v[72:75], a[100:103], v[132:135]
  ds_read_b128 v[100:103], v50 offset:512
  v_mfma_f32_16x16x32_bf16 v[136:139], v[76:79], a[96:99], v[136:139]
  ds_read_b128 v[104:107], v50 offset:4096
  v_mfma_f32_16x16x32_bf16 v[140:143], v[76:79], a[100:103], v[140:143]
  ds_read_b128 v[108:111], v50 offset:4608
  s_waitcnt lgkmcnt(4)
  v_mfma_f32_16x16x32_bf16 v[112:115], v[80:83], a[104:107], v[112:115]
  v_mfma_f32_16x16x32_bf16 v[116:119], v[80:83], a[108:111], v[116:119]
  ds_read_b128 v[64:67], v51 offset:0
  v_mfma_f32_16x16x32_bf16 v[120:123], v[84:87], a[104:107], v[120:123]
  v_mfma_f32_16x16x32_bf16 v[124:127], v[84:87], a[108:111], v[124:127]
  ds_read_b128 v[68:71], v51 offset:512
  v_mfma_f32_16x16x32_bf16 v[128:131], v[88:91], a[104:107], v[128:131]
  v_mfma_f32_16x16x32_bf16 v[132:135], v[88:91], a[108:111], v[132:135]
  ds_read_b128 v[72:75], v51 offset:4096
  v_mfma_f32_16x16x32_bf16 v[136:139], v[92:95], a[104:107], v[136:139]
  v_mfma_f32_16x16x32_bf16 v[140:143], v[92:95], a[108:111], v[140:143]
  ds_read_b128 v[76:79], v51 offset:4608
  s_waitcnt lgkmcnt(4)
  v_mfma_f32_16x16x32_bf16 v[112:115], v[96:99], a[112:115], v[112:115]
  v_mfma_f32_16x16x32_bf16 v[116:119], v[96:99], a[116:119], v[116:119]
  v_mfma_f32_16x16x32_bf16 v[120:123], v[100:103], a[112:115], v[120:123]
  v_mfma_f32_16x16x32_bf16 v[124:127], v[100:103], a[116:119], v[124:127]
  v_mfma_f32_16x16x32_bf16 v[128:131], v[104:107], a[112:115], v[128:131]
  v_mfma_f32_16x16x32_bf16 v[132:135], v[104:107], a[116:119], v[132:135]
  v_mfma_f32_16x16x32_bf16 v[136:139], v[108:111], a[112:115], v[136:139]
  v_mfma_f32_16x16x32_bf16 v[140:143], v[108:111], a[116:119], v[140:143]
  s_waitcnt lgkmcnt(0)
  v_mfma_f32_16x16x32_bf16 v[112:115], v[64:67], a[120:123], v[112:115]
  v_mfma_f32_16x16x32_bf16 v[116:119], v[64:67], a[124:127], v[116:119]
  v_mfma_f32_16x16x32_bf16 v[120:123], v[68:71], a[120:123], v[120:123]
  v_mfma_f32_16x16x32_bf16 v[124:127], v[68:71], a[124:127], v[124:127]
  v_mfma_f32_16x16x32_bf16 v[128:131], v[72:75], a[120:123], v[128:131]
  v_mfma_f32_16x16x32_bf16 v[132:135], v[72:75], a[124:127], v[132:135]
  v_mfma_f32_16x16x32_bf16 v[136:139], v[76:79], a[120:123], v[136:139]
  v_mfma_f32_16x16x32_bf16 v[140:143], v[76:79], a[124:127], v[140:143]
  v_lshrrev_b32 v4, 5, v1
  v_and_b32 v5, 31, v1
  v_lshlrev_b32 v5, 7, v5
  v_lshl_add_u32 v4, v4, 12, v5
  s_lshl_b32 s41, s29, 2
  s_add_u32 s41, s41, s3
  s_lshl_b32 s41, s41, 13
  s_lshl_b32 s42, s28, 20
  s_add_u32 s41, s41, s42
  buffer_load_dword v52, v4, s[16:19], s41 offen
  v_lshlrev_b32 v4, 5, v2
  v_add_u32 v4, 145408, v4
  ds_read_b128 v[160:163], v4 offset:0
  ds_read_b128 v[176:179], v4 offset:256
  ds_read_b128 v[164:167], v4 offset:16
  ds_read_b128 v[180:183], v4 offset:272
  ds_read_b128 v[168:171], v4 offset:128
  ds_read_b128 v[184:187], v4 offset:384
  ds_read_b128 v[172:175], v4 offset:144
  ds_read_b128 v[188:191], v4 offset:400
  s_waitcnt vmcnt(9)
  s_waitcnt lgkmcnt(0)
  v_pk_fma_f32 v[192:193], v[176:177], v[16:17], v[18:19] op_sel:[0,0,0] op_sel_hi:[1,0,0] neg_lo:[1,0,0] neg_hi:[1,0,0]
  v_pk_fma_f32 v[194:195], v[178:179], v[16:17], v[18:19] op_sel:[0,0,0] op_sel_hi:[1,0,0] neg_lo:[1,0,0] neg_hi:[1,0,0]
  v_pk_fma_f32 v[196:197], v[180:181], v[16:17], v[18:19] op_sel:[0,0,0] op_sel_hi:[1,0,0] neg_lo:[1,0,0] neg_hi:[1,0,0]
  v_pk_fma_f32 v[198:199], v[182:183], v[16:17], v[18:19] op_sel:[0,0,0] op_sel_hi:[1,0,0] neg_lo:[1,0,0] neg_hi:[1,0,0]
  v_pk_fma_f32 v[200:201], v[184:185], v[16:17], v[18:19] op_sel:[0,0,0] op_sel_hi:[1,0,0] neg_lo:[1,0,0] neg_hi:[1,0,0]
  v_pk_fma_f32 v[202:203], v[186:187], v[16:17], v[18:19] op_sel:[0,0,0] op_sel_hi:[1,0,0] neg_lo:[1,0,0] neg_hi:[1,0,0]
  v_pk_fma_f32 v[204:205], v[188:189], v[16:17], v[18:19] op_sel:[0,0,0] op_sel_hi:[1,0,0] neg_lo:[1,0,0] neg_hi:[1,0,0]
  v_pk_fma_f32 v[206:207], v[190:191], v[16:17], v[18:19] op_sel:[0,0,0] op_sel_hi:[1,0,0] neg_lo:[1,0,0] neg_hi:[1,0,0]
  v_pk_fma_f32 v[112:113], v[112:113], v[160:161], v[192:193]
  v_pk_fma_f32 v[114:115], v[114:115], v[162:163], v[194:195]
  v_pk_fma_f32 v[120:121], v[120:121], v[164:165], v[196:197]
  v_pk_fma_f32 v[122:123], v[122:123], v[166:167], v[198:199]
  v_pk_fma_f32 v[128:129], v[128:129], v[168:169], v[200:201]
  v_pk_fma_f32 v[130:131], v[130:131], v[170:171], v[202:203]
  v_pk_fma_f32 v[136:137], v[136:137], v[172:173], v[204:205]
  v_pk_fma_f32 v[138:139], v[138:139], v[174:175], v[206:207]
  v_pk_mul_f32 v[192:193], v[112:113], v[112:113]
  v_pk_mul_f32 v[194:195], v[114:115], v[114:115]
  v_pk_mul_f32 v[196:197], v[120:121], v[120:121]
  v_pk_mul_f32 v[198:199], v[122:123], v[122:123]
  v_pk_mul_f32 v[200:201], v[128:129], v[128:129]
  v_pk_mul_f32 v[202:203], v[130:131], v[130:131]
  v_pk_mul_f32 v[204:205], v[136:137], v[136:137]
  v_pk_mul_f32 v[206:207], v[138:139], v[138:139]
  v_pk_fma_f32 v[192:193], v[192:193], s[50:51], v[54:55]
  v_pk_fma_f32 v[194:195], v[194:195], s[50:51], v[54:55]
  v_pk_fma_f32 v[196:197], v[196:197], s[50:51], v[54:55]
  v_pk_fma_f32 v[198:199], v[198:199], s[50:51], v[54:55]
  v_pk_fma_f32 v[200:201], v[200:201], s[50:51], v[54:55]
  v_pk_fma_f32 v[202:203], v[202:203], s[50:51], v[54:55]
  v_pk_fma_f32 v[204:205], v[204:205], s[50:51], v[54:55]
  v_pk_fma_f32 v[206:207], v[206:207], s[50:51], v[54:55]
  v_pk_mul_f32 v[192:193], v[192:193], v[112:113]
  v_pk_mul_f32 v[194:195], v[194:195], v[114:115]
  v_pk_mul_f32 v[196:197], v[196:197], v[120:121]
  v_pk_mul_f32 v[198:199], v[198:199], v[122:123]
  v_pk_mul_f32 v[200:201], v[200:201], v[128:129]
  v_pk_mul_f32 v[202:203], v[202:203], v[130:131]
  v_pk_mul_f32 v[204:205], v[204:205], v[136:137]
  v_pk_mul_f32 v[206:207], v[206:207], v[138:139]
  v_exp_f32 v192, v192
  v_exp_f32 v193, v193
  v_exp_f32 v194, v194
  v_exp_f32 v195, v195
  v_exp_f32 v196, v196
  v_exp_f32 v197, v197
  v_exp_f32 v198, v198
  v_exp_f32 v199, v199
  v_exp_f32 v200, v200
  v_exp_f32 v201, v201
  v_exp_f32 v202, v202
  v_exp_f32 v203, v203
  v_exp_f32 v204, v204
  v_exp_f32 v205, v205
  v_exp_f32 v206, v206
  v_exp_f32 v207, v207
  v_pk_add_f32 v[192:193], v[192:193], 1.0 op_sel_hi:[1,0]
  v_pk_add_f32 v[194:195], v[194:195], 1.0 op_sel_hi:[1,0]
  v_pk_add_f32 v[196:197], v[196:197], 1.0 op_sel_hi:[1,0]
  v_pk_add_f32 v[198:199], v[198:199], 1.0 op_sel_hi:[1,0]
  v_pk_add_f32 v[200:201], v[200:201], 1.0 op_sel_hi:[1,0]
  v_pk_add_f32 v[202:203], v[202:203], 1.0 op_sel_hi:[1,0]
  v_pk_add_f32 v[204:205], v[204:205], 1.0 op_sel_hi:[1,0]
  v_pk_add_f32 v[206:207], v[206:207], 1.0 op_sel_hi:[1,0]
  v_rcp_f32 v192, v192
  v_rcp_f32 v193, v193
  v_rcp_f32 v194, v194
  v_rcp_f32 v195, v195
  v_rcp_f32 v196, v196
  v_rcp_f32 v197, v197
  v_rcp_f32 v198, v198
  v_rcp_f32 v199, v199
  v_rcp_f32 v200, v200
  v_rcp_f32 v201, v201
  v_rcp_f32 v202, v202
  v_rcp_f32 v203, v203
  v_rcp_f32 v204, v204
  v_rcp_f32 v205, v205
  v_rcp_f32 v206, v206
  v_rcp_f32 v207, v207
  v_pk_mul_f32 v[112:113], v[112:113], v[192:193]
  v_pk_mul_f32 v[114:115], v[114:115], v[194:195]
  v_pk_mul_f32 v[120:121], v[120:121], v[196:197]
  v_pk_mul_f32 v[122:123], v[122:123], v[198:199]
  v_pk_mul_f32 v[128:129], v[128:129], v[200:201]
  v_pk_mul_f32 v[130:131], v[130:131], v[202:203]
  v_pk_mul_f32 v[136:137], v[136:137], v[204:205]
  v_pk_mul_f32 v[138:139], v[138:139], v[206:207]
  v_cvt_pk_bf16_f32 v144, v112, v113
  v_cvt_pk_bf16_f32 v145, v114, v115
  v_cvt_pk_bf16_f32 v146, v120, v121
  v_cvt_pk_bf16_f32 v147, v122, v123
  v_cvt_pk_bf16_f32 v148, v128, v129
  v_cvt_pk_bf16_f32 v149, v130, v131
  v_cvt_pk_bf16_f32 v150, v136, v137
  v_cvt_pk_bf16_f32 v151, v138, v139
  v_pk_fma_f32 v[192:193], v[176:177], v[16:17], v[18:19] op_sel:[0,1,1] op_sel_hi:[1,1,1] neg_lo:[1,0,0] neg_hi:[1,0,0]
  v_pk_fma_f32 v[194:195], v[178:179], v[16:17], v[18:19] op_sel:[0,1,1] op_sel_hi:[1,1,1] neg_lo:[1,0,0] neg_hi:[1,0,0]
  v_pk_fma_f32 v[196:197], v[180:181], v[16:17], v[18:19] op_sel:[0,1,1] op_sel_hi:[1,1,1] neg_lo:[1,0,0] neg_hi:[1,0,0]
  v_pk_fma_f32 v[198:199], v[182:183], v[16:17], v[18:19] op_sel:[0,1,1] op_sel_hi:[1,1,1] neg_lo:[1,0,0] neg_hi:[1,0,0]
  v_pk_fma_f32 v[200:201], v[184:185], v[16:17], v[18:19] op_sel:[0,1,1] op_sel_hi:[1,1,1] neg_lo:[1,0,0] neg_hi:[1,0,0]
  v_pk_fma_f32 v[202:203], v[186:187], v[16:17], v[18:19] op_sel:[0,1,1] op_sel_hi:[1,1,1] neg_lo:[1,0,0] neg_hi:[1,0,0]
  v_pk_fma_f32 v[204:205], v[188:189], v[16:17], v[18:19] op_sel:[0,1,1] op_sel_hi:[1,1,1] neg_lo:[1,0,0] neg_hi:[1,0,0]
  v_pk_fma_f32 v[206:207], v[190:191], v[16:17], v[18:19] op_sel:[0,1,1] op_sel_hi:[1,1,1] neg_lo:[1,0,0] neg_hi:[1,0,0]
  v_pk_fma_f32 v[116:117], v[116:117], v[160:161], v[192:193]
  v_pk_fma_f32 v[118:119], v[118:119], v[162:163], v[194:195]
  v_pk_fma_f32 v[124:125], v[124:125], v[164:165], v[196:197]
  v_pk_fma_f32 v[126:127], v[126:127], v[166:167], v[198:199]
  v_pk_fma_f32 v[132:133], v[132:133], v[168:169], v[200:201]
  v_pk_fma_f32 v[134:135], v[134:135], v[170:171], v[202:203]
  v_pk_fma_f32 v[140:141], v[140:141], v[172:173], v[204:205]
  v_pk_fma_f32 v[142:143], v[142:143], v[174:175], v[206:207]
  v_pk_mul_f32 v[192:193], v[116:117], v[116:117]
  v_pk_mul_f32 v[194:195], v[118:119], v[118:119]
  v_pk_mul_f32 v[196:197], v[124:125], v[124:125]
  v_pk_mul_f32 v[198:199], v[126:127], v[126:127]
  v_pk_mul_f32 v[200:201], v[132:133], v[132:133]
  v_pk_mul_f32 v[202:203], v[134:135], v[134:135]
  v_pk_mul_f32 v[204:205], v[140:141], v[140:141]
  v_pk_mul_f32 v[206:207], v[142:143], v[142:143]
  v_pk_fma_f32 v[192:193], v[192:193], s[50:51], v[54:55]
  v_pk_fma_f32 v[194:195], v[194:195], s[50:51], v[54:55]
  v_pk_fma_f32 v[196:197], v[196:197], s[50:51], v[54:55]
  v_pk_fma_f32 v[198:199], v[198:199], s[50:51], v[54:55]
  v_pk_fma_f32 v[200:201], v[200:201], s[50:51], v[54:55]
  v_pk_fma_f32 v[202:203], v[202:203], s[50:51], v[54:55]
  v_pk_fma_f32 v[204:205], v[204:205], s[50:51], v[54:55]
  v_pk_fma_f32 v[206:207], v[206:207], s[50:51], v[54:55]
  v_pk_mul_f32 v[192:193], v[192:193], v[116:117]
  v_pk_mul_f32 v[194:195], v[194:195], v[118:119]
  v_pk_mul_f32 v[196:197], v[196:197], v[124:125]
  v_pk_mul_f32 v[198:199], v[198:199], v[126:127]
  v_pk_mul_f32 v[200:201], v[200:201], v[132:133]
  v_pk_mul_f32 v[202:203], v[202:203], v[134:135]
  v_pk_mul_f32 v[204:205], v[204:205], v[140:141]
  v_pk_mul_f32 v[206:207], v[206:207], v[142:143]
  v_exp_f32 v192, v192
  v_exp_f32 v193, v193
  v_exp_f32 v194, v194
  v_exp_f32 v195, v195
  v_exp_f32 v196, v196
  v_exp_f32 v197, v197
  v_exp_f32 v198, v198
  v_exp_f32 v199, v199
  v_exp_f32 v200, v200
  v_exp_f32 v201, v201
  v_exp_f32 v202, v202
  v_exp_f32 v203, v203
  v_exp_f32 v204, v204
  v_exp_f32 v205, v205
  v_exp_f32 v206, v206
  v_exp_f32 v207, v207
  v_pk_add_f32 v[192:193], v[192:193], 1.0 op_sel_hi:[1,0]
  v_pk_add_f32 v[194:195], v[194:195], 1.0 op_sel_hi:[1,0]
  v_pk_add_f32 v[196:197], v[196:197], 1.0 op_sel_hi:[1,0]
  v_pk_add_f32 v[198:199], v[198:199], 1.0 op_sel_hi:[1,0]
  v_pk_add_f32 v[200:201], v[200:201], 1.0 op_sel_hi:[1,0]
  v_pk_add_f32 v[202:203], v[202:203], 1.0 op_sel_hi:[1,0]
  v_pk_add_f32 v[204:205], v[204:205], 1.0 op_sel_hi:[1,0]
  v_pk_add_f32 v[206:207], v[206:207], 1.0 op_sel_hi:[1,0]
  v_rcp_f32 v192, v192
  v_rcp_f32 v193, v193
  v_rcp_f32 v194, v194
  v_rcp_f32 v195, v195
  v_rcp_f32 v196, v196
  v_rcp_f32 v197, v197
  v_rcp_f32 v198, v198
  v_rcp_f32 v199, v199
  v_rcp_f32 v200, v200
  v_rcp_f32 v201, v201
  v_rcp_f32 v202, v202
  v_rcp_f32 v203, v203
  v_rcp_f32 v204, v204
  v_rcp_f32 v205, v205
  v_rcp_f32 v206, v206
  v_rcp_f32 v207, v207
  v_pk_mul_f32 v[116:117], v[116:117], v[192:193]
  v_pk_mul_f32 v[118:119], v[118:119], v[194:195]
  v_pk_mul_f32 v[124:125], v[124:125], v[196:197]
  v_pk_mul_f32 v[126:127], v[126:127], v[198:199]
  v_pk_mul_f32 v[132:133], v[132:133], v[200:201]
  v_pk_mul_f32 v[134:135], v[134:135], v[202:203]
  v_pk_mul_f32 v[140:141], v[140:141], v[204:205]
  v_pk_mul_f32 v[142:143], v[142:143], v[206:207]
  v_cvt_pk_bf16_f32 v152, v116, v117
  v_cvt_pk_bf16_f32 v153, v118, v119
  v_cvt_pk_bf16_f32 v154, v124, v125
  v_cvt_pk_bf16_f32 v155, v126, v127
  v_cvt_pk_bf16_f32 v156, v132, v133
  v_cvt_pk_bf16_f32 v157, v134, v135
  v_cvt_pk_bf16_f32 v158, v140, v141
  v_cvt_pk_bf16_f32 v159, v142, v143
  v_lshlrev_b32 v240, 16, v144
  v_and_b32 v241, 0xffff0000, v144
  v_lshlrev_b32 v242, 16, v145
  v_and_b32 v243, 0xffff0000, v145
  v_lshlrev_b32 v244, 16, v146
  v_and_b32 v245, 0xffff0000, v146
  v_lshlrev_b32 v246, 16, v147
  v_and_b32 v247, 0xffff0000, v147
  v_lshlrev_b32 v248, 16, v148
  v_and_b32 v249, 0xffff0000, v148
  v_lshlrev_b32 v250, 16, v149
  v_and_b32 v251, 0xffff0000, v149
  v_lshlrev_b32 v252, 16, v150
  v_and_b32 v253, 0xffff0000, v150
  v_lshlrev_b32 v254, 16, v151
  v_and_b32 v255, 0xffff0000, v151
  v_pk_mul_f32 v[224:225], v[240:241], v[240:241]
  v_mov_b32 v208, v240
  v_mov_b32 v209, v241
  v_pk_mul_f32 v[226:227], v[242:243], v[242:243]
  v_mov_b32 v210, v242
  v_mov_b32 v211, v243
  v_pk_mul_f32 v[228:229], v[244:245], v[244:245]
  v_mov_b32 v212, v244
  v_mov_b32 v213, v245
  v_pk_mul_f32 v[230:231], v[246:247], v[246:247]
  v_mov_b32 v214, v246
  v_mov_b32 v215, v247
  v_pk_mul_f32 v[232:233], v[248:249], v[248:249]
  v_mov_b32 v216, v248
  v_mov_b32 v217, v249
  v_pk_mul_f32 v[234:235], v[250:251], v[250:251]
  v_mov_b32 v218, v250
  v_mov_b32 v219, v251
  v_pk_mul_f32 v[236:237], v[252:253], v[252:253]
  v_mov_b32 v220, v252
  v_mov_b32 v221, v253
  v_pk_mul_f32 v[238:239], v[254:255], v[254:255]
  v_mov_b32 v222, v254
  v_mov_b32 v223, v255
  v_lshlrev_b32 v240, 16, v152
  v_and_b32 v241, 0xffff0000, v152
  v_lshlrev_b32 v242, 16, v153
  v_and_b32 v243, 0xffff0000, v153
  v_lshlrev_b32 v244, 16, v154
  v_and_b32 v245, 0xffff0000, v154
  v_lshlrev_b32 v246, 16, v155
  v_and_b32 v247, 0xffff0000, v155
  v_lshlrev_b32 v248, 16, v156
  v_and_b32 v249, 0xffff0000, v156
  v_lshlrev_b32 v250, 16, v157
  v_and_b32 v251, 0xffff0000, v157
  v_lshlrev_b32 v252, 16, v158
  v_and_b32 v253, 0xffff0000, v158
  v_lshlrev_b32 v254, 16, v159
  v_and_b32 v255, 0xffff0000, v159
  v_pk_add_f32 v[208:209], v[208:209], v[240:241]
  v_pk_fma_f32 v[224:225], v[240:241], v[240:241], v[224:225]
  v_pk_add_f32 v[210:211], v[210:211], v[242:243]
  v_pk_fma_f32 v[226:227], v[242:243], v[242:243], v[226:227]
  v_pk_add_f32 v[212:213], v[212:213], v[244:245]
  v_pk_fma_f32 v[228:229], v[244:245], v[244:245], v[228:229]
  v_pk_add_f32 v[214:215], v[214:215], v[246:247]
  v_pk_fma_f32 v[230:231], v[246:247], v[246:247], v[230:231]
  v_pk_add_f32 v[216:217], v[216:217], v[248:249]
  v_pk_fma_f32 v[232:233], v[248:249], v[248:249], v[232:233]
  v_pk_add_f32 v[218:219], v[218:219], v[250:251]
  v_pk_fma_f32 v[234:235], v[250:251], v[250:251], v[234:235]
  v_pk_add_f32 v[220:221], v[220:221], v[252:253]
  v_pk_fma_f32 v[236:237], v[252:253], v[252:253], v[236:237]
  v_pk_add_f32 v[222:223], v[222:223], v[254:255]
  v_pk_fma_f32 v[238:239], v[254:255], v[254:255], v[238:239]
  v_cndmask_b32 v240, v216, v208, s[20:21]
  v_cndmask_b32 v241, v217, v209, s[20:21]
  v_cndmask_b32 v242, v218, v210, s[20:21]
  v_cndmask_b32 v243, v219, v211, s[20:21]
  v_cndmask_b32 v244, v220, v212, s[20:21]
  v_cndmask_b32 v245, v221, v213, s[20:21]
  v_cndmask_b32 v246, v222, v214, s[20:21]
  v_cndmask_b32 v247, v223, v215, s[20:21]
  v_cndmask_b32 v208, v208, v216, s[20:21]
  v_cndmask_b32 v209, v209, v217, s[20:21]
  v_cndmask_b32 v210, v210, v218, s[20:21]
  v_cndmask_b32 v211, v211, v219, s[20:21]
  v_cndmask_b32 v212, v212, v220, s[20:21]
  v_cndmask_b32 v213, v213, v221, s[20:21]
  v_cndmask_b32 v214, v214, v222, s[20:21]
  v_cndmask_b32 v215, v215, v223, s[20:21]
  v_cndmask_b32 v248, v232, v224, s[20:21]
  v_cndmask_b32 v249, v233, v225, s[20:21]
  v_cndmask_b32 v250, v234, v226, s[20:21]
  v_cndmask_b32 v251, v235, v227, s[20:21]
  v_cndmask_b32 v252, v236, v228, s[20:21]
  v_cndmask_b32 v253, v237, v229, s[20:21]
  v_cndmask_b32 v254, v238, v230, s[20:21]
  v_cndmask_b32 v255, v239, v231, s[20:21]
  v_cndmask_b32 v224, v224, v232, s[20:21]
  v_cndmask_b32 v225, v225, v233, s[20:21]
  v_cndmask_b32 v226, v226, v234, s[20:21]
  v_cndmask_b32 v227, v227, v235, s[20:21]
  v_cndmask_b32 v228, v228, v236, s[20:21]
  v_cndmask_b32 v229, v229, v237, s[20:21]
  v_cndmask_b32 v230, v230, v238, s[20:21]
  v_cndmask_b32 v231, v231, v239, s[20:21]
  v_add_f32 v208, v240, v208 row_mirror row_mask:0xf bank_mask:0xf
  v_add_f32 v209, v241, v209 row_mirror row_mask:0xf bank_mask:0xf
  v_add_f32 v210, v242, v210 row_mirror row_mask:0xf bank_mask:0xf
  v_add_f32 v211, v243, v211 row_mirror row_mask:0xf bank_mask:0xf
  v_add_f32 v212, v244, v212 row_mirror row_mask:0xf bank_mask:0xf
  v_add_f32 v213, v245, v213 row_mirror row_mask:0xf bank_mask:0xf
  v_add_f32 v214, v246, v214 row_mirror row_mask:0xf bank_mask:0xf
  v_add_f32 v215, v247, v215 row_mirror row_mask:0xf bank_mask:0xf
  v_add_f32 v224, v248, v224 row_mirror row_mask:0xf bank_mask:0xf
  v_add_f32 v225, v249, v225 row_mirror row_mask:0xf bank_mask:0xf
  v_add_f32 v226, v250, v226 row_mirror row_mask:0xf bank_mask:0xf
  v_add_f32 v227, v251, v227 row_mirror row_mask:0xf bank_mask:0xf
  v_add_f32 v228, v252, v228 row_mirror row_mask:0xf bank_mask:0xf
  v_add_f32 v229, v253, v229 row_mirror row_mask:0xf bank_mask:0xf
  v_add_f32 v230, v254, v230 row_mirror row_mask:0xf bank_mask:0xf
  v_add_f32 v231, v255, v231 row_mirror row_mask:0xf bank_mask:0xf
  v_cndmask_b32 v240, v212, v208, s[22:23]
  v_cndmask_b32 v241, v213, v209, s[22:23]
  v_cndmask_b32 v242, v214, v210, s[22:23]
  v_cndmask_b32 v243, v215, v211, s[22:23]
  v_cndmask_b32 v208, v208, v212, s[22:23]
  v_cndmask_b32 v209, v209, v213, s[22:23]
  v_cndmask_b32 v210, v210, v214, s[22:23]
  v_cndmask_b32 v211, v211, v215, s[22:23]
  v_cndmask_b32 v248, v228, v224, s[22:23]
  v_cndmask_b32 v249, v229, v225, s[22:23]
  v_cndmask_b32 v250, v230, v226, s[22:23]
  v_cndmask_b32 v251, v231, v227, s[22:23]
  v_cndmask_b32 v224, v224, v228, s[22:23]
  v_cndmask_b32 v225, v225, v229, s[22:23]
  v_cndmask_b32 v226, v226, v230, s[22:23]
  v_cndmask_b32 v227, v227, v231, s[22:23]
  v_add_f32 v208, v240, v208 row_half_mirror row_mask:0xf bank_mask:0xf
  v_add_f32 v209, v241, v209 row_half_mirror row_mask:0xf bank_mask:0xf
  v_add_f32 v210, v242, v210 row_half_mirror row_mask:0xf bank_mask:0xf
  v_add_f32 v211, v243, v211 row_half_mirror row_mask:0xf bank_mask:0xf
  v_add_f32 v224, v248, v224 row_half_mirror row_mask:0xf bank_mask:0xf
  v_add_f32 v225, v249, v225 row_half_mirror row_mask:0xf bank_mask:0xf
  v_add_f32 v226, v250, v226 row_half_mirror row_mask:0xf bank_mask:0xf
  v_add_f32 v227, v251, v227 row_half_mirror row_mask:0xf bank_mask:0xf
  v_cndmask_b32 v240, v210, v208, s[26:27]
  v_cndmask_b32 v241, v211, v209, s[26:27]
  v_cndmask_b32 v208, v208, v210, s[26:27]
  v_cndmask_b32 v209, v209, v211, s[26:27]
  v_cndmask_b32 v248, v226, v224, s[26:27]
  v_cndmask_b32 v249, v227, v225, s[26:27]
  v_cndmask_b32 v224, v224, v226, s[26:27]
  v_cndmask_b32 v225, v225, v227, s[26:27]
  v_add_f32 v208, v240, v208 quad_perm:[3,2,1,0] row_mask:0xf bank_mask:0xf
  v_add_f32 v209, v241, v209 quad_perm:[3,2,1,0] row_mask:0xf bank_mask:0xf
  v_add_f32 v224, v248, v224 quad_perm:[3,2,1,0] row_mask:0xf bank_mask:0xf
  v_add_f32 v225, v249, v225 quad_perm:[3,2,1,0] row_mask:0xf bank_mask:0xf
  v_cndmask_b32 v240, v209, v208, s[44:45]
  v_cndmask_b32 v208, v208, v209, s[44:45]
  v_cndmask_b32 v248, v225, v224, s[44:45]
  v_cndmask_b32 v224, v224, v225, s[44:45]
  v_add_f32 v208, v240, v208 quad_perm:[1,0,3,2] row_mask:0xf bank_mask:0xf
  s_nop 0
  v_add_f32 v224, v248, v224 quad_perm:[1,0,3,2] row_mask:0xf bank_mask:0xf
  v_lshrrev_b32 v4, 3, v3
  v_lshlrev_b32 v4, 5, v4
  v_lshl_add_u32 v4, v2, 3, v4
  v_and_b32 v5, 7, v3
  v_add_u32 v4, v4, v5
  v_lshlrev_b32 v4, 3, v4
  s_lshl_b32 s41, s3, 9
  s_add_u32 s41, s41, 145920
  v_add_u32 v4, s41, v4
  v_mov_b32 v209, v224
  ds_write_b64 v4, v[208:209]
  s_waitcnt lgkmcnt(0)
  s_barrier
  s_cmp_lg_u32 s3, 0
  s_cbranch_scc1 adaLN_cond__spectral_fnet__mixer_gmlp__prompt_kernel_nopub55
  v_lshlrev_b32 v4, 3, v1
  v_add_u32 v4, 145920, v4
  ds_read_b64 v[240:241], v4 offset:0
  ds_read_b64 v[242:243], v4 offset:512
  ds_read_b64 v[244:245], v4 offset:1024
  ds_read_b64 v[246:247], v4 offset:1536
  s_waitcnt lgkmcnt(0)
  v_add_f32 v240, v240, v242
  v_add_f32 v241, v241, v243
  v_add_f32 v240, v240, v244
  v_add_f32 v241, v241, v245
  v_add_f32 v240, v240, v246
  v_add_f32 v241, v241, v247
  v_or_b32 v241, 0x80000000, v241
  v_lshlrev_b32 v4, 6, v1
  s_lshl_b32 s41, s30, 12
  s_lshl_b32 s42, s31, 3
  s_add_u32 s41, s41, s42
  s_add_u32 s41, s41, 32768
  buffer_store_dwordx2 v[240:241], v4, s[12:15], s41 offen sc1
adaLN_cond__spectral_fnet__mixer_gmlp__prompt_kernel_nopub55:
  s_lshl_b32 s43, s52, 6
  v_add_u32 v61, s43, v59
  v_add_u32 v62, s43, v60
  ds_read_b128 v[64:67], v61 offset:0
  ds_read_b128 v[68:71], v61 offset:512
  ds_read_b128 v[72:75], v61 offset:4096
  ds_read_b128 v[76:79], v61 offset:4608
  ds_read_b128 v[80:83], v62 offset:0
  ds_read_b128 v[84:87], v62 offset:512
  ds_read_b128 v[88:91], v62 offset:4096
  ds_read_b128 v[92:95], v62 offset:4608
  s_waitcnt lgkmcnt(4)
  v_mfma_f32_16x16x32_bf16 v[112:115], a[128:131], v[64:67], 0
  v_mfma_f32_16x16x32_bf16 v[116:119], a[132:135], v[64:67], 0
  s_lshl_b32 s43, s53, 6
  v_mfma_f32_16x16x32_bf16 v[120:123], a[128:131], v[68:71], 0
  v_add_u32 v50, s43, v59
  v_mfma_f32_16x16x32_bf16 v[124:127], a[132:135], v[68:71], 0
  v_add_u32 v51, s43, v60
  v_mfma_f32_16x16x32_bf16 v[128:131], a[128:131], v[72:75], 0
  ds_read_b128 v[96:99], v50 offset:0
  v_mfma_f32_16x16x32_bf16 v[132:135], a[132:135], v[72:75], 0
  ds_read_b128 v[100:103], v50 offset:512
  v_mfma_f32_16x16x32_bf16 v[136:139], a[128:131], v[76:79], 0
  ds_read_b128 v[104:107], v50 offset:4096
  v_mfma_f32_16x16x32_bf16 v[140:143], a[132:135], v[76:79], 0
  ds_read_b128 v[108:111], v50 offset:4608
  s_waitcnt lgkmcnt(4)
  v_mfma_f32_16x16x32_bf16 v[112:115], a[136:139], v[80:83], v[112:115]
  v_mfma_f32_16x16x32_bf16 v[116:119], a[140:143], v[80:83], v[116:119]
  ds_read_b128 v[64:67], v51 offset:0
  v_mfma_f32_16x16x32_bf16 v[120:123], a[136:139], v[84:87], v[120:123]
  v_mfma_f32_16x16x32_bf16 v[124:127], a[140:143], v[84:87], v[124:127]
  ds_read_b128 v[68:71], v51 offset:512
  v_mfma_f32_16x16x32_bf16 v[128:131], a[136:139], v[88:91], v[128:131]
  v_mfma_f32_16x16x32_bf16 v[132:135], a[140:143], v[88:91], v[132:135]
  ds_read_b128 v[72:75], v51 offset:4096
  v_mfma_f32_16x16x32_bf16 v[136:139], a[136:139], v[92:95], v[136:139]
  v_mfma_f32_16x16x32_bf16 v[140:143], a[140:143], v[92:95], v[140:143]
  ds_read_b128 v[76:79], v51 offset:4608
  s_waitcnt lgkmcnt(4)
  v_mfma_f32_16x16x32_bf16 v[112:115], a[144:147], v[96:99], v[112:115]
  v_mfma_f32_16x16x32_bf16 v[116:119], a[148:151], v[96:99], v[116:119]
  s_lshl_b32 s43, s54, 6
  v_mfma_f32_16x16x32_bf16 v[120:123], a[144:147], v[100:103], v[120:123]
  v_add_u32 v61, s43, v59
  v_mfma_f32_16x16x32_bf16 v[124:127], a[148:151], v[100:103], v[124:127]
  v_add_u32 v62, s43, v60
  v_mfma_f32_16x16x32_bf16 v[128:131], a[144:147], v[104:107], v[128:131]
  ds_read_b128 v[80:83], v61 offset:0
  v_mfma_f32_16x16x32_bf16 v[132:135], a[148:151], v[104:107], v[132:135]
  ds_read_b128 v[84:87], v61 offset:512
  v_mfma_f32_16x16x32_bf16 v[136:139], a[144:147], v[108:111], v[136:139]
  ds_read_b128 v[88:91], v61 offset:4096
  v_mfma_f32_16x16x32_bf16 v[140:143], a[148:151], v[108:111], v[140:143]
  ds_read_b128 v[92:95], v61 offset:4608
  s_waitcnt lgkmcnt(4)
  v_mfma_f32_16x16x32_bf16 v[112:115], a[152:155], v[64:67], v[112:115]
  v_mfma_f32_16x16x32_bf16 v[116:119], a[156:159], v[64:67], v[116:119]
  ds_read_b128 v[96:99], v62 offset:0
  v_mfma_f32_16x16x32_bf16 v[120:123], a[152:155], v[68:71], v[120:123]
  v_mfma_f32_16x16x32_bf16 v[124:127], a[156:159], v[68:71], v[124:127]
  ds_read_b128 v[100:103], v62 offset:512
  v_mfma_f32_16x16x32_bf16 v[128:131], a[152:155], v[72:75], v[128:131]
  v_mfma_f32_16x16x32_bf16 v[132:135], a[156:159], v[72:75], v[132:135]
  ds_read_b128 v[104:107], v62 offset:4096
  v_mfma_f32_16x16x32_bf16 v[136:139], a[152:155], v[76:79], v[136:139]
  v_mfma_f32_16x16x32_bf16 v[140:143], a[156:159], v[76:79], v[140:143]
  ds_read_b128 v[108:111], v62 offset:4608
  s_waitcnt lgkmcnt(4)
  v_mfma_f32_16x16x32_bf16 v[112:115], a[160:163], v[80:83], v[112:115]
  v_mfma_f32_16x16x32_bf16 v[116:119], a[164:167], v[80:83], v[116:119]
  s_lshl_b32 s43, s55, 6
  v_mfma_f32_16x16x32_bf16 v[120:123], a[160:163], v[84:87], v[120:123]
  v_add_u32 v50, s43, v59
  v_mfma_f32_16x16x32_bf16 v[124:127], a[164:167], v[84:87], v[124:127]
  v_add_u32 v51, s43, v60
  v_mfma_f32_16x16x32_bf16 v[128:131], a[160:163], v[88:91], v[128:131]
  ds_read_b128 v[64:67], v50 offset:0
  v_mfma_f32_16x16x32_bf16 v[132:135], a[164:167], v[88:91], v[132:135]
  ds_read_b128 v[68:71], v50 offset:512
  v_mfma_f32_16x16x32_bf16 v[136:139], a[160:163], v[92:95], v[136:139]
  ds_read_b128 v[72:75], v50 offset:4096
  v_mfma_f32_16x16x32_bf16 v[140:143], a[164:167], v[92:95], v[140:143]
  ds_read_b128 v[76:79], v50 offset:4608
  s_waitcnt lgkmcnt(4)
  v_mfma_f32_16x16x32_bf16 v[112:115], a[168:171], v[96:99], v[112:115]
  v_mfma_f32_16x16x32_bf16 v[116:119], a[172:175], v[96:99], v[116:119]
  ds_read_b128 v[80:83], v51 offset:0
  v_mfma_f32_16x16x32_bf16 v[120:123], a[168:171], v[100:103], v[120:123]
  v_mfma_f32_16x16x32_bf16 v[124:127], a[172:175], v[100:103], v[124:127]
  ds_read_b128 v[84:87], v51 offset:512
  v_mfma_f32_16x16x32_bf16 v[128:131], a[168:171], v[104:107], v[128:131]
  v_mfma_f32_16x16x32_bf16 v[132:135], a[172:175], v[104:107], v[132:135]
  ds_read_b128 v[88:91], v51 offset:4096
  v_mfma_f32_16x16x32_bf16 v[136:139], a[168:171], v[108:111], v[136:139]
  v_mfma_f32_16x16x32_bf16 v[140:143], a[172:175], v[108:111], v[140:143]
  ds_read_b128 v[92:95], v51 offset:4608
  s_waitcnt lgkmcnt(4)
  v_mfma_f32_16x16x32_bf16 v[112:115], a[176:179], v[64:67], v[112:115]
  v_mfma_f32_16x16x32_bf16 v[116:119], a[180:183], v[64:67], v[116:119]
  s_lshl_b32 s43, s56, 6
  v_mfma_f32_16x16x32_bf16 v[120:123], a[176:179], v[68:71], v[120:123]
  v_add_u32 v61, s43, v59
  v_mfma_f32_16x16x32_bf16 v[124:127], a[180:183], v[68:71], v[124:127]
  v_add_u32 v62, s43, v60
  v_mfma_f32_16x16x32_bf16 v[128:131], a[176:179], v[72:75], v[128:131]
  ds_read_b128 v[96:99], v61 offset:0
  v_mfma_f32_16x16x32_bf16 v[132:135], a[180:183], v[72:75], v[132:135]
  ds_read_b128 v[100:103], v61 offset:512
  v_mfma_f32_16x16x32_bf16 v[136:139], a[176:179], v[76:79], v[136:139]
  ds_read_b128 v[104:107], v61 offset:4096
  v_mfma_f32_16x16x32_bf16 v[140:143], a[180:183], v[76:79], v[140:143]
  ds_read_b128 v[108:111], v61 offset:4608
  s_waitcnt lgkmcnt(4)
  v_mfma_f32_16x16x32_bf16 v[112:115], a[184:187], v[80:83], v[112:115]
  v_mfma_f32_16x16x32_bf16 v[116:119], a[188:191], v[80:83], v[116:119]
  ds_read_b128 v[64:67], v62 offset:0
  v_mfma_f32_16x16x32_bf16 v[120:123], a[184:187], v[84:87], v[120:123]
  v_mfma_f32_16x16x32_bf16 v[124:127], a[188:191], v[84:87], v[124:127]
  ds_read_b128 v[68:71], v62 offset:512
  v_mfma_f32_16x16x32_bf16 v[128:131], a[184:187], v[88:91], v[128:131]
  v_mfma_f32_16x16x32_bf16 v[132:135], a[188:191], v[88:91], v[132:135]
  ds_read_b128 v[72:75], v62 offset:4096
  v_mfma_f32_16x16x32_bf16 v[136:139], a[184:187], v[92:95], v[136:139]
  v_mfma_f32_16x16x32_bf16 v[140:143], a[188:191], v[92:95], v[140:143]
  ds_read_b128 v[76:79], v62 offset:4608
  s_waitcnt lgkmcnt(4)
  v_mfma_f32_16x16x32_bf16 v[112:115], a[192:195], v[96:99], v[112:115]
  v_mfma_f32_16x16x32_bf16 v[116:119], a[196:199], v[96:99], v[116:119]
  s_lshl_b32 s43, s57, 6
  v_mfma_f32_16x16x32_bf16 v[120:123], a[192:195], v[100:103], v[120:123]
  v_add_u32 v50, s43, v59
  v_mfma_f32_16x16x32_bf16 v[124:127], a[196:199], v[100:103], v[124:127]
  v_add_u32 v51, s43, v60
  v_mfma_f32_16x16x32_bf16 v[128:131], a[192:195], v[104:107], v[128:131]
  ds_read_b128 v[80:83], v50 offset:0
  v_mfma_f32_16x16x32_bf16 v[132:135], a[196:199], v[104:107], v[132:135]
  ds_read_b128 v[84:87], v50 offset:512
  v_mfma_f32_16x16x32_bf16 v[136:139], a[192:195], v[108:111], v[136:139]
  ds_read_b128 v[88:91], v50 offset:4096
  v_mfma_f32_16x16x32_bf16 v[140:143], a[196:199], v[108:111], v[140:143]
  ds_read_b128 v[92:95], v50 offset:4608
  s_waitcnt lgkmcnt(4)
  v_mfma_f32_16x16x32_bf16 v[112:115], a[200:203], v[64:67], v[112:115]
  v_mfma_f32_16x16x32_bf16 v[116:119], a[204:207], v[64:67], v[116:119]
  ds_read_b128 v[96:99], v51 offset:0
  v_mfma_f32_16x16x32_bf16 v[120:123], a[200:203], v[68:71], v[120:123]
  v_mfma_f32_16x16x32_bf16 v[124:127], a[204:207], v[68:71], v[124:127]
  ds_read_b128 v[100:103], v51 offset:512
  v_mfma_f32_16x16x32_bf16 v[128:131], a[200:203], v[72:75], v[128:131]
  v_mfma_f32_16x16x32_bf16 v[132:135], a[204:207], v[72:75], v[132:135]
  ds_read_b128 v[104:107], v51 offset:4096
  v_mfma_f32_16x16x32_bf16 v[136:139], a[200:203], v[76:79], v[136:139]
  v_mfma_f32_16x16x32_bf16 v[140:143], a[204:207], v[76:79], v[140:143]
  ds_read_b128 v[108:111], v51 offset:4608
  s_waitcnt lgkmcnt(4)
  v_mfma_f32_16x16x32_bf16 v[112:115], a[208:211], v[80:83], v[112:115]
  v_mfma_f32_16x16x32_bf16 v[116:119], a[212:215], v[80:83], v[116:119]
  s_lshl_b32 s43, s58, 6
  v_mfma_f32_16x16x32_bf16 v[120:123], a[208:211], v[84:87], v[120:123]
  v_add_u32 v61, s43, v59
  v_mfma_f32_16x16x32_bf16 v[124:127], a[212:215], v[84:87], v[124:127]
  v_add_u32 v62, s43, v60
  v_mfma_f32_16x16x32_bf16 v[128:131], a[208:211], v[88:91], v[128:131]
  ds_read_b128 v[64:67], v61 offset:0
  v_mfma_f32_16x16x32_bf16 v[132:135], a[212:215], v[88:91], v[132:135]
  ds_read_b128 v[68:71], v61 offset:512
  v_mfma_f32_16x16x32_bf16 v[136:139], a[208:211], v[92:95], v[136:139]
  ds_read_b128 v[72:75], v61 offset:4096
  v_mfma_f32_16x16x32_bf16 v[140:143], a[212:215], v[92:95], v[140:143]
  ds_read_b128 v[76:79], v61 offset:4608
  s_waitcnt lgkmcnt(4)
  v_mfma_f32_16x16x32_bf16 v[112:115], a[216:219], v[96:99], v[112:115]
  v_mfma_f32_16x16x32_bf16 v[116:119], a[220:223], v[96:99], v[116:119]
  ds_read_b128 v[80:83], v62 offset:0
  v_mfma_f32_16x16x32_bf16 v[120:123], a[216:219], v[100:103], v[120:123]
  v_mfma_f32_16x16x32_bf16 v[124:127], a[220:223], v[100:103], v[124:127]
  ds_read_b128 v[84:87], v62 offset:512
  v_mfma_f32_16x16x32_bf16 v[128:131], a[216:219], v[104:107], v[128:131]
  v_mfma_f32_16x16x32_bf16 v[132:135], a[220:223], v[104:107], v[132:135]
  ds_read_b128 v[88:91], v62 offset:4096
  v_mfma_f32_16x16x32_bf16 v[136:139], a[216:219], v[108:111], v[136:139]
  v_mfma_f32_16x16x32_bf16 v[140:143], a[220:223], v[108:111], v[140:143]
  ds_read_b128 v[92:95], v62 offset:4608
  s_waitcnt lgkmcnt(4)
  s_waitcnt vmcnt(7)
  v_mfma_f32_16x16x32_bf16 v[112:115], a[224:227], v[64:67], v[112:115]
  v_mfma_f32_16x16x32_bf16 v[116:119], a[228:231], v[64:67], v[116:119]
  s_lshl_b32 s43, s59, 6
  v_mfma_f32_16x16x32_bf16 v[120:123], a[224:227], v[68:71], v[120:123]
  v_add_u32 v50, s43, v59
  v_mfma_f32_16x16x32_bf16 v[124:127], a[228:231], v[68:71], v[124:127]
  v_add_u32 v51, s43, v60
  v_mfma_f32_16x16x32_bf16 v[128:131], a[224:227], v[72:75], v[128:131]
  ds_read_b128 v[96:99], v50 offset:0
  v_mfma_f32_16x16x32_bf16 v[132:135], a[228:231], v[72:75], v[132:135]
  ds_read_b128 v[100:103], v50 offset:512
  v_mfma_f32_16x16x32_bf16 v[136:139], a[224:227], v[76:79], v[136:139]
  ds_read_b128 v[104:107], v50 offset:4096
  v_mfma_f32_16x16x32_bf16 v[140:143], a[228:231], v[76:79], v[140:143]
  ds_read_b128 v[108:111], v50 offset:4608
  s_waitcnt lgkmcnt(4)
  s_waitcnt vmcnt(5)
  v_mfma_f32_16x16x32_bf16 v[112:115], a[232:235], v[80:83], v[112:115]
  v_mfma_f32_16x16x32_bf16 v[116:119], a[236:239], v[80:83], v[116:119]
  ds_read_b128 v[64:67], v51 offset:0
  v_mfma_f32_16x16x32_bf16 v[120:123], a[232:235], v[84:87], v[120:123]
  v_mfma_f32_16x16x32_bf16 v[124:127], a[236:239], v[84:87], v[124:127]
  ds_read_b128 v[68:71], v51 offset:512
  v_mfma_f32_16x16x32_bf16 v[128:131], a[232:235], v[88:91], v[128:131]
  v_mfma_f32_16x16x32_bf16 v[132:135], a[236:239], v[88:91], v[132:135]
  ds_read_b128 v[72:75], v51 offset:4096
  v_mfma_f32_16x16x32_bf16 v[136:139], a[232:235], v[92:95], v[136:139]
  v_mfma_f32_16x16x32_bf16 v[140:143], a[236:239], v[92:95], v[140:143]
  ds_read_b128 v[76:79], v51 offset:4608
  s_waitcnt lgkmcnt(4)
  s_waitcnt vmcnt(3)
  v_mfma_f32_16x16x32_bf16 v[112:115], a[240:243], v[96:99], v[112:115]
  v_mfma_f32_16x16x32_bf16 v[116:119], a[244:247], v[96:99], v[116:119]
  v_mfma_f32_16x16x32_bf16 v[120:123], a[240:243], v[100:103], v[120:123]
  v_mfma_f32_16x16x32_bf16 v[124:127], a[244:247], v[100:103], v[124:127]
  v_mfma_f32_16x16x32_bf16 v[128:131], a[240:243], v[104:107], v[128:131]
  v_mfma_f32_16x16x32_bf16 v[132:135], a[244:247], v[104:107], v[132:135]
  v_mfma_f32_16x16x32_bf16 v[136:139], a[240:243], v[108:111], v[136:139]
  v_mfma_f32_16x16x32_bf16 v[140:143], a[244:247], v[108:111], v[140:143]
  s_waitcnt lgkmcnt(0)
  s_waitcnt vmcnt(1)
  v_mfma_f32_16x16x32_bf16 v[112:115], a[248:251], v[64:67], v[112:115]
  v_mfma_f32_16x16x32_bf16 v[116:119], a[252:255], v[64:67], v[116:119]
  v_mfma_f32_16x16x32_bf16 v[120:123], a[248:251], v[68:71], v[120:123]
  v_mfma_f32_16x16x32_bf16 v[124:127], a[252:255], v[68:71], v[124:127]
  v_mfma_f32_16x16x32_bf16 v[128:131], a[248:251], v[72:75], v[128:131]
  v_mfma_f32_16x16x32_bf16 v[132:135], a[252:255], v[72:75], v[132:135]
  v_mfma_f32_16x16x32_bf16 v[136:139], a[248:251], v[76:79], v[136:139]
  v_mfma_f32_16x16x32_bf16 v[140:143], a[252:255], v[76:79], v[140:143]
  v_lshlrev_b32 v4, 4, v0
  s_lshl_b32 s41, s30, 12
  s_add_u32 s41, s41, 32768
  s_mov_b32 s42, 0x20000
adaLN_cond__spectral_fnet__mixer_gmlp__prompt_kernel_poll56:
  buffer_load_dwordx4 v[160:163], v4, s[12:15], s41 offen sc1
  s_waitcnt vmcnt(0)
  v_min_u32 v5, v161, v163
  v_cmp_eq_u32 vcc, 0, v5
  s_nop 4
  s_cbranch_vccz adaLN_cond__spectral_fnet__mixer_gmlp__prompt_kernel_pdone57
  s_sub_u32 s42, s42, 1
  s_cmp_lg_u32 s42, 0
  s_cbranch_scc1 adaLN_cond__spectral_fnet__mixer_gmlp__prompt_kernel_poll56
adaLN_cond__spectral_fnet__mixer_gmlp__prompt_kernel_pdone57:
  v_add_f32 v5, v160, v162
  v_add_f32 v6, abs(v161), abs(v163)
  s_nop 0
  v_add_f32 v5, v5, v5 quad_perm:[1,0,3,2] row_mask:0xf bank_mask:0xf
  v_add_f32 v6, v6, v6 quad_perm:[1,0,3,2] row_mask:0xf bank_mask:0xf
  s_nop 0
  v_add_f32 v5, v5, v5 quad_perm:[2,3,0,1] row_mask:0xf bank_mask:0xf
  v_add_f32 v6, v6, v6 quad_perm:[2,3,0,1] row_mask:0xf bank_mask:0xf
  v_mul_f32 v5, 0x3a924925, v5
  v_mul_f32 v6, 0x3a924925, v6
  v_fma_f32 v6, -v5, v5, v6
  v_max_f32 v6, 0, v6
  v_add_f32 v6, 0x3727c5ac, v6
  v_rsq_f32 v6, v6
  s_nop 0
  v_mul_f32 v7, v5, v6
  v_lshrrev_b32 v4, 2, v0
  v_lshlrev_b32 v4, 2, v4
  v_add_u32 v4, 147968, v4
  ds_write_b32 v4, v6
  ds_write_b32 v4, v7 offset:256
  s_waitcnt lgkmcnt(0)
  s_barrier
  v_lshlrev_b32 v4, 5, v2
  v_add_u32 v4, 147968, v4
  ds_read_b128 v[160:163], v4 offset:0
  ds_read_b128 v[176:179], v4 offset:256
  ds_read_b128 v[164:167], v4 offset:16
  ds_read_b128 v[180:183], v4 offset:272
  ds_read_b128 v[168:171], v4 offset:128
  ds_read_b128 v[184:187], v4 offset:384
  ds_read_b128 v[172:175], v4 offset:144
  ds_read_b128 v[188:191], v4 offset:400
  s_waitcnt lgkmcnt(0)
  s_mul_i32 s36, s31, 7
  s_lshl_b32 s37, s3, 1
  s_add_u32 s36, s36, s37
  s_lshl_b32 s36, s36, 6
  s_lshl_b32 s37, s30, 1
  s_add_u32 s36, s36, s37
  s_lshl_b32 s36, s36, 10
  s_add_u32 s36, s36, 13172736
  s_add_u32 s37, s36, 65536
  s_cmp_eq_u32 s3, 3
  s_cselect_b32 s37, 0x40000000, s37
  v_lshlrev_b32 v240, 16, v144
  v_and_b32 v241, 0xffff0000, v144
  v_lshlrev_b32 v242, 16, v145
  v_and_b32 v243, 0xffff0000, v145
  v_lshlrev_b32 v244, 16, v146
  v_and_b32 v245, 0xffff0000, v146
  v_lshlrev_b32 v246, 16, v147
  v_and_b32 v247, 0xffff0000, v147
  v_pk_fma_f32 v[240:241], v[240:241], v[160:161], v[176:177] neg_lo:[0,0,1] neg_hi:[0,0,1]
  v_pk_fma_f32 v[242:243], v[242:243], v[162:163], v[178:179] neg_lo:[0,0,1] neg_hi:[0,0,1]
  v_pk_fma_f32 v[244:245], v[244:245], v[164:165], v[180:181] neg_lo:[0,0,1] neg_hi:[0,0,1]
  v_pk_fma_f32 v[246:247], v[246:247], v[166:167], v[182:183] neg_lo:[0,0,1] neg_hi:[0,0,1]
  v_cvt_pk_bf16_f32 v144, v240, v241
  v_cvt_pk_bf16_f32 v145, v242, v243
  v_cvt_pk_bf16_f32 v146, v244, v245
  v_cvt_pk_bf16_f32 v147, v246, v247
  buffer_store_dwordx4 v[144:147], v58, s[12:15], s36 offen offset:0 sc1
  v_lshlrev_b32 v248, 16, v148
  v_and_b32 v249, 0xffff0000, v148
  v_lshlrev_b32 v250, 16, v149
  v_and_b32 v251, 0xffff0000, v149
  v_lshlrev_b32 v252, 16, v150
  v_and_b32 v253, 0xffff0000, v150
  v_lshlrev_b32 v254, 16, v151
  v_and_b32 v255, 0xffff0000, v151
  v_pk_fma_f32 v[248:249], v[248:249], v[168:169], v[184:185] neg_lo:[0,0,1] neg_hi:[0,0,1]
  v_pk_fma_f32 v[250:251], v[250:251], v[170:171], v[186:187] neg_lo:[0,0,1] neg_hi:[0,0,1]
  v_pk_fma_f32 v[252:253], v[252:253], v[172:173], v[188:189] neg_lo:[0,0,1] neg_hi:[0,0,1]
  v_pk_fma_f32 v[254:255], v[254:255], v[174:175], v[190:191] neg_lo:[0,0,1] neg_hi:[0,0,1]
  v_cvt_pk_bf16_f32 v148, v248, v249
  v_cvt_pk_bf16_f32 v149, v250, v251
  v_cvt_pk_bf16_f32 v150, v252, v253
  v_cvt_pk_bf16_f32 v151, v254, v255
  buffer_store_dwordx4 v[148:151], v58, s[12:15], s36 offen offset:1024 sc1
  v_lshlrev_b32 v240, 16, v152
  v_and_b32 v241, 0xffff0000, v152
  v_lshlrev_b32 v242, 16, v153
  v_and_b32 v243, 0xffff0000, v153
  v_lshlrev_b32 v244, 16, v154
  v_and_b32 v245, 0xffff0000, v154
  v_lshlrev_b32 v246, 16, v155
  v_and_b32 v247, 0xffff0000, v155
  v_pk_fma_f32 v[240:241], v[240:241], v[160:161], v[176:177] neg_lo:[0,0,1] neg_hi:[0,0,1]
  v_pk_fma_f32 v[242:243], v[242:243], v[162:163], v[178:179] neg_lo:[0,0,1] neg_hi:[0,0,1]
  v_pk_fma_f32 v[244:245], v[244:245], v[164:165], v[180:181] neg_lo:[0,0,1] neg_hi:[0,0,1]
  v_pk_fma_f32 v[246:247], v[246:247], v[166:167], v[182:183] neg_lo:[0,0,1] neg_hi:[0,0,1]
  v_cvt_pk_bf16_f32 v152, v240, v241
  v_cvt_pk_bf16_f32 v153, v242, v243
  v_cvt_pk_bf16_f32 v154, v244, v245
  v_cvt_pk_bf16_f32 v155, v246, v247
  buffer_store_dwordx4 v[152:155], v58, s[12:15], s37 offen offset:0 sc1
  v_lshlrev_b32 v248, 16, v156
  v_and_b32 v249, 0xffff0000, v156
  v_lshlrev_b32 v250, 16, v157
  v_and_b32 v251, 0xffff0000, v157
  v_lshlrev_b32 v252, 16, v158
  v_and_b32 v253, 0xffff0000, v158
  v_lshlrev_b32 v254, 16, v159
  v_and_b32 v255, 0xffff0000, v159
  v_pk_fma_f32 v[248:249], v[248:249], v[168:169], v[184:185] neg_lo:[0,0,1] neg_hi:[0,0,1]
  v_pk_fma_f32 v[250:251], v[250:251], v[170:171], v[186:187] neg_lo:[0,0,1] neg_hi:[0,0,1]
  v_pk_fma_f32 v[252:253], v[252:253], v[172:173], v[188:189] neg_lo:[0,0,1] neg_hi:[0,0,1]
  v_pk_fma_f32 v[254:255], v[254:255], v[174:175], v[190:191] neg_lo:[0,0,1] neg_hi:[0,0,1]
  v_cvt_pk_bf16_f32 v156, v248, v249
  v_cvt_pk_bf16_f32 v157, v250, v251
  v_cvt_pk_bf16_f32 v158, v252, v253
  v_cvt_pk_bf16_f32 v159, v254, v255
  buffer_store_dwordx4 v[156:159], v58, s[12:15], s37 offen offset:1024 sc1
  s_load_dwordx2 s[4:5], s[0:1], 56
  s_load_dwordx2 s[6:7], s[0:1], 112
  s_load_dwordx2 s[24:25], s[0:1], 64
  v_and_b32 v1, 63, v0
  s_and_b32 s28, s2, 7
  s_lshr_b32 s29, s2, 3
  s_lshr_b32 s30, s28, 1
  s_lshl_b32 s30, s30, 3
  s_lshr_b32 s31, s29, 2
  s_add_u32 s30, s30, s31
  s_and_b32 s31, s28, 1
  s_lshl_b32 s31, s31, 2
  s_and_b32 s32, s29, 3
  s_add_u32 s31, s31, s32
  v_lshrrev_b32 v2, 4, v1
  v_and_b32 v3, 15, v1
  v_lshrrev_b32 v8, 3, v1
  v_and_b32 v9, 7, v1
  v_bfe_u32 v10, v8, 1, 1
  v_xor_b32 v9, v9, v10
  v_lshlrev_b32 v9, 4, v9
  v_lshl_add_u32 v4, v8, 12, v9
  v_xor_b32 v5, 32, v4
  v_xor_b32 v6, 64, v4
  v_xor_b32 v7, 96, v4
  v_lshlrev_b32 v12, 4, v1
  v_add_u32 v13, 65536, v12
  v_add_u32 v14, 131072, v12
  v_add_u32 v15, 196608, v12
  v_add_u32 v16, 262144, v12
  v_add_u32 v17, 327680, v12
  v_add_u32 v18, 393216, v12
  s_lshl_b32 s33, s30, 18
  s_add_u32 s66, s33, 3072
  s_mov_b32 s67, 98304
  s_lshl_b32 s34, s3, 10
  s_add_u32 s33, s33, s34
  s_lshl_b32 s35, s3, 15
  s_mul_i32 s36, s31, 7
  s_lshl_b32 s36, s36, 16
  s_lshl_b32 s37, s3, 14
  s_add_u32 s36, s36, s37
  s_add_u32 s36, s36, 13172736
  v_lshrrev_b32 v8, 2, v3
  v_and_b32 v9, 3, v3
  v_lshl_add_u32 v8, v8, 3, v9
  v_lshrrev_b32 v9, 1, v3
  v_xor_b32 v9, v9, v2
  v_lshlrev_b32 v9, 4, v9
  v_lshl_add_u32 v10, v8, 7, v9
  v_add_u32 v10, s35, v10
  s_add_u32 s38, s3, 0
  s_and_b32 s38, s38, 3
  s_lshr_b32 s39, s38, 1
  s_lshl_b32 s39, s39, 12
  s_and_b32 s38, s38, 1
  s_lshl_b32 s38, s38, 9
  s_add_u32 s38, s38, s39
  v_add_u32 v36, s38, v10
  v_xor_b32 v37, 64, v36
  s_add_u32 s38, s3, 1
  s_and_b32 s38, s38, 3
  s_lshr_b32 s39, s38, 1
  s_lshl_b32 s39, s39, 12
  s_and_b32 s38, s38, 1
  s_lshl_b32 s38, s38, 9
  s_add_u32 s38, s38, s39
  v_add_u32 v38, s38, v10
  v_xor_b32 v39, 64, v38
  s_add_u32 s38, s3, 2
  s_and_b32 s38, s38, 3
  s_lshr_b32 s39, s38, 1
  s_lshl_b32 s39, s39, 12
  s_and_b32 s38, s38, 1
  s_lshl_b32 s38, s38, 9
  s_add_u32 s38, s38, s39
  v_add_u32 v40, s38, v10
  v_xor_b32 v41, 64, v40
  s_add_u32 s38, s3, 3
  s_and_b32 s38, s38, 3
  s_lshr_b32 s39, s38, 1
  s_lshl_b32 s39, s39, 12
  s_and_b32 s38, s38, 1
  s_lshl_b32 s38, s38, 9
  s_add_u32 s38, s38, s39
  v_add_u32 v42, s38, v10
  v_xor_b32 v43, 64, v42
  s_lshl_b32 s39, s30, 6
  s_lshr_b32 s40, s3, 1
  s_lshl_b32 s40, s40, 5
  s_add_u32 s39, s39, s40
  s_and_b32 s40, s3, 1
  s_lshl_b32 s40, s40, 2
  s_add_u32 s39, s39, s40
  v_add_u32 v9, s39, v8
  v_lshlrev_b32 v11, 1, v9
  v_lshlrev_b32 v8, 4, v1
  v_add_u32 v9, s35, v8
  s_sub_u32 s38, s3, 1
  s_and_b32 s38, s38, 3
  s_lshl_b32 s38, s38, 15
  s_add_u32 s38, s38, 7168
  v_add_u32 v44, s38, v8
  s_sub_u32 s38, s3, 2
  s_and_b32 s38, s38, 3
  s_lshl_b32 s38, s38, 15
  s_add_u32 s38, s38, 14336
  v_add_u32 v45, s38, v8
  s_sub_u32 s38, s3, 3
  s_and_b32 s38, s38, 3
  s_lshl_b32 s38, s38, 15
  s_add_u32 s38, s38, 21504
  v_add_u32 v46, s38, v8
  s_waitcnt lgkmcnt(0)
  s_mov_b32 s8, s4
  s_mov_b32 s9, s5
  s_mov_b32 s10, 0x800000
  s_mov_b32 s11, 0x20000
  s_mov_b32 s12, s6
  s_mov_b32 s13, s7
  s_mov_b32 s14, 0x2000000
  s_mov_b32 s15, 0x20000
  s_mov_b32 s16, s24
  s_mov_b32 s17, s25
  s_mov_b32 s18, 0x1000
  s_mov_b32 s19, 0x20000
  s_waitcnt vmcnt(0) lgkmcnt(0)
  s_barrier
  s_cmp_lg_u32 s3, 3
  s_cbranch_scc1 adaLN_cond__spectral_fnet__mixer_gmlp__prompt_kernel_join59
  v_mov_b32 v254, s101
  v_mov_b32 v255, 0
  s_lshl_b32 s88, s2, 7
  s_add_u32 s88, s88, 23166976
  s_mov_b64 s[90:91], exec
  s_mov_b64 exec, 1
  buffer_store_dword v254, v255, s[96:99], s88 offen sc1
  s_mov_b64 exec, s[90:91]
  v_and_b32 v250, 63, v0
  v_lshrrev_b32 v251, 3, v250
  v_lshlrev_b32 v251, 1, v251
  v_and_b32 v252, 7, v250
  v_lshl_add_u32 v251, v252, 5, v251
  s_lshr_b32 s88, s31, 2
  s_and_b32 s89, s31, 3
  s_lshl_b32 s89, s89, 3
  s_add_u32 s88, s88, s89
  v_add_u32 v251, s88, v251
  v_lshlrev_b32 v251, 7, v251
  v_add_u32 v251, 98304, v251
  v_mov_b32 v252, 0x40000000
  v_cmp_gt_u32 vcc, 32, v250
  s_nop 1
  v_cndmask_b32 v250, v252, v251, vcc
  v_lshrrev_b32 v64, 2, v3
  v_and_b32 v65, 3, v3
  v_lshl_add_u32 v64, v64, 3, v65
  v_lshlrev_b32 v64, 2, v64
  v_add_u32 v64, 145408, v64
  ds_read2_b32 v[160:161], v64 offset0:0 offset1:64
  ds_read2_b32 v[162:163], v64 offset0:4 offset1:68
  ds_read2_b32 v[164:165], v64 offset0:32 offset1:96
  ds_read2_b32 v[166:167], v64 offset0:36 offset1:100
  s_waitcnt lgkmcnt(0)
  v_lshlrev_b32 v65, 3, v1
  s_lshl_b32 s62, s3, 10
  s_add_u32 s62, s62, 131072
  v_add_u32 v65, s62, v65
  v_add_u32 v66, 512, v65
  v_pk_fma_f32 v[192:193], v[160:161], v[20:21], v[28:29] op_sel:[1,0,0] op_sel_hi:[1,1,1] neg_lo:[1,0,0] neg_hi:[1,0,0]
  v_pk_fma_f32 v[194:195], v[160:161], v[22:23], v[30:31] op_sel:[1,0,0] op_sel_hi:[1,1,1] neg_lo:[1,0,0] neg_hi:[1,0,0]
  v_pk_fma_f32 v[196:197], v[162:163], v[20:21], v[28:29] op_sel:[1,0,0] op_sel_hi:[1,1,1] neg_lo:[1,0,0] neg_hi:[1,0,0]
  v_pk_fma_f32 v[198:199], v[162:163], v[22:23], v[30:31] op_sel:[1,0,0] op_sel_hi:[1,1,1] neg_lo:[1,0,0] neg_hi:[1,0,0]
  v_pk_fma_f32 v[200:201], v[164:165], v[20:21], v[28:29] op_sel:[1,0,0] op_sel_hi:[1,1,1] neg_lo:[1,0,0] neg_hi:[1,0,0]
  v_pk_fma_f32 v[202:203], v[164:165], v[22:23], v[30:31] op_sel:[1,0,0] op_sel_hi:[1,1,1] neg_lo:[1,0,0] neg_hi:[1,0,0]
  v_pk_fma_f32 v[204:205], v[166:167], v[20:21], v[28:29] op_sel:[1,0,0] op_sel_hi:[1,1,1] neg_lo:[1,0,0] neg_hi:[1,0,0]
  v_pk_fma_f32 v[206:207], v[166:167], v[22:23], v[30:31] op_sel:[1,0,0] op_sel_hi:[1,1,1] neg_lo:[1,0,0] neg_hi:[1,0,0]
  v_pk_fma_f32 v[112:113], v[112:113], v[160:161], v[192:193] op_sel:[0,0,0] op_sel_hi:[1,0,1]
  v_pk_fma_f32 v[114:115], v[114:115], v[160:161], v[194:195] op_sel:[0,0,0] op_sel_hi:[1,0,1]
  v_pk_fma_f32 v[120:121], v[120:121], v[162:163], v[196:197] op_sel:[0,0,0] op_sel_hi:[1,0,1]
  v_pk_fma_f32 v[122:123], v[122:123], v[162:163], v[198:199] op_sel:[0,0,0] op_sel_hi:[1,0,1]
  v_pk_fma_f32 v[128:129], v[128:129], v[164:165], v[200:201] op_sel:[0,0,0] op_sel_hi:[1,0,1]
  v_pk_fma_f32 v[130:131], v[130:131], v[164:165], v[202:203] op_sel:[0,0,0] op_sel_hi:[1,0,1]
  v_pk_fma_f32 v[136:137], v[136:137], v[166:167], v[204:205] op_sel:[0,0,0] op_sel_hi:[1,0,1]
  v_pk_fma_f32 v[138:139], v[138:139], v[166:167], v[206:207] op_sel:[0,0,0] op_sel_hi:[1,0,1]
  v_pk_mul_f32 v[192:193], v[112:113], v[112:113]
  v_pk_mul_f32 v[194:195], v[114:115], v[114:115]
  v_pk_mul_f32 v[196:197], v[120:121], v[120:121]
  v_pk_mul_f32 v[198:199], v[122:123], v[122:123]
  v_pk_mul_f32 v[200:201], v[128:129], v[128:129]
  v_pk_mul_f32 v[202:203], v[130:131], v[130:131]
  v_pk_mul_f32 v[204:205], v[136:137], v[136:137]
  v_pk_mul_f32 v[206:207], v[138:139], v[138:139]
  v_pk_fma_f32 v[192:193], v[192:193], s[50:51], v[54:55]
  v_pk_fma_f32 v[194:195], v[194:195], s[50:51], v[54:55]
  v_pk_fma_f32 v[196:197], v[196:197], s[50:51], v[54:55]
  v_pk_fma_f32 v[198:199], v[198:199], s[50:51], v[54:55]
  v_pk_fma_f32 v[200:201], v[200:201], s[50:51], v[54:55]
  v_pk_fma_f32 v[202:203], v[202:203], s[50:51], v[54:55]
  v_pk_fma_f32 v[204:205], v[204:205], s[50:51], v[54:55]
  v_pk_fma_f32 v[206:207], v[206:207], s[50:51], v[54:55]
  v_pk_mul_f32 v[192:193], v[192:193], v[112:113]
  v_pk_mul_f32 v[194:195], v[194:195], v[114:115]
  v_pk_mul_f32 v[196:197], v[196:197], v[120:121]
  v_pk_mul_f32 v[198:199], v[198:199], v[122:123]
  v_pk_mul_f32 v[200:201], v[200:201], v[128:129]
  v_pk_mul_f32 v[202:203], v[202:203], v[130:131]
  v_pk_mul_f32 v[204:205], v[204:205], v[136:137]
  v_pk_mul_f32 v[206:207], v[206:207], v[138:139]
  v_exp_f32 v192, v192
  v_exp_f32 v193, v193
  v_exp_f32 v194, v194
  v_exp_f32 v195, v195
  v_exp_f32 v196, v196
  v_exp_f32 v197, v197
  v_exp_f32 v198, v198
  v_exp_f32 v199, v199
  v_exp_f32 v200, v200
  v_exp_f32 v201, v201
  v_exp_f32 v202, v202
  v_exp_f32 v203, v203
  v_exp_f32 v204, v204
  v_exp_f32 v205, v205
  v_exp_f32 v206, v206
  v_exp_f32 v207, v207
  v_pk_add_f32 v[192:193], v[192:193], 1.0 op_sel_hi:[1,0]
  v_pk_add_f32 v[194:195], v[194:195], 1.0 op_sel_hi:[1,0]
  v_pk_add_f32 v[196:197], v[196:197], 1.0 op_sel_hi:[1,0]
  v_pk_add_f32 v[198:199], v[198:199], 1.0 op_sel_hi:[1,0]
  v_pk_add_f32 v[200:201], v[200:201], 1.0 op_sel_hi:[1,0]
  v_pk_add_f32 v[202:203], v[202:203], 1.0 op_sel_hi:[1,0]
  v_pk_add_f32 v[204:205], v[204:205], 1.0 op_sel_hi:[1,0]
  v_pk_add_f32 v[206:207], v[206:207], 1.0 op_sel_hi:[1,0]
  v_rcp_f32 v192, v192
  v_rcp_f32 v193, v193
  v_rcp_f32 v194, v194
  v_rcp_f32 v195, v195
  v_rcp_f32 v196, v196
  v_rcp_f32 v197, v197
  v_rcp_f32 v198, v198
  v_rcp_f32 v199, v199
  v_rcp_f32 v200, v200
  v_rcp_f32 v201, v201
  v_rcp_f32 v202, v202
  v_rcp_f32 v203, v203
  v_rcp_f32 v204, v204
  v_rcp_f32 v205, v205
  v_rcp_f32 v206, v206
  v_rcp_f32 v207, v207
  v_pk_mul_f32 v[112:113], v[112:113], v[192:193]
  v_pk_mul_f32 v[114:115], v[114:115], v[194:195]
  v_pk_mul_f32 v[120:121], v[120:121], v[196:197]
  v_pk_mul_f32 v[122:123], v[122:123], v[198:199]
  v_pk_mul_f32 v[128:129], v[128:129], v[200:201]
  v_pk_mul_f32 v[130:131], v[130:131], v[202:203]
  v_pk_mul_f32 v[136:137], v[136:137], v[204:205]
  v_pk_mul_f32 v[138:139], v[138:139], v[206:207]
  v_cvt_pk_bf16_f32 v112, v112, v113
  v_cvt_pk_bf16_f32 v113, v114, v115
  ds_write_b64 v65, v[112:113] offset:0
  v_cvt_pk_bf16_f32 v120, v120, v121
  v_cvt_pk_bf16_f32 v121, v122, v123
  ds_write_b64 v65, v[120:121] offset:3584
  v_cvt_pk_bf16_f32 v128, v128, v129
  v_cvt_pk_bf16_f32 v129, v130, v131
  ds_write_b64 v65, v[128:129] offset:7168
  v_cvt_pk_bf16_f32 v136, v136, v137
  v_cvt_pk_bf16_f32 v137, v138, v139
  ds_write_b64 v65, v[136:137] offset:10752
  v_pk_fma_f32 v[192:193], v[160:161], v[24:25], v[32:33] op_sel:[1,0,0] op_sel_hi:[1,1,1] neg_lo:[1,0,0] neg_hi:[1,0,0]
  v_pk_fma_f32 v[194:195], v[160:161], v[26:27], v[34:35] op_sel:[1,0,0] op_sel_hi:[1,1,1] neg_lo:[1,0,0] neg_hi:[1,0,0]
  v_pk_fma_f32 v[196:197], v[162:163], v[24:25], v[32:33] op_sel:[1,0,0] op_sel_hi:[1,1,1] neg_lo:[1,0,0] neg_hi:[1,0,0]
  v_pk_fma_f32 v[198:199], v[162:163], v[26:27], v[34:35] op_sel:[1,0,0] op_sel_hi:[1,1,1] neg_lo:[1,0,0] neg_hi:[1,0,0]
  v_pk_fma_f32 v[200:201], v[164:165], v[24:25], v[32:33] op_sel:[1,0,0] op_sel_hi:[1,1,1] neg_lo:[1,0,0] neg_hi:[1,0,0]
  v_pk_fma_f32 v[202:203], v[164:165], v[26:27], v[34:35] op_sel:[1,0,0] op_sel_hi:[1,1,1] neg_lo:[1,0,0] neg_hi:[1,0,0]
  v_pk_fma_f32 v[204:205], v[166:167], v[24:25], v[32:33] op_sel:[1,0,0] op_sel_hi:[1,1,1] neg_lo:[1,0,0] neg_hi:[1,0,0]
  v_pk_fma_f32 v[206:207], v[166:167], v[26:27], v[34:35] op_sel:[1,0,0] op_sel_hi:[1,1,1] neg_lo:[1,0,0] neg_hi:[1,0,0]
  v_pk_fma_f32 v[116:117], v[116:117], v[160:161], v[192:193] op_sel:[0,0,0] op_sel_hi:[1,0,1]
  v_pk_fma_f32 v[118:119], v[118:119], v[160:161], v[194:195] op_sel:[0,0,0] op_sel_hi:[1,0,1]
  v_pk_fma_f32 v[124:125], v[124:125], v[162:163], v[196:197] op_sel:[0,0,0] op_sel_hi:[1,0,1]
  v_pk_fma_f32 v[126:127], v[126:127], v[162:163], v[198:199] op_sel:[0,0,0] op_sel_hi:[1,0,1]
  v_pk_fma_f32 v[132:133], v[132:133], v[164:165], v[200:201] op_sel:[0,0,0] op_sel_hi:[1,0,1]
  v_pk_fma_f32 v[134:135], v[134:135], v[164:165], v[202:203] op_sel:[0,0,0] op_sel_hi:[1,0,1]
  v_pk_fma_f32 v[140:141], v[140:141], v[166:167], v[204:205] op_sel:[0,0,0] op_sel_hi:[1,0,1]
  v_pk_fma_f32 v[142:143], v[142:143], v[166:167], v[206:207] op_sel:[0,0,0] op_sel_hi:[1,0,1]
  v_pk_mul_f32 v[192:193], v[116:117], v[116:117]
  v_pk_mul_f32 v[194:195], v[118:119], v[118:119]
  v_pk_mul_f32 v[196:197], v[124:125], v[124:125]
  v_pk_mul_f32 v[198:199], v[126:127], v[126:127]
  v_pk_mul_f32 v[200:201], v[132:133], v[132:133]
  v_pk_mul_f32 v[202:203], v[134:135], v[134:135]
  v_pk_mul_f32 v[204:205], v[140:141], v[140:141]
  v_pk_mul_f32 v[206:207], v[142:143], v[142:143]
  v_pk_fma_f32 v[192:193], v[192:193], s[50:51], v[54:55]
  v_pk_fma_f32 v[194:195], v[194:195], s[50:51], v[54:55]
  v_pk_fma_f32 v[196:197], v[196:197], s[50:51], v[54:55]
  v_pk_fma_f32 v[198:199], v[198:199], s[50:51], v[54:55]
  v_pk_fma_f32 v[200:201], v[200:201], s[50:51], v[54:55]
  v_pk_fma_f32 v[202:203], v[202:203], s[50:51], v[54:55]
  v_pk_fma_f32 v[204:205], v[204:205], s[50:51], v[54:55]
  v_pk_fma_f32 v[206:207], v[206:207], s[50:51], v[54:55]
  v_pk_mul_f32 v[192:193], v[192:193], v[116:117]
  v_pk_mul_f32 v[194:195], v[194:195], v[118:119]
  v_pk_mul_f32 v[196:197], v[196:197], v[124:125]
  v_pk_mul_f32 v[198:199], v[198:199], v[126:127]
  v_pk_mul_f32 v[200:201], v[200:201], v[132:133]
  v_pk_mul_f32 v[202:203], v[202:203], v[134:135]
  v_pk_mul_f32 v[204:205], v[204:205], v[140:141]
  v_pk_mul_f32 v[206:207], v[206:207], v[142:143]
  v_exp_f32 v192, v192
  v_exp_f32 v193, v193
  v_exp_f32 v194, v194
  v_exp_f32 v195, v195
  v_exp_f32 v196, v196
  v_exp_f32 v197, v197
  v_exp_f32 v198, v198
  v_exp_f32 v199, v199
  v_exp_f32 v200, v200
  v_exp_f32 v201, v201
  v_exp_f32 v202, v202
  v_exp_f32 v203, v203
  v_exp_f32 v204, v204
  v_exp_f32 v205, v205
  v_exp_f32 v206, v206
  v_exp_f32 v207, v207
  v_pk_add_f32 v[192:193], v[192:193], 1.0 op_sel_hi:[1,0]
  v_pk_add_f32 v[194:195], v[194:195], 1.0 op_sel_hi:[1,0]
  v_pk_add_f32 v[196:197], v[196:197], 1.0 op_sel_hi:[1,0]
  v_pk_add_f32 v[198:199], v[198:199], 1.0 op_sel_hi:[1,0]
  v_pk_add_f32 v[200:201], v[200:201], 1.0 op_sel_hi:[1,0]
  v_pk_add_f32 v[202:203], v[202:203], 1.0 op_sel_hi:[1,0]
  v_pk_add_f32 v[204:205], v[204:205], 1.0 op_sel_hi:[1,0]
  v_pk_add_f32 v[206:207], v[206:207], 1.0 op_sel_hi:[1,0]
  v_rcp_f32 v192, v192
  v_rcp_f32 v193, v193
  v_rcp_f32 v194, v194
  v_rcp_f32 v195, v195
  v_rcp_f32 v196, v196
  v_rcp_f32 v197, v197
  v_rcp_f32 v198, v198
  v_rcp_f32 v199, v199
  v_rcp_f32 v200, v200
  v_rcp_f32 v201, v201
  v_rcp_f32 v202, v202
  v_rcp_f32 v203, v203
  v_rcp_f32 v204, v204
  v_rcp_f32 v205, v205
  v_rcp_f32 v206, v206
  v_rcp_f32 v207, v207
  v_pk_mul_f32 v[116:117], v[116:117], v[192:193]
  v_pk_mul_f32 v[118:119], v[118:119], v[194:195]
  v_pk_mul_f32 v[124:125], v[124:125], v[196:197]
  v_pk_mul_f32 v[126:127], v[126:127], v[198:199]
  v_pk_mul_f32 v[132:133], v[132:133], v[200:201]
  v_pk_mul_f32 v[134:135], v[134:135], v[202:203]
  v_pk_mul_f32 v[140:141], v[140:141], v[204:205]
  v_pk_mul_f32 v[142:143], v[142:143], v[206:207]
  s_cmp_eq_u32 s3, 3
  s_cbranch_scc1 adaLN_cond__spectral_fnet__mixer_gmlp__prompt_kernel_z1skip63
  v_cvt_pk_bf16_f32 v116, v116, v117
  v_cvt_pk_bf16_f32 v117, v118, v119
  ds_write_b64 v66, v[116:117] offset:0
  v_cvt_pk_bf16_f32 v124, v124, v125
  v_cvt_pk_bf16_f32 v125, v126, v127
  ds_write_b64 v66, v[124:125] offset:3584
  v_cvt_pk_bf16_f32 v132, v132, v133
  v_cvt_pk_bf16_f32 v133, v134, v135
  ds_write_b64 v66, v[132:133] offset:7168
  v_cvt_pk_bf16_f32 v140, v140, v141
  v_cvt_pk_bf16_f32 v141, v142, v143
  ds_write_b64 v66, v[140:141] offset:10752
adaLN_cond__spectral_fnet__mixer_gmlp__prompt_kernel_z1skip63:
  s_add_u32 s41, s33, 512
  buffer_load_dwordx4 a[128:131], v4, s[8:11], s41 offen
  s_add_u32 s41, s33, 33280
  buffer_load_dwordx4 a[132:135], v5, s[8:11], s41 offen
  s_add_u32 s41, s33, 66048
  buffer_load_dwordx4 a[136:139], v6, s[8:11], s41 offen
  s_add_u32 s41, s33, 98816
  buffer_load_dwordx4 a[140:143], v7, s[8:11], s41 offen
  s_add_u32 s41, s33, 131584
  buffer_load_dwordx4 a[144:147], v4, s[8:11], s41 offen
  s_add_u32 s41, s33, 164352
  buffer_load_dwordx4 a[148:151], v5, s[8:11], s41 offen
  s_add_u32 s41, s33, 197120
  buffer_load_dwordx4 a[152:155], v6, s[8:11], s41 offen
  s_add_u32 s41, s33, 229888
  buffer_load_dwordx4 a[156:159], v7, s[8:11], s41 offen
  s_add_u32 s41, s33, 640
  buffer_load_dwordx4 a[160:163], v4, s[8:11], s41 offen
  s_add_u32 s41, s33, 33408
  buffer_load_dwordx4 a[164:167], v5, s[8:11], s41 offen
  s_add_u32 s41, s33, 66176
  buffer_load_dwordx4 a[168:171], v6, s[8:11], s41 offen
  s_add_u32 s41, s33, 98944
  buffer_load_dwordx4 a[172:175], v7, s[8:11], s41 offen
  s_add_u32 s41, s33, 131712
  buffer_load_dwordx4 a[176:179], v4, s[8:11], s41 offen
  s_add_u32 s41, s33, 164480
  buffer_load_dwordx4 a[180:183], v5, s[8:11], s41 offen
  s_add_u32 s41, s33, 197248
  buffer_load_dwordx4 a[184:187], v6, s[8:11], s41 offen
  s_add_u32 s41, s33, 230016
  buffer_load_dwordx4 a[188:191], v7, s[8:11], s41 offen
  s_add_u32 s41, s33, 768
  buffer_load_dwordx4 a[192:195], v4, s[8:11], s41 offen
  s_add_u32 s41, s33, 33536
  buffer_load_dwordx4 a[196:199], v5, s[8:11], s41 offen
  s_add_u32 s41, s33, 66304
  buffer_load_dwordx4 a[200:203], v6, s[8:11], s41 offen
  s_add_u32 s41, s33, 99072
  buffer_load_dwordx4 a[204:207], v7, s[8:11], s41 offen
  s_add_u32 s41, s33, 131840
  buffer_load_dwordx4 a[208:211], v4, s[8:11], s41 offen
  s_add_u32 s41, s33, 164608
  buffer_load_dwordx4 a[212:215], v5, s[8:11], s41 offen
  s_add_u32 s41, s33, 197376
  buffer_load_dwordx4 a[216:219], v6, s[8:11], s41 offen
  s_add_u32 s41, s33, 230144
  buffer_load_dwordx4 a[220:223], v7, s[8:11], s41 offen
  s_add_u32 s41, s33, 896
  buffer_load_dwordx4 a[224:227], v4, s[8:11], s41 offen
  s_add_u32 s41, s33, 33664
  buffer_load_dwordx4 a[228:231], v5, s[8:11], s41 offen
  s_add_u32 s41, s33, 66432
  buffer_load_dwordx4 a[232:235], v6, s[8:11], s41 offen
  s_add_u32 s41, s33, 99200
  buffer_load_dwordx4 a[236:239], v7, s[8:11], s41 offen
  s_add_u32 s41, s33, 131968
  buffer_load_dwordx4 a[240:243], v4, s[8:11], s41 offen
  s_add_u32 s41, s33, 164736
  buffer_load_dwordx4 a[244:247], v5, s[8:11], s41 offen
  s_add_u32 s41, s33, 197504
  buffer_load_dwordx4 a[248:251], v6, s[8:11], s41 offen
  s_add_u32 s41, s33, 230272
  buffer_load_dwordx4 a[252:255], v7, s[8:11], s41 offen
  s_mov_b32 s88, 23068672
  s_mov_b32 s89, 0x40000
adaLN_cond__spectral_fnet__mixer_gmlp__prompt_kernel_gb60:
  buffer_load_dword v244, v250, s[96:99], s88 offen sc1
  s_waitcnt vmcnt(0)
  v_cmp_le_u32 vcc, 0x40000000, v250
  s_nop 1
  v_cndmask_b32 v244, v244, v254, vcc
  v_xor_b32 v244, v244, v254
  v_cmp_ne_u32 vcc, 0, v244
  s_nop 4
  s_cbranch_vccz adaLN_cond__spectral_fnet__mixer_gmlp__prompt_kernel_gbd61
  s_sub_u32 s89, s89, 1
  s_cmp_lg_u32 s89, 0
  s_cbranch_scc1 adaLN_cond__spectral_fnet__mixer_gmlp__prompt_kernel_gb60
adaLN_cond__spectral_fnet__mixer_gmlp__prompt_kernel_gbd61:
  s_mov_b64 s[90:91], exec
  s_branch adaLN_cond__spectral_fnet__mixer_gmlp__prompt_kernel_join264
adaLN_cond__spectral_fnet__mixer_gmlp__prompt_kernel_join59:
  s_getpc_b64 s[92:93]
adaLN_cond__spectral_fnet__mixer_gmlp__prompt_kernel_ct65:
  s_lshl_b32 s94, s3, 13
  v_and_b32 v244, 63, v0
  v_lshlrev_b32 v244, 7, v244
  v_add_u32 v244, s94, v244
  v_cmp_gt_u32 vcc, code_end-adaLN_cond__spectral_fnet__mixer_gmlp__prompt_kernel_ct65, v244
  s_nop 0
  s_and_saveexec_b64 s[94:95], vcc
  s_cbranch_execz adaLN_cond__spectral_fnet__mixer_gmlp__prompt_kernel_ctn66
  global_load_dword v245, v244, s[92:93]
adaLN_cond__spectral_fnet__mixer_gmlp__prompt_kernel_ctn66:
  s_mov_b64 exec, s[94:95]
  v_lshrrev_b32 v64, 2, v3
  v_and_b32 v65, 3, v3
  v_lshl_add_u32 v64, v64, 3, v65
  v_lshlrev_b32 v64, 2, v64
  v_add_u32 v64, 145408, v64
  ds_read2_b32 v[160:161], v64 offset0:0 offset1:64
  ds_read2_b32 v[162:163], v64 offset0:4 offset1:68
  ds_read2_b32 v[164:165], v64 offset0:32 offset1:96
  ds_read2_b32 v[166:167], v64 offset0:36 offset1:100
  s_waitcnt lgkmcnt(0)
  v_lshlrev_b32 v65, 3, v1
  s_lshl_b32 s62, s3, 10
  s_add_u32 s62, s62, 131072
  v_add_u32 v65, s62, v65
  v_add_u32 v66, 512, v65
  v_pk_fma_f32 v[192:193], v[160:161], v[20:21], v[28:29] op_sel:[1,0,0] op_sel_hi:[1,1,1] neg_lo:[1,0,0] neg_hi:[1,0,0]
  s_add_u32 s41, s33, 0
  s_add_u32 m0, s35, 0
  s_nop 0
  buffer_load_dwordx4 v4, s[8:11], s41 offen lds
  v_pk_fma_f32 v[194:195], v[160:161], v[22:23], v[30:31] op_sel:[1,0,0] op_sel_hi:[1,1,1] neg_lo:[1,0,0] neg_hi:[1,0,0]
  s_add_u32 s41, s33, 32768
  s_add_u32 m0, s35, 1024
  s_nop 0
  buffer_load_dwordx4 v5, s[8:11], s41 offen lds
  v_pk_fma_f32 v[196:197], v[162:163], v[20:21], v[28:29] op_sel:[1,0,0] op_sel_hi:[1,1,1] neg_lo:[1,0,0] neg_hi:[1,0,0]
  s_add_u32 s41, s33, 65536
  s_add_u32 m0, s35, 2048
  s_nop 0
  buffer_load_dwordx4 v6, s[8:11], s41 offen lds
  v_pk_fma_f32 v[198:199], v[162:163], v[22:23], v[30:31] op_sel:[1,0,0] op_sel_hi:[1,1,1] neg_lo:[1,0,0] neg_hi:[1,0,0]
  s_add_u32 s41, s33, 98304
  s_add_u32 m0, s35, 3072
  s_nop 0
  buffer_load_dwordx4 v7, s[8:11], s41 offen lds
  v_pk_fma_f32 v[200:201], v[164:165], v[20:21], v[28:29] op_sel:[1,0,0] op_sel_hi:[1,1,1] neg_lo:[1,0,0] neg_hi:[1,0,0]
  s_add_u32 s41, s33, 131072
  s_add_u32 m0, s35, 4096
  s_nop 0
  buffer_load_dwordx4 v4, s[8:11], s41 offen lds
  v_pk_fma_f32 v[202:203], v[164:165], v[22:23], v[30:31] op_sel:[1,0,0] op_sel_hi:[1,1,1] neg_lo:[1,0,0] neg_hi:[1,0,0]
  s_add_u32 s41, s33, 163840
  s_add_u32 m0, s35, 5120
  s_nop 0
  buffer_load_dwordx4 v5, s[8:11], s41 offen lds
  v_pk_fma_f32 v[204:205], v[166:167], v[20:21], v[28:29] op_sel:[1,0,0] op_sel_hi:[1,1,1] neg_lo:[1,0,0] neg_hi:[1,0,0]
  s_add_u32 s41, s33, 196608
  s_add_u32 m0, s35, 6144
  s_nop 0
  buffer_load_dwordx4 v6, s[8:11], s41 offen lds
  v_pk_fma_f32 v[206:207], v[166:167], v[22:23], v[30:31] op_sel:[1,0,0] op_sel_hi:[1,1,1] neg_lo:[1,0,0] neg_hi:[1,0,0]
  s_add_u32 s41, s33, 229376
  s_add_u32 m0, s35, 7168
  s_nop 0
  buffer_load_dwordx4 v7, s[8:11], s41 offen lds
  v_pk_fma_f32 v[112:113], v[112:113], v[160:161], v[192:193] op_sel:[0,0,0] op_sel_hi:[1,0,1]
  s_add_u32 s41, s33, 128
  s_add_u32 m0, s35, 8192
  s_nop 0
  buffer_load_dwordx4 v4, s[8:11], s41 offen lds
  v_pk_fma_f32 v[114:115], v[114:115], v[160:161], v[194:195] op_sel:[0,0,0] op_sel_hi:[1,0,1]
  s_add_u32 s41, s33, 32896
  s_add_u32 m0, s35, 9216
  s_nop 0
  buffer_load_dwordx4 v5, s[8:11], s41 offen lds
  v_pk_fma_f32 v[120:121], v[120:121], v[162:163], v[196:197] op_sel:[0,0,0] op_sel_hi:[1,0,1]
  s_add_u32 s41, s33, 65664
  s_add_u32 m0, s35, 10240
  s_nop 0
  buffer_load_dwordx4 v6, s[8:11], s41 offen lds
  v_pk_fma_f32 v[122:123], v[122:123], v[162:163], v[198:199] op_sel:[0,0,0] op_sel_hi:[1,0,1]
  s_add_u32 s41, s33, 98432
  s_add_u32 m0, s35, 11264
  s_nop 0
  buffer_load_dwordx4 v7, s[8:11], s41 offen lds
  v_pk_fma_f32 v[128:129], v[128:129], v[164:165], v[200:201] op_sel:[0,0,0] op_sel_hi:[1,0,1]
  s_add_u32 s41, s33, 131200
  s_add_u32 m0, s35, 12288
  s_nop 0
  buffer_load_dwordx4 v4, s[8:11], s41 offen lds
  v_pk_fma_f32 v[130:131], v[130:131], v[164:165], v[202:203] op_sel:[0,0,0] op_sel_hi:[1,0,1]
  s_add_u32 s41, s33, 163968
  s_add_u32 m0, s35, 13312
  s_nop 0
  buffer_load_dwordx4 v5, s[8:11], s41 offen lds
  v_pk_fma_f32 v[136:137], v[136:137], v[166:167], v[204:205] op_sel:[0,0,0] op_sel_hi:[1,0,1]
  s_add_u32 s41, s33, 196736
  s_add_u32 m0, s35, 14336
  s_nop 0
  buffer_load_dwordx4 v6, s[8:11], s41 offen lds
  v_pk_fma_f32 v[138:139], v[138:139], v[166:167], v[206:207] op_sel:[0,0,0] op_sel_hi:[1,0,1]
  s_add_u32 s41, s33, 229504
  s_add_u32 m0, s35, 15360
  s_nop 0
  buffer_load_dwordx4 v7, s[8:11], s41 offen lds
  v_pk_mul_f32 v[192:193], v[112:113], v[112:113]
  v_pk_mul_f32 v[194:195], v[114:115], v[114:115]
  v_pk_mul_f32 v[196:197], v[120:121], v[120:121]
  v_pk_mul_f32 v[198:199], v[122:123], v[122:123]
  v_pk_mul_f32 v[200:201], v[128:129], v[128:129]
  v_pk_mul_f32 v[202:203], v[130:131], v[130:131]
  v_pk_mul_f32 v[204:205], v[136:137], v[136:137]
  v_pk_mul_f32 v[206:207], v[138:139], v[138:139]
  v_pk_fma_f32 v[192:193], v[192:193], s[50:51], v[54:55]
  v_pk_fma_f32 v[194:195], v[194:195], s[50:51], v[54:55]
  v_pk_fma_f32 v[196:197], v[196:197], s[50:51], v[54:55]
  v_pk_fma_f32 v[198:199], v[198:199], s[50:51], v[54:55]
  v_pk_fma_f32 v[200:201], v[200:201], s[50:51], v[54:55]
  v_pk_fma_f32 v[202:203], v[202:203], s[50:51], v[54:55]
  v_pk_fma_f32 v[204:205], v[204:205], s[50:51], v[54:55]
  v_pk_fma_f32 v[206:207], v[206:207], s[50:51], v[54:55]
  v_pk_mul_f32 v[192:193], v[192:193], v[112:113]
  v_pk_mul_f32 v[194:195], v[194:195], v[114:115]
  v_pk_mul_f32 v[196:197], v[196:197], v[120:121]
  v_pk_mul_f32 v[198:199], v[198:199], v[122:123]
  v_pk_mul_f32 v[200:201], v[200:201], v[128:129]
  v_pk_mul_f32 v[202:203], v[202:203], v[130:131]
  v_pk_mul_f32 v[204:205], v[204:205], v[136:137]
  v_pk_mul_f32 v[206:207], v[206:207], v[138:139]
  v_exp_f32 v192, v192
  v_exp_f32 v193, v193
  s_add_u32 s41, s33, 256
  s_add_u32 m0, s35, 16384
  s_nop 0
  buffer_load_dwordx4 v4, s[8:11], s41 offen lds
  v_exp_f32 v194, v194
  v_exp_f32 v195, v195
  s_add_u32 s41, s33, 33024
  s_add_u32 m0, s35, 17408
  s_nop 0
  buffer_load_dwordx4 v5, s[8:11], s41 offen lds
  v_exp_f32 v196, v196
  v_exp_f32 v197, v197
  s_add_u32 s41, s33, 65792
  s_add_u32 m0, s35, 18432
  s_nop 0
  buffer_load_dwordx4 v6, s[8:11], s41 offen lds
  v_exp_f32 v198, v198
  v_exp_f32 v199, v199
  s_add_u32 s41, s33, 98560
  s_add_u32 m0, s35, 19456
  s_nop 0
  buffer_load_dwordx4 v7, s[8:11], s41 offen lds
  v_exp_f32 v200, v200
  v_exp_f32 v201, v201
  s_add_u32 s41, s33, 131328
  s_add_u32 m0, s35, 20480
  s_nop 0
  buffer_load_dwordx4 v4, s[8:11], s41 offen lds
  v_exp_f32 v202, v202
  v_exp_f32 v203, v203
  s_add_u32 s41, s33, 164096
  s_add_u32 m0, s35, 21504
  s_nop 0
  buffer_load_dwordx4 v5, s[8:11], s41 offen lds
  v_exp_f32 v204, v204
  v_exp_f32 v205, v205
  s_add_u32 s41, s33, 196864
  s_add_u32 m0, s35, 22528
  s_nop 0
  buffer_load_dwordx4 v6, s[8:11], s41 offen lds
  v_exp_f32 v206, v206
  v_exp_f32 v207, v207
  s_add_u32 s41, s33, 229632
  s_add_u32 m0, s35, 23552
  s_nop 0
  buffer_load_dwordx4 v7, s[8:11], s41 offen lds
  v_pk_add_f32 v[192:193], v[192:193], 1.0 op_sel_hi:[1,0]
  v_pk_add_f32 v[194:195], v[194:195], 1.0 op_sel_hi:[1,0]
  v_pk_add_f32 v[196:197], v[196:197], 1.0 op_sel_hi:[1,0]
  v_pk_add_f32 v[198:199], v[198:199], 1.0 op_sel_hi:[1,0]
  v_pk_add_f32 v[200:201], v[200:201], 1.0 op_sel_hi:[1,0]
  v_pk_add_f32 v[202:203], v[202:203], 1.0 op_sel_hi:[1,0]
  v_pk_add_f32 v[204:205], v[204:205], 1.0 op_sel_hi:[1,0]
  v_pk_add_f32 v[206:207], v[206:207], 1.0 op_sel_hi:[1,0]
  v_rcp_f32 v192, v192
  v_rcp_f32 v193, v193
  s_add_u32 s41, s33, 384
  s_add_u32 m0, s35, 24576
  s_nop 0
  buffer_load_dwordx4 v4, s[8:11], s41 offen lds
  v_rcp_f32 v194, v194
  v_rcp_f32 v195, v195
  s_add_u32 s41, s33, 33152
  s_add_u32 m0, s35, 25600
  s_nop 0
  buffer_load_dwordx4 v5, s[8:11], s41 offen lds
  v_rcp_f32 v196, v196
  v_rcp_f32 v197, v197
  s_add_u32 s41, s33, 65920
  s_add_u32 m0, s35, 26624
  s_nop 0
  buffer_load_dwordx4 v6, s[8:11], s41 offen lds
  v_rcp_f32 v198, v198
  v_rcp_f32 v199, v199
  s_add_u32 s41, s33, 98688
  s_add_u32 m0, s35, 27648
  s_nop 0
  buffer_load_dwordx4 v7, s[8:11], s41 offen lds
  v_rcp_f32 v200, v200
  v_rcp_f32 v201, v201
  s_add_u32 s41, s33, 131456
  s_add_u32 m0, s35, 28672
  s_nop 0
  buffer_load_dwordx4 v4, s[8:11], s41 offen lds
  v_rcp_f32 v202, v202
  v_rcp_f32 v203, v203
  s_add_u32 s41, s33, 164224
  s_add_u32 m0, s35, 29696
  s_nop 0
  buffer_load_dwordx4 v5, s[8:11], s41 offen lds
  v_rcp_f32 v204, v204
  v_rcp_f32 v205, v205
  s_add_u32 s41, s33, 196992
  s_add_u32 m0, s35, 30720
  s_nop 0
  buffer_load_dwordx4 v6, s[8:11], s41 offen lds
  v_rcp_f32 v206, v206
  v_rcp_f32 v207, v207
  s_add_u32 s41, s33, 229760
  s_add_u32 m0, s35, 31744
  s_nop 0
  buffer_load_dwordx4 v7, s[8:11], s41 offen lds
  v_pk_mul_f32 v[112:113], v[112:113], v[192:193]
  v_pk_mul_f32 v[114:115], v[114:115], v[194:195]
  v_pk_mul_f32 v[120:121], v[120:121], v[196:197]
  v_pk_mul_f32 v[122:123], v[122:123], v[198:199]
  v_pk_mul_f32 v[128:129], v[128:129], v[200:201]
  v_pk_mul_f32 v[130:131], v[130:131], v[202:203]
  v_pk_mul_f32 v[136:137], v[136:137], v[204:205]
  v_pk_mul_f32 v[138:139], v[138:139], v[206:207]
  v_cvt_pk_bf16_f32 v112, v112, v113
  v_cvt_pk_bf16_f32 v113, v114, v115
  ds_write_b64 v65, v[112:113] offset:0
  v_cvt_pk_bf16_f32 v120, v120, v121
  v_cvt_pk_bf16_f32 v121, v122, v123
  ds_write_b64 v65, v[120:121] offset:3584
  v_cvt_pk_bf16_f32 v128, v128, v129
  v_cvt_pk_bf16_f32 v129, v130, v131
  ds_write_b64 v65, v[128:129] offset:7168
  v_cvt_pk_bf16_f32 v136, v136, v137
  v_cvt_pk_bf16_f32 v137, v138, v139
  ds_write_b64 v65, v[136:137] offset:10752
  v_pk_fma_f32 v[192:193], v[160:161], v[24:25], v[32:33] op_sel:[1,0,0] op_sel_hi:[1,1,1] neg_lo:[1,0,0] neg_hi:[1,0,0]
  s_add_u32 s42, s3, 0
  s_and_b32 s43, s42, 7
  s_lshr_b32 s44, s42, 3
  s_lshl_b32 s41, s43, 15
  s_lshl_b32 s45, s44, 7
  s_add_u32 s41, s41, s45
  s_add_u32 s41, s41, s66
  s_and_b32 s45, s43, 3
  s_lshl_b32 s45, s45, 5
  v_xor_b32 v47, s45, v4
  s_lshl_b32 s45, s44, 13
  s_lshl_b32 s43, s43, 10
  s_add_u32 s45, s45, s43
  s_add_u32 m0, s45, s67
  s_nop 0
  buffer_load_dwordx4 v47, s[8:11], s41 offen lds
  v_pk_fma_f32 v[194:195], v[160:161], v[26:27], v[34:35] op_sel:[1,0,0] op_sel_hi:[1,1,1] neg_lo:[1,0,0] neg_hi:[1,0,0]
  s_add_u32 s42, s3, 3
  s_and_b32 s43, s42, 7
  s_lshr_b32 s44, s42, 3
  s_lshl_b32 s41, s43, 15
  s_lshl_b32 s45, s44, 7
  s_add_u32 s41, s41, s45
  s_add_u32 s41, s41, s66
  s_and_b32 s45, s43, 3
  s_lshl_b32 s45, s45, 5
  v_xor_b32 v47, s45, v4
  s_lshl_b32 s45, s44, 13
  s_lshl_b32 s43, s43, 10
  s_add_u32 s45, s45, s43
  s_add_u32 m0, s45, s67
  s_nop 0
  buffer_load_dwordx4 v47, s[8:11], s41 offen lds
  v_pk_fma_f32 v[196:197], v[162:163], v[24:25], v[32:33] op_sel:[1,0,0] op_sel_hi:[1,1,1] neg_lo:[1,0,0] neg_hi:[1,0,0]
  s_add_u32 s42, s3, 6
  s_and_b32 s43, s42, 7
  s_lshr_b32 s44, s42, 3
  s_lshl_b32 s41, s43, 15
  s_lshl_b32 s45, s44, 7
  s_add_u32 s41, s41, s45
  s_add_u32 s41, s41, s66
  s_and_b32 s45, s43, 3
  s_lshl_b32 s45, s45, 5
  v_xor_b32 v47, s45, v4
  s_lshl_b32 s45, s44, 13
  s_lshl_b32 s43, s43, 10
  s_add_u32 s45, s45, s43
  s_add_u32 m0, s45, s67
  s_nop 0
  buffer_load_dwordx4 v47, s[8:11], s41 offen lds
  v_pk_fma_f32 v[198:199], v[162:163], v[26:27], v[34:35] op_sel:[1,0,0] op_sel_hi:[1,1,1] neg_lo:[1,0,0] neg_hi:[1,0,0]
  s_add_u32 s42, s3, 9
  s_and_b32 s43, s42, 7
  s_lshr_b32 s44, s42, 3
  s_lshl_b32 s41, s43, 15
  s_lshl_b32 s45, s44, 7
  s_add_u32 s41, s41, s45
  s_add_u32 s41, s41, s66
  s_and_b32 s45, s43, 3
  s_lshl_b32 s45, s45, 5
  v_xor_b32 v47, s45, v4
  s_lshl_b32 s45, s44, 13
  s_lshl_b32 s43, s43, 10
  s_add_u32 s45, s45, s43
  s_add_u32 m0, s45, s67
  s_nop 0
  buffer_load_dwordx4 v47, s[8:11], s41 offen lds
  v_pk_fma_f32 v[200:201], v[164:165], v[24:25], v[32:33] op_sel:[1,0,0] op_sel_hi:[1,1,1] neg_lo:[1,0,0] neg_hi:[1,0,0]
  s_add_u32 s42, s3, 12
  s_and_b32 s43, s42, 7
  s_lshr_b32 s44, s42, 3
  s_lshl_b32 s41, s43, 15
  s_lshl_b32 s45, s44, 7
  s_add_u32 s41, s41, s45
  s_add_u32 s41, s41, s66
  s_and_b32 s45, s43, 3
  s_lshl_b32 s45, s45, 5
  v_xor_b32 v47, s45, v4
  s_lshl_b32 s45, s44, 13
  s_lshl_b32 s43, s43, 10
  s_add_u32 s45, s45, s43
  s_add_u32 m0, s45, s67
  s_nop 0
  buffer_load_dwordx4 v47, s[8:11], s41 offen lds
  v_pk_fma_f32 v[202:203], v[164:165], v[26:27], v[34:35] op_sel:[1,0,0] op_sel_hi:[1,1,1] neg_lo:[1,0,0] neg_hi:[1,0,0]
  s_add_u32 s42, s3, 15
  s_and_b32 s43, s42, 7
  s_lshr_b32 s44, s42, 3
  s_lshl_b32 s41, s43, 15
  s_lshl_b32 s45, s44, 7
  s_add_u32 s41, s41, s45
  s_add_u32 s41, s41, s66
  s_and_b32 s45, s43, 3
  s_lshl_b32 s45, s45, 5
  v_xor_b32 v47, s45, v4
  s_lshl_b32 s45, s44, 13
  s_lshl_b32 s43, s43, 10
  s_add_u32 s45, s45, s43
  s_add_u32 m0, s45, s67
  s_nop 0
  buffer_load_dwordx4 v47, s[8:11], s41 offen lds
  v_pk_fma_f32 v[204:205], v[166:167], v[24:25], v[32:33] op_sel:[1,0,0] op_sel_hi:[1,1,1] neg_lo:[1,0,0] neg_hi:[1,0,0]
  s_add_u32 s42, s3, 18
  s_and_b32 s43, s42, 7
  s_lshr_b32 s44, s42, 3
  s_lshl_b32 s41, s43, 15
  s_lshl_b32 s45, s44, 7
  s_add_u32 s41, s41, s45
  s_add_u32 s41, s41, s66
  s_and_b32 s45, s43, 3
  s_lshl_b32 s45, s45, 5
  v_xor_b32 v47, s45, v4
  s_lshl_b32 s45, s44, 13
  s_lshl_b32 s43, s43, 10
  s_add_u32 s45, s45, s43
  s_add_u32 m0, s45, s67
  s_nop 0
  buffer_load_dwordx4 v47, s[8:11], s41 offen lds
  v_pk_fma_f32 v[206:207], v[166:167], v[26:27], v[34:35] op_sel:[1,0,0] op_sel_hi:[1,1,1] neg_lo:[1,0,0] neg_hi:[1,0,0]
  s_add_u32 s42, s3, 21
  s_and_b32 s43, s42, 7
  s_lshr_b32 s44, s42, 3
  s_lshl_b32 s41, s43, 15
  s_lshl_b32 s45, s44, 7
  s_add_u32 s41, s41, s45
  s_add_u32 s41, s41, s66
  s_and_b32 s45, s43, 3
  s_lshl_b32 s45, s45, 5
  v_xor_b32 v47, s45, v4
  s_lshl_b32 s45, s44, 13
  s_lshl_b32 s43, s43, 10
  s_add_u32 s45, s45, s43
  s_add_u32 m0, s45, s67
  s_nop 0
  buffer_load_dwordx4 v47, s[8:11], s41 offen lds
  v_pk_fma_f32 v[116:117], v[116:117], v[160:161], v[192:193] op_sel:[0,0,0] op_sel_hi:[1,0,1]
  s_add_u32 s42, s3, 24
  s_and_b32 s43, s42, 7
  s_lshr_b32 s44, s42, 3
  s_lshl_b32 s41, s43, 15
  s_lshl_b32 s45, s44, 7
  s_add_u32 s41, s41, s45
  s_add_u32 s41, s41, s66
  s_and_b32 s45, s43, 3
  s_lshl_b32 s45, s45, 5
  v_xor_b32 v47, s45, v4
  s_lshl_b32 s45, s44, 13
  s_lshl_b32 s43, s43, 10
  s_add_u32 s45, s45, s43
  s_add_u32 m0, s45, s67
  s_nop 0
  buffer_load_dwordx4 v47, s[8:11], s41 offen lds
  v_pk_fma_f32 v[118:119], v[118:119], v[160:161], v[194:195] op_sel:[0,0,0] op_sel_hi:[1,0,1]
  s_add_u32 s42, s3, 27
  s_and_b32 s43, s42, 7
  s_lshr_b32 s44, s42, 3
  s_lshl_b32 s41, s43, 15
  s_lshl_b32 s45, s44, 7
  s_add_u32 s41, s41, s45
  s_add_u32 s41, s41, s66
  s_and_b32 s45, s43, 3
  s_lshl_b32 s45, s45, 5
  v_xor_b32 v47, s45, v4
  s_lshl_b32 s45, s44, 13
  s_lshl_b32 s43, s43, 10
  s_add_u32 s45, s45, s43
  s_add_u32 m0, s45, s67
  s_nop 0
  buffer_load_dwordx4 v47, s[8:11], s41 offen lds
  v_pk_fma_f32 v[124:125], v[124:125], v[162:163], v[196:197] op_sel:[0,0,0] op_sel_hi:[1,0,1]
  s_add_u32 s42, s3, 30
  s_and_b32 s43, s42, 7
  s_lshr_b32 s44, s42, 3
  s_lshl_b32 s41, s43, 15
  s_lshl_b32 s45, s44, 7
  s_add_u32 s41, s41, s45
  s_add_u32 s41, s41, s66
  s_and_b32 s45, s43, 3
  s_lshl_b32 s45, s45, 5
  v_xor_b32 v47, s45, v4
  s_lshl_b32 s45, s44, 13
  s_lshl_b32 s43, s43, 10
  s_add_u32 s45, s45, s43
  s_add_u32 m0, s45, s67
  s_cmp_lt_u32 s42, 32
  s_cbranch_scc0 adaLN_cond__spectral_fnet__mixer_gmlp__prompt_kernel_ad67
  buffer_load_dwordx4 v47, s[8:11], s41 offen lds
adaLN_cond__spectral_fnet__mixer_gmlp__prompt_kernel_ad67:
  v_pk_fma_f32 v[126:127], v[126:127], v[162:163], v[198:199] op_sel:[0,0,0] op_sel_hi:[1,0,1]
  s_add_u32 s41, s33, 512
  buffer_load_dwordx4 a[128:131], v4, s[8:11], s41 offen
  v_pk_fma_f32 v[132:133], v[132:133], v[164:165], v[200:201] op_sel:[0,0,0] op_sel_hi:[1,0,1]
  s_add_u32 s41, s33, 33280
  buffer_load_dwordx4 a[132:135], v5, s[8:11], s41 offen
  v_pk_fma_f32 v[134:135], v[134:135], v[164:165], v[202:203] op_sel:[0,0,0] op_sel_hi:[1,0,1]
  s_add_u32 s41, s33, 66048
  buffer_load_dwordx4 a[136:139], v6, s[8:11], s41 offen
  v_pk_fma_f32 v[140:141], v[140:141], v[166:167], v[204:205] op_sel:[0,0,0] op_sel_hi:[1,0,1]
  s_add_u32 s41, s33, 98816
  buffer_load_dwordx4 a[140:143], v7, s[8:11], s41 offen
  v_pk_fma_f32 v[142:143], v[142:143], v[166:167], v[206:207] op_sel:[0,0,0] op_sel_hi:[1,0,1]
  s_add_u32 s41, s33, 131584
  buffer_load_dwordx4 a[144:147], v4, s[8:11], s41 offen
  v_pk_mul_f32 v[192:193], v[116:117], v[116:117]
  v_pk_mul_f32 v[194:195], v[118:119], v[118:119]
  v_pk_mul_f32 v[196:197], v[124:125], v[124:125]
  v_pk_mul_f32 v[198:199], v[126:127], v[126:127]
  v_pk_mul_f32 v[200:201], v[132:133], v[132:133]
  v_pk_mul_f32 v[202:203], v[134:135], v[134:135]
  v_pk_mul_f32 v[204:205], v[140:141], v[140:141]
  v_pk_mul_f32 v[206:207], v[142:143], v[142:143]
  v_pk_fma_f32 v[192:193], v[192:193], s[50:51], v[54:55]
  v_pk_fma_f32 v[194:195], v[194:195], s[50:51], v[54:55]
  v_pk_fma_f32 v[196:197], v[196:197], s[50:51], v[54:55]
  v_pk_fma_f32 v[198:199], v[198:199], s[50:51], v[54:55]
  v_pk_fma_f32 v[200:201], v[200:201], s[50:51], v[54:55]
  v_pk_fma_f32 v[202:203], v[202:203], s[50:51], v[54:55]
  v_pk_fma_f32 v[204:205], v[204:205], s[50:51], v[54:55]
  v_pk_fma_f32 v[206:207], v[206:207], s[50:51], v[54:55]
  v_pk_mul_f32 v[192:193], v[192:193], v[116:117]
  v_pk_mul_f32 v[194:195], v[194:195], v[118:119]
  v_pk_mul_f32 v[196:197], v[196:197], v[124:125]
  v_pk_mul_f32 v[198:199], v[198:199], v[126:127]
  v_pk_mul_f32 v[200:201], v[200:201], v[132:133]
  v_pk_mul_f32 v[202:203], v[202:203], v[134:135]
  v_pk_mul_f32 v[204:205], v[204:205], v[140:141]
  v_pk_mul_f32 v[206:207], v[206:207], v[142:143]
  v_exp_f32 v192, v192
  v_exp_f32 v193, v193
  s_add_u32 s41, s33, 164352
  buffer_load_dwordx4 a[148:151], v5, s[8:11], s41 offen
  v_exp_f32 v194, v194
  v_exp_f32 v195, v195
  s_add_u32 s41, s33, 197120
  buffer_load_dwordx4 a[152:155], v6, s[8:11], s41 offen
  v_exp_f32 v196, v196
  v_exp_f32 v197, v197
  s_add_u32 s41, s33, 229888
  buffer_load_dwordx4 a[156:159], v7, s[8:11], s41 offen
  v_exp_f32 v198, v198
  v_exp_f32 v199, v199
  s_add_u32 s41, s33, 640
  buffer_load_dwordx4 a[160:163], v4, s[8:11], s41 offen
  v_exp_f32 v200, v200
  v_exp_f32 v201, v201
  s_add_u32 s41, s33, 33408
  buffer_load_dwordx4 a[164:167], v5, s[8:11], s41 offen
  v_exp_f32 v202, v202
  v_exp_f32 v203, v203
  s_add_u32 s41, s33, 66176
  buffer_load_dwordx4 a[168:171], v6, s[8:11], s41 offen
  v_exp_f32 v204, v204
  v_exp_f32 v205, v205
  s_add_u32 s41, s33, 98944
  buffer_load_dwordx4 a[172:175], v7, s[8:11], s41 offen
  v_exp_f32 v206, v206
  v_exp_f32 v207, v207
  s_add_u32 s41, s33, 131712
  buffer_load_dwordx4 a[176:179], v4, s[8:11], s41 offen
  v_pk_add_f32 v[192:193], v[192:193], 1.0 op_sel_hi:[1,0]
  v_pk_add_f32 v[194:195], v[194:195], 1.0 op_sel_hi:[1,0]
  v_pk_add_f32 v[196:197], v[196:197], 1.0 op_sel_hi:[1,0]
  v_pk_add_f32 v[198:199], v[198:199], 1.0 op_sel_hi:[1,0]
  v_pk_add_f32 v[200:201], v[200:201], 1.0 op_sel_hi:[1,0]
  v_pk_add_f32 v[202:203], v[202:203], 1.0 op_sel_hi:[1,0]
  v_pk_add_f32 v[204:205], v[204:205], 1.0 op_sel_hi:[1,0]
  v_pk_add_f32 v[206:207], v[206:207], 1.0 op_sel_hi:[1,0]
  v_rcp_f32 v192, v192
  v_rcp_f32 v193, v193
  s_add_u32 s41, s33, 164480
  buffer_load_dwordx4 a[180:183], v5, s[8:11], s41 offen
  v_rcp_f32 v194, v194
  v_rcp_f32 v195, v195
  s_add_u32 s41, s33, 197248
  buffer_load_dwordx4 a[184:187], v6, s[8:11], s41 offen
  v_rcp_f32 v196, v196
  v_rcp_f32 v197, v197
  s_add_u32 s41, s33, 230016
  buffer_load_dwordx4 a[188:191], v7, s[8:11], s41 offen
  v_rcp_f32 v198, v198
  v_rcp_f32 v199, v199
  s_add_u32 s41, s33, 768
  buffer_load_dwordx4 a[192:195], v4, s[8:11], s41 offen
  v_rcp_f32 v200, v200
  v_rcp_f32 v201, v201
  s_waitcnt vmcnt(48)
  s_add_u32 s41, s33, 33536
  buffer_load_dwordx4 a[196:199], v5, s[8:11], s41 offen
  v_rcp_f32 v202, v202
  v_rcp_f32 v203, v203
  s_add_u32 s41, s33, 66304
  buffer_load_dwordx4 a[200:203], v6, s[8:11], s41 offen
  v_rcp_f32 v204, v204
  v_rcp_f32 v205, v205
  s_add_u32 s41, s33, 99072
  buffer_load_dwordx4 a[204:207], v7, s[8:11], s41 offen
  v_rcp_f32 v206, v206
  v_rcp_f32 v207, v207
  s_add_u32 s41, s33, 131840
  buffer_load_dwordx4 a[208:211], v4, s[8:11], s41 offen
  v_pk_mul_f32 v[116:117], v[116:117], v[192:193]
  v_pk_mul_f32 v[118:119], v[118:119], v[194:195]
  v_pk_mul_f32 v[124:125], v[124:125], v[196:197]
  v_pk_mul_f32 v[126:127], v[126:127], v[198:199]
  v_pk_mul_f32 v[132:133], v[132:133], v[200:201]
  v_pk_mul_f32 v[134:135], v[134:135], v[202:203]
  v_pk_mul_f32 v[140:141], v[140:141], v[204:205]
  v_pk_mul_f32 v[142:143], v[142:143], v[206:207]
  s_cmp_eq_u32 s3, 3
  s_cbranch_scc1 adaLN_cond__spectral_fnet__mixer_gmlp__prompt_kernel_z1skip69
  v_cvt_pk_bf16_f32 v116, v116, v117
  v_cvt_pk_bf16_f32 v117, v118, v119
  ds_write_b64 v66, v[116:117] offset:0
  v_cvt_pk_bf16_f32 v124, v124, v125
  v_cvt_pk_bf16_f32 v125, v126, v127
  ds_write_b64 v66, v[124:125] offset:3584
  v_cvt_pk_bf16_f32 v132, v132, v133
  v_cvt_pk_bf16_f32 v133, v134, v135
  ds_write_b64 v66, v[132:133] offset:7168
  v_cvt_pk_bf16_f32 v140, v140, v141
  v_cvt_pk_bf16_f32 v141, v142, v143
  ds_write_b64 v66, v[140:141] offset:10752
adaLN_cond__spectral_fnet__mixer_gmlp__prompt_kernel_z1skip69:
  s_add_u32 s41, s33, 164608
  buffer_load_dwordx4 a[212:215], v5, s[8:11], s41 offen
  s_add_u32 s41, s33, 197376
  buffer_load_dwordx4 a[216:219], v6, s[8:11], s41 offen
  s_add_u32 s41, s33, 230144
  buffer_load_dwordx4 a[220:223], v7, s[8:11], s41 offen
  s_add_u32 s41, s33, 896
  buffer_load_dwordx4 a[224:227], v4, s[8:11], s41 offen
  s_add_u32 s41, s33, 33664
  buffer_load_dwordx4 a[228:231], v5, s[8:11], s41 offen
  s_add_u32 s41, s33, 66432
  buffer_load_dwordx4 a[232:235], v6, s[8:11], s41 offen
  s_add_u32 s41, s33, 99200
  buffer_load_dwordx4 a[236:239], v7, s[8:11], s41 offen
  s_add_u32 s41, s33, 131968
  buffer_load_dwordx4 a[240:243], v4, s[8:11], s41 offen
  s_waitcnt vmcnt(48)
  s_add_u32 s41, s33, 164736
  buffer_load_dwordx4 a[244:247], v5, s[8:11], s41 offen
  s_add_u32 s41, s33, 197504
  buffer_load_dwordx4 a[248:251], v6, s[8:11], s41 offen
  s_add_u32 s41, s33, 230272
  buffer_load_dwordx4 a[252:255], v7, s[8:11], s41 offen
  s_waitcnt vmcnt(32)
adaLN_cond__spectral_fnet__mixer_gmlp__prompt_kernel_join264:
  s_barrier
  s_add_u32 s42, s36, 0
  buffer_load_dwordx4 a[0:3], v12, s[12:15], s42 offen offset:0 sc1
  buffer_load_dwordx4 a[4:7], v13, s[12:15], s42 offen offset:0 sc1
  buffer_load_dwordx4 a[8:11], v14, s[12:15], s42 offen offset:0 sc1
  buffer_load_dwordx4 a[12:15], v15, s[12:15], s42 offen offset:0 sc1
  buffer_load_dwordx4 a[16:19], v16, s[12:15], s42 offen offset:0 sc1
  buffer_load_dwordx4 a[20:23], v17, s[12:15], s42 offen offset:0 sc1
  buffer_load_dwordx4 a[24:27], v18, s[12:15], s42 offen offset:0 sc1
  s_add_u32 s42, s36, 0
  buffer_load_dwordx4 a[28:31], v12, s[12:15], s42 offen offset:1024 sc1
  buffer_load_dwordx4 a[32:35], v13, s[12:15], s42 offen offset:1024 sc1
  buffer_load_dwordx4 a[36:39], v14, s[12:15], s42 offen offset:1024 sc1
  buffer_load_dwordx4 a[40:43], v15, s[12:15], s42 offen offset:1024 sc1
  buffer_load_dwordx4 a[44:47], v16, s[12:15], s42 offen offset:1024 sc1
  buffer_load_dwordx4 a[48:51], v17, s[12:15], s42 offen offset:1024 sc1
  buffer_load_dwordx4 a[52:55], v18, s[12:15], s42 offen offset:1024 sc1
  s_add_u32 s42, s36, 2048
  buffer_load_dwordx4 a[56:59], v12, s[12:15], s42 offen offset:0 sc1
  buffer_load_dwordx4 a[60:63], v13, s[12:15], s42 offen offset:0 sc1
  buffer_load_dwordx4 a[64:67], v14, s[12:15], s42 offen offset:0 sc1
  buffer_load_dwordx4 a[68:71], v15, s[12:15], s42 offen offset:0 sc1
  buffer_load_dwordx4 a[72:75], v16, s[12:15], s42 offen offset:0 sc1
  buffer_load_dwordx4 a[76:79], v17, s[12:15], s42 offen offset:0 sc1
  buffer_load_dwordx4 a[80:83], v18, s[12:15], s42 offen offset:0 sc1
  buffer_load_ushort v34, v11, s[16:19], 0 offen
  ds_read_b128 v[176:179], v36 offset:0
  ds_read_b128 v[180:183], v38 offset:0
  ds_read_b128 v[184:187], v40 offset:0
  ds_read_b128 v[188:191], v42 offset:0
  ds_read_b128 v[192:195], v37 offset:0
  ds_read_b128 v[196:199], v39 offset:0
  ds_read_b128 v[200:203], v41 offset:0
  ds_read_b128 v[204:207], v43 offset:0
  s_waitcnt lgkmcnt(0)
  s_waitcnt vmcnt(15)
  v_mfma_f32_16x16x32_bf16 v[64:67], a[0:3], v[176:179], 0
  v_mfma_f32_16x16x32_bf16 v[92:95], a[0:3], v[180:183], 0
  v_mfma_f32_16x16x32_bf16 v[120:123], a[0:3], v[184:187], 0
  s_add_u32 s42, s36, 2048
  buffer_load_dwordx4 a[84:87], v12, s[12:15], s42 offen offset:1024 sc1
  v_mfma_f32_16x16x32_bf16 v[148:151], a[0:3], v[188:191], 0
  v_mfma_f32_16x16x32_bf16 v[68:71], a[4:7], v[176:179], 0
  v_mfma_f32_16x16x32_bf16 v[96:99], a[4:7], v[180:183], 0
  buffer_load_dwordx4 a[88:91], v13, s[12:15], s42 offen offset:1024 sc1
  v_mfma_f32_16x16x32_bf16 v[124:127], a[4:7], v[184:187], 0
  v_mfma_f32_16x16x32_bf16 v[152:155], a[4:7], v[188:191], 0
  v_mfma_f32_16x16x32_bf16 v[72:75], a[8:11], v[176:179], 0
  buffer_load_dwordx4 a[92:95], v14, s[12:15], s42 offen offset:1024 sc1
  v_mfma_f32_16x16x32_bf16 v[100:103], a[8:11], v[180:183], 0
  v_mfma_f32_16x16x32_bf16 v[128:131], a[8:11], v[184:187], 0
  v_mfma_f32_16x16x32_bf16 v[156:159], a[8:11], v[188:191], 0
  buffer_load_dwordx4 a[96:99], v15, s[12:15], s42 offen offset:1024 sc1
  v_mfma_f32_16x16x32_bf16 v[76:79], a[12:15], v[176:179], 0
  v_mfma_f32_16x16x32_bf16 v[104:107], a[12:15], v[180:183], 0
  v_mfma_f32_16x16x32_bf16 v[132:135], a[12:15], v[184:187], 0
  buffer_load_dwordx4 a[100:103], v16, s[12:15], s42 offen offset:1024 sc1
  v_mfma_f32_16x16x32_bf16 v[160:163], a[12:15], v[188:191], 0
  v_mfma_f32_16x16x32_bf16 v[80:83], a[16:19], v[176:179], 0
  v_mfma_f32_16x16x32_bf16 v[108:111], a[16:19], v[180:183], 0
  buffer_load_dwordx4 a[104:107], v17, s[12:15], s42 offen offset:1024 sc1
  v_mfma_f32_16x16x32_bf16 v[136:139], a[16:19], v[184:187], 0
  v_mfma_f32_16x16x32_bf16 v[164:167], a[16:19], v[188:191], 0
  v_mfma_f32_16x16x32_bf16 v[84:87], a[20:23], v[176:179], 0
  buffer_load_dwordx4 a[108:111], v18, s[12:15], s42 offen offset:1024 sc1
  v_mfma_f32_16x16x32_bf16 v[112:115], a[20:23], v[180:183], 0
  v_mfma_f32_16x16x32_bf16 v[140:143], a[20:23], v[184:187], 0
  v_mfma_f32_16x16x32_bf16 v[168:171], a[20:23], v[188:191], 0
  v_mfma_f32_16x16x32_bf16 v[88:91], a[24:27], v[176:179], 0
  v_mfma_f32_16x16x32_bf16 v[116:119], a[24:27], v[180:183], 0
  v_mfma_f32_16x16x32_bf16 v[144:147], a[24:27], v[184:187], 0
  v_mfma_f32_16x16x32_bf16 v[172:175], a[24:27], v[188:191], 0
  s_waitcnt vmcnt(15)
  v_mfma_f32_16x16x32_bf16 v[64:67], a[28:31], v[192:195], v[64:67]
  v_mfma_f32_16x16x32_bf16 v[92:95], a[28:31], v[196:199], v[92:95]
  s_add_u32 s42, s36, 4096
  buffer_load_dwordx4 a[0:3], v12, s[12:15], s42 offen offset:0 sc1
  v_mfma_f32_16x16x32_bf16 v[120:123], a[28:31], v[200:203], v[120:123]
  v_mfma_f32_16x16x32_bf16 v[148:151], a[28:31], v[204:207], v[148:151]
  v_mfma_f32_16x16x32_bf16 v[68:71], a[32:35], v[192:195], v[68:71]
  buffer_load_dwordx4 a[4:7], v13, s[12:15], s42 offen offset:0 sc1
  v_mfma_f32_16x16x32_bf16 v[96:99], a[32:35], v[196:199], v[96:99]
  v_mfma_f32_16x16x32_bf16 v[124:127], a[32:35], v[200:203], v[124:127]
  v_mfma_f32_16x16x32_bf16 v[152:155], a[32:35], v[204:207], v[152:155]
  buffer_load_dwordx4 a[8:11], v14, s[12:15], s42 offen offset:0 sc1
  v_mfma_f32_16x16x32_bf16 v[72:75], a[36:39], v[192:195], v[72:75]
  v_mfma_f32_16x16x32_bf16 v[100:103], a[36:39], v[196:199], v[100:103]
  v_mfma_f32_16x16x32_bf16 v[128:131], a[36:39], v[200:203], v[128:131]
  buffer_load_dwordx4 a[12:15], v15, s[12:15], s42 offen offset:0 sc1
  v_mfma_f32_16x16x32_bf16 v[156:159], a[36:39], v[204:207], v[156:159]
  ds_read_b128 v[208:211], v36 offset:8192
  v_mfma_f32_16x16x32_bf16 v[76:79], a[40:43], v[192:195], v[76:79]
  v_mfma_f32_16x16x32_bf16 v[104:107], a[40:43], v[196:199], v[104:107]
  buffer_load_dwordx4 a[16:19], v16, s[12:15], s42 offen offset:0 sc1
  ds_read_b128 v[212:215], v38 offset:8192
  v_mfma_f32_16x16x32_bf16 v[132:135], a[40:43], v[200:203], v[132:135]
  v_mfma_f32_16x16x32_bf16 v[160:163], a[40:43], v[204:207], v[160:163]
  ds_read_b128 v[216:219], v40 offset:8192
  v_mfma_f32_16x16x32_bf16 v[80:83], a[44:47], v[192:195], v[80:83]
  buffer_load_dwordx4 a[20:23], v17, s[12:15], s42 offen offset:0 sc1
  v_mfma_f32_16x16x32_bf16 v[108:111], a[44:47], v[196:199], v[108:111]
  ds_read_b128 v[220:223], v42 offset:8192
  v_mfma_f32_16x16x32_bf16 v[136:139], a[44:47], v[200:203], v[136:139]
  v_mfma_f32_16x16x32_bf16 v[164:167], a[44:47], v[204:207], v[164:167]
  buffer_load_dwordx4 a[24:27], v18, s[12:15], s42 offen offset:0 sc1
  ds_read_b128 v[224:227], v37 offset:8192
  v_mfma_f32_16x16x32_bf16 v[84:87], a[48:51], v[192:195], v[84:87]
  v_mfma_f32_16x16x32_bf16 v[112:115], a[48:51], v[196:199], v[112:115]
  ds_read_b128 v[228:231], v39 offset:8192
  v_mfma_f32_16x16x32_bf16 v[140:143], a[48:51], v[200:203], v[140:143]
  v_mfma_f32_16x16x32_bf16 v[168:171], a[48:51], v[204:207], v[168:171]
  ds_read_b128 v[232:235], v41 offset:8192
  v_mfma_f32_16x16x32_bf16 v[88:91], a[52:55], v[192:195], v[88:91]
  v_mfma_f32_16x16x32_bf16 v[116:119], a[52:55], v[196:199], v[116:119]
  ds_read_b128 v[236:239], v43 offset:8192
  v_mfma_f32_16x16x32_bf16 v[144:147], a[52:55], v[200:203], v[144:147]
  v_mfma_f32_16x16x32_bf16 v[172:175], a[52:55], v[204:207], v[172:175]
  s_waitcnt lgkmcnt(0)
  s_waitcnt vmcnt(15)
  v_mfma_f32_16x16x32_bf16 v[64:67], a[56:59], v[208:211], v[64:67]
  s_add_u32 s42, s36, 4096
  buffer_load_dwordx4 a[28:31], v12, s[12:15], s42 offen offset:1024 sc1
  v_mfma_f32_16x16x32_bf16 v[92:95], a[56:59], v[212:215], v[92:95]
  v_mfma_f32_16x16x32_bf16 v[120:123], a[56:59], v[216:219], v[120:123]
  ds_write_b128 v9, a[128:131] offset:0
  v_mfma_f32_16x16x32_bf16 v[148:151], a[56:59], v[220:223], v[148:151]
  buffer_load_dwordx4 a[32:35], v13, s[12:15], s42 offen offset:1024 sc1
  v_mfma_f32_16x16x32_bf16 v[68:71], a[60:63], v[208:211], v[68:71]
  v_mfma_f32_16x16x32_bf16 v[96:99], a[60:63], v[212:215], v[96:99]
  ds_write_b128 v9, a[132:135] offset:1024
  v_mfma_f32_16x16x32_bf16 v[124:127], a[60:63], v[216:219], v[124:127]
  buffer_load_dwordx4 a[36:39], v14, s[12:15], s42 offen offset:1024 sc1
  v_mfma_f32_16x16x32_bf16 v[152:155], a[60:63], v[220:223], v[152:155]
  v_mfma_f32_16x16x32_bf16 v[72:75], a[64:67], v[208:211], v[72:75]
  ds_write_b128 v9, a[136:139] offset:2048
  v_mfma_f32_16x16x32_bf16 v[100:103], a[64:67], v[212:215], v[100:103]
  buffer_load_dwordx4 a[40:43], v15, s[12:15], s42 offen offset:1024 sc1
  v_mfma_f32_16x16x32_bf16 v[128:131], a[64:67], v[216:219], v[128:131]
  v_mfma_f32_16x16x32_bf16 v[156:159], a[64:67], v[220:223], v[156:159]
  ds_write_b128 v9, a[140:143] offset:3072
  v_mfma_f32_16x16x32_bf16 v[76:79], a[68:71], v[208:211], v[76:79]
  buffer_load_dwordx4 a[44:47], v16, s[12:15], s42 offen offset:1024 sc1
  v_mfma_f32_16x16x32_bf16 v[104:107], a[68:71], v[212:215], v[104:107]
  v_mfma_f32_16x16x32_bf16 v[132:135], a[68:71], v[216:219], v[132:135]
  ds_write_b128 v9, a[144:147] offset:4096
  v_mfma_f32_16x16x32_bf16 v[160:163], a[68:71], v[220:223], v[160:163]
  buffer_load_dwordx4 a[48:51], v17, s[12:15], s42 offen offset:1024 sc1
  v_mfma_f32_16x16x32_bf16 v[80:83], a[72:75], v[208:211], v[80:83]
  v_mfma_f32_16x16x32_bf16 v[108:111], a[72:75], v[212:215], v[108:111]
  ds_write_b128 v9, a[148:151] offset:5120
  v_mfma_f32_16x16x32_bf16 v[136:139], a[72:75], v[216:219], v[136:139]
  buffer_load_dwordx4 a[52:55], v18, s[12:15], s42 offen offset:1024 sc1
  v_mfma_f32_16x16x32_bf16 v[164:167], a[72:75], v[220:223], v[164:167]
  v_mfma_f32_16x16x32_bf16 v[84:87], a[76:79], v[208:211], v[84:87]
  ds_write_b128 v9, a[152:155] offset:6144
  v_mfma_f32_16x16x32_bf16 v[112:115], a[76:79], v[212:215], v[112:115]
  v_mfma_f32_16x16x32_bf16 v[140:143], a[76:79], v[216:219], v[140:143]
  v_mfma_f32_16x16x32_bf16 v[168:171], a[76:79], v[220:223], v[168:171]
  ds_write_b128 v9, a[156:159] offset:7168
  v_mfma_f32_16x16x32_bf16 v[88:91], a[80:83], v[208:211], v[88:91]
  v_mfma_f32_16x16x32_bf16 v[116:119], a[80:83], v[212:215], v[116:119]
  v_mfma_f32_16x16x32_bf16 v[144:147], a[80:83], v[216:219], v[144:147]
  v_mfma_f32_16x16x32_bf16 v[172:175], a[80:83], v[220:223], v[172:175]
  s_waitcnt vmcnt(14)
  v_mfma_f32_16x16x32_bf16 v[64:67], a[84:87], v[224:227], v[64:67]
  v_mfma_f32_16x16x32_bf16 v[92:95], a[84:87], v[228:231], v[92:95]
  v_mfma_f32_16x16x32_bf16 v[120:123], a[84:87], v[232:235], v[120:123]
  s_add_u32 s42, s36, 6144
  buffer_load_dwordx4 a[56:59], v12, s[12:15], s42 offen offset:0 sc1
  v_mfma_f32_16x16x32_bf16 v[148:151], a[84:87], v[236:239], v[148:151]
  v_mfma_f32_16x16x32_bf16 v[68:71], a[88:91], v[224:227], v[68:71]
  v_mfma_f32_16x16x32_bf16 v[96:99], a[88:91], v[228:231], v[96:99]
  buffer_load_dwordx4 a[60:63], v13, s[12:15], s42 offen offset:0 sc1
  v_mfma_f32_16x16x32_bf16 v[124:127], a[88:91], v[232:235], v[124:127]
  v_mfma_f32_16x16x32_bf16 v[152:155], a[88:91], v[236:239], v[152:155]
  v_mfma_f32_16x16x32_bf16 v[72:75], a[92:95], v[224:227], v[72:75]
  buffer_load_dwordx4 a[64:67], v14, s[12:15], s42 offen offset:0 sc1
  v_mfma_f32_16x16x32_bf16 v[100:103], a[92:95], v[228:231], v[100:103]
  v_mfma_f32_16x16x32_bf16 v[128:131], a[92:95], v[232:235], v[128:131]
  v_mfma_f32_16x16x32_bf16 v[156:159], a[92:95], v[236:239], v[156:159]
  buffer_load_dwordx4 a[68:71], v15, s[12:15], s42 offen offset:0 sc1
  ds_read_b128 v[176:179], v36 offset:16384
  v_mfma_f32_16x16x32_bf16 v[76:79], a[96:99], v[224:227], v[76:79]
  v_mfma_f32_16x16x32_bf16 v[104:107], a[96:99], v[228:231], v[104:107]
  ds_read_b128 v[180:183], v38 offset:16384
  v_mfma_f32_16x16x32_bf16 v[132:135], a[96:99], v[232:235], v[132:135]
  buffer_load_dwordx4 a[72:75], v16, s[12:15], s42 offen offset:0 sc1
  v_mfma_f32_16x16x32_bf16 v[160:163], a[96:99], v[236:239], v[160:163]
  ds_read_b128 v[184:187], v40 offset:16384
  v_mfma_f32_16x16x32_bf16 v[80:83], a[100:103], v[224:227], v[80:83]
  v_mfma_f32_16x16x32_bf16 v[108:111], a[100:103], v[228:231], v[108:111]
  buffer_load_dwordx4 a[76:79], v17, s[12:15], s42 offen offset:0 sc1
  ds_read_b128 v[188:191], v42 offset:16384
  v_mfma_f32_16x16x32_bf16 v[136:139], a[100:103], v[232:235], v[136:139]
  v_mfma_f32_16x16x32_bf16 v[164:167], a[100:103], v[236:239], v[164:167]
  ds_read_b128 v[192:195], v37 offset:16384
  v_mfma_f32_16x16x32_bf16 v[84:87], a[104:107], v[224:227], v[84:87]
  buffer_load_dwordx4 a[80:83], v18, s[12:15], s42 offen offset:0 sc1
  v_mfma_f32_16x16x32_bf16 v[112:115], a[104:107], v[228:231], v[112:115]
  ds_read_b128 v[196:199], v39 offset:16384
  v_mfma_f32_16x16x32_bf16 v[140:143], a[104:107], v[232:235], v[140:143]
  v_mfma_f32_16x16x32_bf16 v[168:171], a[104:107], v[236:239], v[168:171]
  ds_read_b128 v[200:203], v41 offset:16384
  v_mfma_f32_16x16x32_bf16 v[88:91], a[108:111], v[224:227], v[88:91]
  v_mfma_f32_16x16x32_bf16 v[116:119], a[108:111], v[228:231], v[116:119]
  ds_read_b128 v[204:207], v43 offset:16384
  v_mfma_f32_16x16x32_bf16 v[144:147], a[108:111], v[232:235], v[144:147]
  v_mfma_f32_16x16x32_bf16 v[172:175], a[108:111], v[236:239], v[172:175]
  s_waitcnt lgkmcnt(0)
  s_waitcnt vmcnt(14)
  v_mfma_f32_16x16x32_bf16 v[64:67], a[0:3], v[176:179], v[64:67]
  v_mfma_f32_16x16x32_bf16 v[92:95], a[0:3], v[180:183], v[92:95]
  s_add_u32 s42, s36, 6144
  buffer_load_dwordx4 a[84:87], v12, s[12:15], s42 offen offset:1024 sc1
  v_mfma_f32_16x16x32_bf16 v[120:123], a[0:3], v[184:187], v[120:123]
  ds_write_b128 v9, a[160:163] offset:8192
  v_mfma_f32_16x16x32_bf16 v[148:151], a[0:3], v[188:191], v[148:151]
  v_mfma_f32_16x16x32_bf16 v[68:71], a[4:7], v[176:179], v[68:71]
  buffer_load_dwordx4 a[88:91], v13, s[12:15], s42 offen offset:1024 sc1
  v_mfma_f32_16x16x32_bf16 v[96:99], a[4:7], v[180:183], v[96:99]
  ds_write_b128 v9, a[164:167] offset:9216
  v_mfma_f32_16x16x32_bf16 v[124:127], a[4:7], v[184:187], v[124:127]
  v_mfma_f32_16x16x32_bf16 v[152:155], a[4:7], v[188:191], v[152:155]
  buffer_load_dwordx4 a[92:95], v14, s[12:15], s42 offen offset:1024 sc1
  v_mfma_f32_16x16x32_bf16 v[72:75], a[8:11], v[176:179], v[72:75]
  ds_write_b128 v9, a[168:171] offset:10240
  v_mfma_f32_16x16x32_bf16 v[100:103], a[8:11], v[180:183], v[100:103]
  v_mfma_f32_16x16x32_bf16 v[128:131], a[8:11], v[184:187], v[128:131]
  buffer_load_dwordx4 a[96:99], v15, s[12:15], s42 offen offset:1024 sc1
  v_mfma_f32_16x16x32_bf16 v[156:159], a[8:11], v[188:191], v[156:159]
  ds_write_b128 v9, a[172:175] offset:11264
  v_mfma_f32_16x16x32_bf16 v[76:79], a[12:15], v[176:179], v[76:79]
  v_mfma_f32_16x16x32_bf16 v[104:107], a[12:15], v[180:183], v[104:107]
  buffer_load_dwordx4 a[100:103], v16, s[12:15], s42 offen offset:1024 sc1
  v_mfma_f32_16x16x32_bf16 v[132:135], a[12:15], v[184:187], v[132:135]
  ds_write_b128 v9, a[176:179] offset:12288
  v_mfma_f32_16x16x32_bf16 v[160:163], a[12:15], v[188:191], v[160:163]
  v_mfma_f32_16x16x32_bf16 v[80:83], a[16:19], v[176:179], v[80:83]
  buffer_load_dwordx4 a[104:107], v17, s[12:15], s42 offen offset:1024 sc1
  v_mfma_f32_16x16x32_bf16 v[108:111], a[16:19], v[180:183], v[108:111]
  ds_write_b128 v9, a[180:183] offset:13312
  v_mfma_f32_16x16x32_bf16 v[136:139], a[16:19], v[184:187], v[136:139]
  v_mfma_f32_16x16x32_bf16 v[164:167], a[16:19], v[188:191], v[164:167]
  buffer_load_dwordx4 a[108:111], v18, s[12:15], s42 offen offset:1024 sc1
  v_mfma_f32_16x16x32_bf16 v[84:87], a[20:23], v[176:179], v[84:87]
  ds_write_b128 v9, a[184:187] offset:14336
  v_mfma_f32_16x16x32_bf16 v[112:115], a[20:23], v[180:183], v[112:115]
  v_mfma_f32_16x16x32_bf16 v[140:143], a[20:23], v[184:187], v[140:143]
  v_mfma_f32_16x16x32_bf16 v[168:171], a[20:23], v[188:191], v[168:171]
  ds_write_b128 v9, a[188:191] offset:15360
  v_mfma_f32_16x16x32_bf16 v[88:91], a[24:27], v[176:179], v[88:91]
  v_mfma_f32_16x16x32_bf16 v[116:119], a[24:27], v[180:183], v[116:119]
  v_mfma_f32_16x16x32_bf16 v[144:147], a[24:27], v[184:187], v[144:147]
  v_mfma_f32_16x16x32_bf16 v[172:175], a[24:27], v[188:191], v[172:175]
  s_waitcnt vmcnt(14)
  v_mfma_f32_16x16x32_bf16 v[64:67], a[28:31], v[192:195], v[64:67]
  s_add_u32 s42, s36, 8192
  buffer_load_dwordx4 a[0:3], v12, s[12:15], s42 offen offset:0 sc1
  v_mfma_f32_16x16x32_bf16 v[92:95], a[28:31], v[196:199], v[92:95]
  v_mfma_f32_16x16x32_bf16 v[120:123], a[28:31], v[200:203], v[120:123]
  v_mfma_f32_16x16x32_bf16 v[148:151], a[28:31], v[204:207], v[148:151]
  buffer_load_dwordx4 a[4:7], v13, s[12:15], s42 offen offset:0 sc1
  v_mfma_f32_16x16x32_bf16 v[68:71], a[32:35], v[192:195], v[68:71]
  v_mfma_f32_16x16x32_bf16 v[96:99], a[32:35], v[196:199], v[96:99]
  v_mfma_f32_16x16x32_bf16 v[124:127], a[32:35], v[200:203], v[124:127]
  buffer_load_dwordx4 a[8:11], v14, s[12:15], s42 offen offset:0 sc1
  v_mfma_f32_16x16x32_bf16 v[152:155], a[32:35], v[204:207], v[152:155]
  v_mfma_f32_16x16x32_bf16 v[72:75], a[36:39], v[192:195], v[72:75]
  v_mfma_f32_16x16x32_bf16 v[100:103], a[36:39], v[196:199], v[100:103]
  buffer_load_dwordx4 a[12:15], v15, s[12:15], s42 offen offset:0 sc1
  v_mfma_f32_16x16x32_bf16 v[128:131], a[36:39], v[200:203], v[128:131]
  v_mfma_f32_16x16x32_bf16 v[156:159], a[36:39], v[204:207], v[156:159]
  ds_read_b128 v[208:211], v36 offset:24576
  v_mfma_f32_16x16x32_bf16 v[76:79], a[40:43], v[192:195], v[76:79]
  buffer_load_dwordx4 a[16:19], v16, s[12:15], s42 offen offset:0 sc1
  v_mfma_f32_16x16x32_bf16 v[104:107], a[40:43], v[196:199], v[104:107]
  ds_read_b128 v[212:215], v38 offset:24576
  v_mfma_f32_16x16x32_bf16 v[132:135], a[40:43], v[200:203], v[132:135]
  v_mfma_f32_16x16x32_bf16 v[160:163], a[40:43], v[204:207], v[160:163]
  buffer_load_dwordx4 a[20:23], v17, s[12:15], s42 offen offset:0 sc1
  ds_read_b128 v[216:219], v40 offset:24576
  v_mfma_f32_16x16x32_bf16 v[80:83], a[44:47], v[192:195], v[80:83]
  v_mfma_f32_16x16x32_bf16 v[108:111], a[44:47], v[196:199], v[108:111]
  ds_read_b128 v[220:223], v42 offset:24576
  v_mfma_f32_16x16x32_bf16 v[136:139], a[44:47], v[200:203], v[136:139]
  buffer_load_dwordx4 a[24:27], v18, s[12:15], s42 offen offset:0 sc1
  v_mfma_f32_16x16x32_bf16 v[164:167], a[44:47], v[204:207], v[164:167]
  ds_read_b128 v[224:227], v37 offset:24576
  v_mfma_f32_16x16x32_bf16 v[84:87], a[48:51], v[192:195], v[84:87]
  v_mfma_f32_16x16x32_bf16 v[112:115], a[48:51], v[196:199], v[112:115]
  ds_read_b128 v[228:231], v39 offset:24576
  v_mfma_f32_16x16x32_bf16 v[140:143], a[48:51], v[200:203], v[140:143]
  v_mfma_f32_16x16x32_bf16 v[168:171], a[48:51], v[204:207], v[168:171]
  ds_read_b128 v[232:235], v41 offset:24576
  v_mfma_f32_16x16x32_bf16 v[88:91], a[52:55], v[192:195], v[88:91]
  v_mfma_f32_16x16x32_bf16 v[116:119], a[52:55], v[196:199], v[116:119]
  ds_read_b128 v[236:239], v43 offset:24576
  v_mfma_f32_16x16x32_bf16 v[144:147], a[52:55], v[200:203], v[144:147]
  v_mfma_f32_16x16x32_bf16 v[172:175], a[52:55], v[204:207], v[172:175]
  s_waitcnt lgkmcnt(0)
  s_waitcnt vmcnt(14)
  v_mfma_f32_16x16x32_bf16 v[64:67], a[56:59], v[208:211], v[64:67]
  v_mfma_f32_16x16x32_bf16 v[92:95], a[56:59], v[212:215], v[92:95]
  v_mfma_f32_16x16x32_bf16 v[120:123], a[56:59], v[216:219], v[120:123]
  s_add_u32 s42, s36, 8192
  buffer_load_dwordx4 a[28:31], v12, s[12:15], s42 offen offset:1024 sc1
  ds_write_b128 v9, a[192:195] offset:16384
  v_mfma_f32_16x16x32_bf16 v[148:151], a[56:59], v[220:223], v[148:151]
  v_mfma_f32_16x16x32_bf16 v[68:71], a[60:63], v[208:211], v[68:71]
  v_mfma_f32_16x16x32_bf16 v[96:99], a[60:63], v[212:215], v[96:99]
  buffer_load_dwordx4 a[32:35], v13, s[12:15], s42 offen offset:1024 sc1
  ds_write_b128 v9, a[196:199] offset:17408
  v_mfma_f32_16x16x32_bf16 v[124:127], a[60:63], v[216:219], v[124:127]
  v_mfma_f32_16x16x32_bf16 v[152:155], a[60:63], v[220:223], v[152:155]
  v_mfma_f32_16x16x32_bf16 v[72:75], a[64:67], v[208:211], v[72:75]
  buffer_load_dwordx4 a[36:39], v14, s[12:15], s42 offen offset:1024 sc1
  ds_write_b128 v9, a[200:203] offset:18432
  v_mfma_f32_16x16x32_bf16 v[100:103], a[64:67], v[212:215], v[100:103]
  v_mfma_f32_16x16x32_bf16 v[128:131], a[64:67], v[216:219], v[128:131]
  v_mfma_f32_16x16x32_bf16 v[156:159], a[64:67], v[220:223], v[156:159]
  buffer_load_dwordx4 a[40:43], v15, s[12:15], s42 offen offset:1024 sc1
  ds_write_b128 v9, a[204:207] offset:19456
  v_mfma_f32_16x16x32_bf16 v[76:79], a[68:71], v[208:211], v[76:79]
  v_mfma_f32_16x16x32_bf16 v[104:107], a[68:71], v[212:215], v[104:107]
  v_mfma_f32_16x16x32_bf16 v[132:135], a[68:71], v[216:219], v[132:135]
  buffer_load_dwordx4 a[44:47], v16, s[12:15], s42 offen offset:1024 sc1
  ds_write_b128 v9, a[208:211] offset:20480
  v_mfma_f32_16x16x32_bf16 v[160:163], a[68:71], v[220:223], v[160:163]
  v_mfma_f32_16x16x32_bf16 v[80:83], a[72:75], v[208:211], v[80:83]
  v_mfma_f32_16x16x32_bf16 v[108:111], a[72:75], v[212:215], v[108:111]
  buffer_load_dwordx4 a[48:51], v17, s[12:15], s42 offen offset:1024 sc1
  ds_write_b128 v9, a[212:215] offset:21504
  v_mfma_f32_16x16x32_bf16 v[136:139], a[72:75], v[216:219], v[136:139]
  v_mfma_f32_16x16x32_bf16 v[164:167], a[72:75], v[220:223], v[164:167]
  v_mfma_f32_16x16x32_bf16 v[84:87], a[76:79], v[208:211], v[84:87]
  buffer_load_dwordx4 a[52:55], v18, s[12:15], s42 offen offset:1024 sc1
  ds_write_b128 v9, a[216:219] offset:22528
  v_mfma_f32_16x16x32_bf16 v[112:115], a[76:79], v[212:215], v[112:115]
  v_mfma_f32_16x16x32_bf16 v[140:143], a[76:79], v[216:219], v[140:143]
  v_mfma_f32_16x16x32_bf16 v[168:171], a[76:79], v[220:223], v[168:171]
  ds_write_b128 v9, a[220:223] offset:23552
  v_mfma_f32_16x16x32_bf16 v[88:91], a[80:83], v[208:211], v[88:91]
  v_mfma_f32_16x16x32_bf16 v[116:119], a[80:83], v[212:215], v[116:119]
  v_mfma_f32_16x16x32_bf16 v[144:147], a[80:83], v[216:219], v[144:147]
  v_mfma_f32_16x16x32_bf16 v[172:175], a[80:83], v[220:223], v[172:175]
  s_waitcnt vmcnt(14)
  v_mfma_f32_16x16x32_bf16 v[64:67], a[84:87], v[224:227], v[64:67]
  v_mfma_f32_16x16x32_bf16 v[92:95], a[84:87], v[228:231], v[92:95]
  s_add_u32 s42, s36, 10240
  buffer_load_dwordx4 a[56:59], v12, s[12:15], s42 offen offset:0 sc1
  v_mfma_f32_16x16x32_bf16 v[120:123], a[84:87], v[232:235], v[120:123]
  v_mfma_f32_16x16x32_bf16 v[148:151], a[84:87], v[236:239], v[148:151]
  v_mfma_f32_16x16x32_bf16 v[68:71], a[88:91], v[224:227], v[68:71]
  buffer_load_dwordx4 a[60:63], v13, s[12:15], s42 offen offset:0 sc1
  v_mfma_f32_16x16x32_bf16 v[96:99], a[88:91], v[228:231], v[96:99]
  v_mfma_f32_16x16x32_bf16 v[124:127], a[88:91], v[232:235], v[124:127]
  v_mfma_f32_16x16x32_bf16 v[152:155], a[88:91], v[236:239], v[152:155]
  buffer_load_dwordx4 a[64:67], v14, s[12:15], s42 offen offset:0 sc1
  v_mfma_f32_16x16x32_bf16 v[72:75], a[92:95], v[224:227], v[72:75]
  v_mfma_f32_16x16x32_bf16 v[100:103], a[92:95], v[228:231], v[100:103]
  v_mfma_f32_16x16x32_bf16 v[128:131], a[92:95], v[232:235], v[128:131]
  buffer_load_dwordx4 a[68:71], v15, s[12:15], s42 offen offset:0 sc1
  v_mfma_f32_16x16x32_bf16 v[156:159], a[92:95], v[236:239], v[156:159]
  ds_read_b128 v[176:179], v36 offset:0
  v_mfma_f32_16x16x32_bf16 v[76:79], a[96:99], v[224:227], v[76:79]
  v_mfma_f32_16x16x32_bf16 v[104:107], a[96:99], v[228:231], v[104:107]
  buffer_load_dwordx4 a[72:75], v16, s[12:15], s42 offen offset:0 sc1
  ds_read_b128 v[180:183], v38 offset:0
  v_mfma_f32_16x16x32_bf16 v[132:135], a[96:99], v[232:235], v[132:135]
  v_mfma_f32_16x16x32_bf16 v[160:163], a[96:99], v[236:239], v[160:163]
  ds_read_b128 v[184:187], v40 offset:0
  v_mfma_f32_16x16x32_bf16 v[80:83], a[100:103], v[224:227], v[80:83]
  buffer_load_dwordx4 a[76:79], v17, s[12:15], s42 offen offset:0 sc1
  v_mfma_f32_16x16x32_bf16 v[108:111], a[100:103], v[228:231], v[108:111]
  ds_read_b128 v[188:191], v42 offset:0
  v_mfma_f32_16x16x32_bf16 v[136:139], a[100:103], v[232:235], v[136:139]
  v_mfma_f32_16x16x32_bf16 v[164:167], a[100:103], v[236:239], v[164:167]
  buffer_load_dwordx4 a[80:83], v18, s[12:15], s42 offen offset:0 sc1
  ds_read_b128 v[192:195], v37 offset:0
  v_mfma_f32_16x16x32_bf16 v[84:87], a[104:107], v[224:227], v[84:87]
  v_mfma_f32_16x16x32_bf16 v[112:115], a[104:107], v[228:231], v[112:115]
  ds_read_b128 v[196:199], v39 offset:0
  v_mfma_f32_16x16x32_bf16 v[140:143], a[104:107], v[232:235], v[140:143]
  v_mfma_f32_16x16x32_bf16 v[168:171], a[104:107], v[236:239], v[168:171]
  ds_read_b128 v[200:203], v41 offset:0
  v_mfma_f32_16x16x32_bf16 v[88:91], a[108:111], v[224:227], v[88:91]
  v_mfma_f32_16x16x32_bf16 v[116:119], a[108:111], v[228:231], v[116:119]
  ds_read_b128 v[204:207], v43 offset:0
  v_mfma_f32_16x16x32_bf16 v[144:147], a[108:111], v[232:235], v[144:147]
  v_mfma_f32_16x16x32_bf16 v[172:175], a[108:111], v[236:239], v[172:175]
  s_waitcnt lgkmcnt(0)
  s_waitcnt vmcnt(14)
  v_mfma_f32_16x16x32_bf16 v[64:67], a[0:3], v[176:179], v[64:67]
  s_add_u32 s42, s36, 10240
  buffer_load_dwordx4 a[84:87], v12, s[12:15], s42 offen offset:1024 sc1
  v_mfma_f32_16x16x32_bf16 v[92:95], a[0:3], v[180:183], v[92:95]
  v_mfma_f32_16x16x32_bf16 v[120:123], a[0:3], v[184:187], v[120:123]
  ds_write_b128 v9, a[224:227] offset:24576
  v_mfma_f32_16x16x32_bf16 v[148:151], a[0:3], v[188:191], v[148:151]
  buffer_load_dwordx4 a[88:91], v13, s[12:15], s42 offen offset:1024 sc1
  v_mfma_f32_16x16x32_bf16 v[68:71], a[4:7], v[176:179], v[68:71]
  v_mfma_f32_16x16x32_bf16 v[96:99], a[4:7], v[180:183], v[96:99]
  ds_write_b128 v9, a[228:231] offset:25600
  v_mfma_f32_16x16x32_bf16 v[124:127], a[4:7], v[184:187], v[124:127]
  buffer_load_dwordx4 a[92:95], v14, s[12:15], s42 offen offset:1024 sc1
  v_mfma_f32_16x16x32_bf16 v[152:155], a[4:7], v[188:191], v[152:155]
  v_mfma_f32_16x16x32_bf16 v[72:75], a[8:11], v[176:179], v[72:75]
  ds_write_b128 v9, a[232:235] offset:26624
  v_mfma_f32_16x16x32_bf16 v[100:103], a[8:11], v[180:183], v[100:103]
  buffer_load_dwordx4 a[96:99], v15, s[12:15], s42 offen offset:1024 sc1
  v_mfma_f32_16x16x32_bf16 v[128:131], a[8:11], v[184:187], v[128:131]
  v_mfma_f32_16x16x32_bf16 v[156:159], a[8:11], v[188:191], v[156:159]
  ds_write_b128 v9, a[236:239] offset:27648
  v_mfma_f32_16x16x32_bf16 v[76:79], a[12:15], v[176:179], v[76:79]
  buffer_load_dwordx4 a[100:103], v16, s[12:15], s42 offen offset:1024 sc1
  v_mfma_f32_16x16x32_bf16 v[104:107], a[12:15], v[180:183], v[104:107]
  v_mfma_f32_16x16x32_bf16 v[132:135], a[12:15], v[184:187], v[132:135]
  ds_write_b128 v9, a[240:243] offset:28672
  v_mfma_f32_16x16x32_bf16 v[160:163], a[12:15], v[188:191], v[160:163]
  buffer_load_dwordx4 a[104:107], v17, s[12:15], s42 offen offset:1024 sc1
  v_mfma_f32_16x16x32_bf16 v[80:83], a[16:19], v[176:179], v[80:83]
  v_mfma_f32_16x16x32_bf16 v[108:111], a[16:19], v[180:183], v[108:111]
  ds_write_b128 v9, a[244:247] offset:29696
  v_mfma_f32_16x16x32_bf16 v[136:139], a[16:19], v[184:187], v[136:139]
  buffer_load_dwordx4 a[108:111], v18, s[12:15], s42 offen offset:1024 sc1
  v_mfma_f32_16x16x32_bf16 v[164:167], a[16:19], v[188:191], v[164:167]
  v_mfma_f32_16x16x32_bf16 v[84:87], a[20:23], v[176:179], v[84:87]
  ds_write_b128 v9, a[248:251] offset:30720
  v_mfma_f32_16x16x32_bf16 v[112:115], a[20:23], v[180:183], v[112:115]
  v_mfma_f32_16x16x32_bf16 v[140:143], a[20:23], v[184:187], v[140:143]
  v_mfma_f32_16x16x32_bf16 v[168:171], a[20:23], v[188:191], v[168:171]
  ds_write_b128 v9, a[252:255] offset:31744
  v_mfma_f32_16x16x32_bf16 v[88:91], a[24:27], v[176:179], v[88:91]
  v_mfma_f32_16x16x32_bf16 v[116:119], a[24:27], v[180:183], v[116:119]
  v_mfma_f32_16x16x32_bf16 v[144:147], a[24:27], v[184:187], v[144:147]
  v_mfma_f32_16x16x32_bf16 v[172:175], a[24:27], v[188:191], v[172:175]
  s_waitcnt vmcnt(14)
  v_mfma_f32_16x16x32_bf16 v[64:67], a[28:31], v[192:195], v[64:67]
  v_mfma_f32_16x16x32_bf16 v[92:95], a[28:31], v[196:199], v[92:95]
  v_mfma_f32_16x16x32_bf16 v[120:123], a[28:31], v[200:203], v[120:123]
  s_add_u32 s42, s36, 12288
  buffer_load_dwordx4 a[0:3], v12, s[12:15], s42 offen offset:0 sc1
  v_mfma_f32_16x16x32_bf16 v[148:151], a[28:31], v[204:207], v[148:151]
  v_mfma_f32_16x16x32_bf16 v[68:71], a[32:35], v[192:195], v[68:71]
  v_mfma_f32_16x16x32_bf16 v[96:99], a[32:35], v[196:199], v[96:99]
  buffer_load_dwordx4 a[4:7], v13, s[12:15], s42 offen offset:0 sc1
  v_mfma_f32_16x16x32_bf16 v[124:127], a[32:35], v[200:203], v[124:127]
  v_mfma_f32_16x16x32_bf16 v[152:155], a[32:35], v[204:207], v[152:155]
  v_mfma_f32_16x16x32_bf16 v[72:75], a[36:39], v[192:195], v[72:75]
  buffer_load_dwordx4 a[8:11], v14, s[12:15], s42 offen offset:0 sc1
  v_mfma_f32_16x16x32_bf16 v[100:103], a[36:39], v[196:199], v[100:103]
  v_mfma_f32_16x16x32_bf16 v[128:131], a[36:39], v[200:203], v[128:131]
  v_mfma_f32_16x16x32_bf16 v[156:159], a[36:39], v[204:207], v[156:159]
  buffer_load_dwordx4 a[12:15], v15, s[12:15], s42 offen offset:0 sc1
  ds_read_b128 v[208:211], v36 offset:8192
  v_mfma_f32_16x16x32_bf16 v[76:79], a[40:43], v[192:195], v[76:79]
  v_mfma_f32_16x16x32_bf16 v[104:107], a[40:43], v[196:199], v[104:107]
  ds_read_b128 v[212:215], v38 offset:8192
  v_mfma_f32_16x16x32_bf16 v[132:135], a[40:43], v[200:203], v[132:135]
  buffer_load_dwordx4 a[16:19], v16, s[12:15], s42 offen offset:0 sc1
  v_mfma_f32_16x16x32_bf16 v[160:163], a[40:43], v[204:207], v[160:163]
  ds_read_b128 v[216:219], v40 offset:8192
  v_mfma_f32_16x16x32_bf16 v[80:83], a[44:47], v[192:195], v[80:83]
  v_mfma_f32_16x16x32_bf16 v[108:111], a[44:47], v[196:199], v[108:111]
  buffer_load_dwordx4 a[20:23], v17, s[12:15], s42 offen offset:0 sc1
  ds_read_b128 v[220:223], v42 offset:8192
  v_mfma_f32_16x16x32_bf16 v[136:139], a[44:47], v[200:203], v[136:139]
  v_mfma_f32_16x16x32_bf16 v[164:167], a[44:47], v[204:207], v[164:167]
  ds_read_b128 v[224:227], v37 offset:8192
  v_mfma_f32_16x16x32_bf16 v[84:87], a[48:51], v[192:195], v[84:87]
  buffer_load_dwordx4 a[24:27], v18, s[12:15], s42 offen offset:0 sc1
  v_mfma_f32_16x16x32_bf16 v[112:115], a[48:51], v[196:199], v[112:115]
  ds_read_b128 v[228:231], v39 offset:8192
  v_mfma_f32_16x16x32_bf16 v[140:143], a[48:51], v[200:203], v[140:143]
  v_mfma_f32_16x16x32_bf16 v[168:171], a[48:51], v[204:207], v[168:171]
  ds_read_b128 v[232:235], v41 offset:8192
  v_mfma_f32_16x16x32_bf16 v[88:91], a[52:55], v[192:195], v[88:91]
  v_mfma_f32_16x16x32_bf16 v[116:119], a[52:55], v[196:199], v[116:119]
  ds_read_b128 v[236:239], v43 offset:8192
  v_mfma_f32_16x16x32_bf16 v[144:147], a[52:55], v[200:203], v[144:147]
  v_mfma_f32_16x16x32_bf16 v[172:175], a[52:55], v[204:207], v[172:175]
  s_waitcnt lgkmcnt(0)
  s_waitcnt vmcnt(14)
  v_mfma_f32_16x16x32_bf16 v[64:67], a[56:59], v[208:211], v[64:67]
  v_mfma_f32_16x16x32_bf16 v[92:95], a[56:59], v[212:215], v[92:95]
  s_add_u32 s42, s36, 12288
  buffer_load_dwordx4 a[28:31], v12, s[12:15], s42 offen offset:1024 sc1
  v_mfma_f32_16x16x32_bf16 v[120:123], a[56:59], v[216:219], v[120:123]
  v_mfma_f32_16x16x32_bf16 v[148:151], a[56:59], v[220:223], v[148:151]
  v_mfma_f32_16x16x32_bf16 v[68:71], a[60:63], v[208:211], v[68:71]
  buffer_load_dwordx4 a[32:35], v13, s[12:15], s42 offen offset:1024 sc1
  v_mfma_f32_16x16x32_bf16 v[96:99], a[60:63], v[212:215], v[96:99]
  v_mfma_f32_16x16x32_bf16 v[124:127], a[60:63], v[216:219], v[124:127]
  v_mfma_f32_16x16x32_bf16 v[152:155], a[60:63], v[220:223], v[152:155]
  buffer_load_dwordx4 a[36:39], v14, s[12:15], s42 offen offset:1024 sc1
  v_mfma_f32_16x16x32_bf16 v[72:75], a[64:67], v[208:211], v[72:75]
  v_mfma_f32_16x16x32_bf16 v[100:103], a[64:67], v[212:215], v[100:103]
  v_mfma_f32_16x16x32_bf16 v[128:131], a[64:67], v[216:219], v[128:131]
  buffer_load_dwordx4 a[40:43], v15, s[12:15], s42 offen offset:1024 sc1
  v_mfma_f32_16x16x32_bf16 v[156:159], a[64:67], v[220:223], v[156:159]
  v_mfma_f32_16x16x32_bf16 v[76:79], a[68:71], v[208:211], v[76:79]
  v_mfma_f32_16x16x32_bf16 v[104:107], a[68:71], v[212:215], v[104:107]
  buffer_load_dwordx4 a[44:47], v16, s[12:15], s42 offen offset:1024 sc1
  v_mfma_f32_16x16x32_bf16 v[132:135], a[68:71], v[216:219], v[132:135]
  v_mfma_f32_16x16x32_bf16 v[160:163], a[68:71], v[220:223], v[160:163]
  v_mfma_f32_16x16x32_bf16 v[80:83], a[72:75], v[208:211], v[80:83]
  buffer_load_dwordx4 a[48:51], v17, s[12:15], s42 offen offset:1024 sc1
  v_mfma_f32_16x16x32_bf16 v[108:111], a[72:75], v[212:215], v[108:111]
  v_mfma_f32_16x16x32_bf16 v[136:139], a[72:75], v[216:219], v[136:139]
  v_mfma_f32_16x16x32_bf16 v[164:167], a[72:75], v[220:223], v[164:167]
  buffer_load_dwordx4 a[52:55], v18, s[12:15], s42 offen offset:1024 sc1
  v_mfma_f32_16x16x32_bf16 v[84:87], a[76:79], v[208:211], v[84:87]
  v_mfma_f32_16x16x32_bf16 v[112:115], a[76:79], v[212:215], v[112:115]
  v_mfma_f32_16x16x32_bf16 v[140:143], a[76:79], v[216:219], v[140:143]
  v_mfma_f32_16x16x32_bf16 v[168:171], a[76:79], v[220:223], v[168:171]
  v_mfma_f32_16x16x32_bf16 v[88:91], a[80:83], v[208:211], v[88:91]
  v_mfma_f32_16x16x32_bf16 v[116:119], a[80:83], v[212:215], v[116:119]
  v_mfma_f32_16x16x32_bf16 v[144:147], a[80:83], v[216:219], v[144:147]
  v_mfma_f32_16x16x32_bf16 v[172:175], a[80:83], v[220:223], v[172:175]
  s_waitcnt vmcnt(14)
  v_mfma_f32_16x16x32_bf16 v[64:67], a[84:87], v[224:227], v[64:67]
  s_add_u32 s42, s36, 14336
  buffer_load_dwordx4 a[56:59], v12, s[12:15], s42 offen offset:0 sc1
  v_mfma_f32_16x16x32_bf16 v[92:95], a[84:87], v[228:231], v[92:95]
  v_mfma_f32_16x16x32_bf16 v[120:123], a[84:87], v[232:235], v[120:123]
  v_mfma_f32_16x16x32_bf16 v[148:151], a[84:87], v[236:239], v[148:151]
  buffer_load_dwordx4 a[60:63], v13, s[12:15], s42 offen offset:0 sc1
  v_mfma_f32_16x16x32_bf16 v[68:71], a[88:91], v[224:227], v[68:71]
  v_mfma_f32_16x16x32_bf16 v[96:99], a[88:91], v[228:231], v[96:99]
  v_mfma_f32_16x16x32_bf16 v[124:127], a[88:91], v[232:235], v[124:127]
  buffer_load_dwordx4 a[64:67], v14, s[12:15], s42 offen offset:0 sc1
  v_mfma_f32_16x16x32_bf16 v[152:155], a[88:91], v[236:239], v[152:155]
  v_mfma_f32_16x16x32_bf16 v[72:75], a[92:95], v[224:227], v[72:75]
  v_mfma_f32_16x16x32_bf16 v[100:103], a[92:95], v[228:231], v[100:103]
  buffer_load_dwordx4 a[68:71], v15, s[12:15], s42 offen offset:0 sc1
  v_mfma_f32_16x16x32_bf16 v[128:131], a[92:95], v[232:235], v[128:131]
  v_mfma_f32_16x16x32_bf16 v[156:159], a[92:95], v[236:239], v[156:159]
  ds_read_b128 v[176:179], v36 offset:16384
  v_mfma_f32_16x16x32_bf16 v[76:79], a[96:99], v[224:227], v[76:79]
  buffer_load_dwordx4 a[72:75], v16, s[12:15], s42 offen offset:0 sc1
  v_mfma_f32_16x16x32_bf16 v[104:107], a[96:99], v[228:231], v[104:107]
  ds_read_b128 v[180:183], v38 offset:16384
  v_mfma_f32_16x16x32_bf16 v[132:135], a[96:99], v[232:235], v[132:135]
  v_mfma_f32_16x16x32_bf16 v[160:163], a[96:99], v[236:239], v[160:163]
  buffer_load_dwordx4 a[76:79], v17, s[12:15], s42 offen offset:0 sc1
  ds_read_b128 v[184:187], v40 offset:16384
  v_mfma_f32_16x16x32_bf16 v[80:83], a[100:103], v[224:227], v[80:83]
  v_mfma_f32_16x16x32_bf16 v[108:111], a[100:103], v[228:231], v[108:111]
  ds_read_b128 v[188:191], v42 offset:16384
  v_mfma_f32_16x16x32_bf16 v[136:139], a[100:103], v[232:235], v[136:139]
  buffer_load_dwordx4 a[80:83], v18, s[12:15], s42 offen offset:0 sc1
  v_mfma_f32_16x16x32_bf16 v[164:167], a[100:103], v[236:239], v[164:167]
  ds_read_b128 v[192:195], v37 offset:16384
  v_mfma_f32_16x16x32_bf16 v[84:87], a[104:107], v[224:227], v[84:87]
  v_mfma_f32_16x16x32_bf16 v[112:115], a[104:107], v[228:231], v[112:115]
  ds_read_b128 v[196:199], v39 offset:16384
  v_mfma_f32_16x16x32_bf16 v[140:143], a[104:107], v[232:235], v[140:143]
  v_mfma_f32_16x16x32_bf16 v[168:171], a[104:107], v[236:239], v[168:171]
  ds_read_b128 v[200:203], v41 offset:16384
  v_mfma_f32_16x16x32_bf16 v[88:91], a[108:111], v[224:227], v[88:91]
  v_mfma_f32_16x16x32_bf16 v[116:119], a[108:111], v[228:231], v[116:119]
  ds_read_b128 v[204:207], v43 offset:16384
  v_mfma_f32_16x16x32_bf16 v[144:147], a[108:111], v[232:235], v[144:147]
  v_mfma_f32_16x16x32_bf16 v[172:175], a[108:111], v[236:239], v[172:175]
  s_waitcnt lgkmcnt(0)
  s_waitcnt vmcnt(14)
  v_mfma_f32_16x16x32_bf16 v[64:67], a[0:3], v[176:179], v[64:67]
  v_mfma_f32_16x16x32_bf16 v[92:95], a[0:3], v[180:183], v[92:95]
  v_mfma_f32_16x16x32_bf16 v[120:123], a[0:3], v[184:187], v[120:123]
  s_add_u32 s42, s36, 14336
  buffer_load_dwordx4 a[84:87], v12, s[12:15], s42 offen offset:1024 sc1
  v_mfma_f32_16x16x32_bf16 v[148:151], a[0:3], v[188:191], v[148:151]
  v_mfma_f32_16x16x32_bf16 v[68:71], a[4:7], v[176:179], v[68:71]
  v_mfma_f32_16x16x32_bf16 v[96:99], a[4:7], v[180:183], v[96:99]
  buffer_load_dwordx4 a[88:91], v13, s[12:15], s42 offen offset:1024 sc1
  v_mfma_f32_16x16x32_bf16 v[124:127], a[4:7], v[184:187], v[124:127]
  v_mfma_f32_16x16x32_bf16 v[152:155], a[4:7], v[188:191], v[152:155]
  v_mfma_f32_16x16x32_bf16 v[72:75], a[8:11], v[176:179], v[72:75]
  buffer_load_dwordx4 a[92:95], v14, s[12:15], s42 offen offset:1024 sc1
  v_mfma_f32_16x16x32_bf16 v[100:103], a[8:11], v[180:183], v[100:103]
  v_mfma_f32_16x16x32_bf16 v[128:131], a[8:11], v[184:187], v[128:131]
  v_mfma_f32_16x16x32_bf16 v[156:159], a[8:11], v[188:191], v[156:159]
  buffer_load_dwordx4 a[96:99], v15, s[12:15], s42 offen offset:1024 sc1
  v_mfma_f32_16x16x32_bf16 v[76:79], a[12:15], v[176:179], v[76:79]
  v_mfma_f32_16x16x32_bf16 v[104:107], a[12:15], v[180:183], v[104:107]
  v_mfma_f32_16x16x32_bf16 v[132:135], a[12:15], v[184:187], v[132:135]
  buffer_load_dwordx4 a[100:103], v16, s[12:15], s42 offen offset:1024 sc1
  v_mfma_f32_16x16x32_bf16 v[160:163], a[12:15], v[188:191], v[160:163]
  v_mfma_f32_16x16x32_bf16 v[80:83], a[16:19], v[176:179], v[80:83]
  v_mfma_f32_16x16x32_bf16 v[108:111], a[16:19], v[180:183], v[108:111]
  buffer_load_dwordx4 a[104:107], v17, s[12:15], s42 offen offset:1024 sc1
  v_mfma_f32_16x16x32_bf16 v[136:139], a[16:19], v[184:187], v[136:139]
  v_mfma_f32_16x16x32_bf16 v[164:167], a[16:19], v[188:191], v[164:167]
  v_mfma_f32_16x16x32_bf16 v[84:87], a[20:23], v[176:179], v[84:87]
  buffer_load_dwordx4 a[108:111], v18, s[12:15], s42 offen offset:1024 sc1
  v_mfma_f32_16x16x32_bf16 v[112:115], a[20:23], v[180:183], v[112:115]
  v_mfma_f32_16x16x32_bf16 v[140:143], a[20:23], v[184:187], v[140:143]
  v_mfma_f32_16x16x32_bf16 v[168:171], a[20:23], v[188:191], v[168:171]
  v_mfma_f32_16x16x32_bf16 v[88:91], a[24:27], v[176:179], v[88:91]
  v_mfma_f32_16x16x32_bf16 v[116:119], a[24:27], v[180:183], v[116:119]
  v_mfma_f32_16x16x32_bf16 v[144:147], a[24:27], v[184:187], v[144:147]
  v_mfma_f32_16x16x32_bf16 v[172:175], a[24:27], v[188:191], v[172:175]
  s_waitcnt vmcnt(14)
  v_mfma_f32_16x16x32_bf16 v[64:67], a[28:31], v[192:195], v[64:67]
  v_mfma_f32_16x16x32_bf16 v[92:95], a[28:31], v[196:199], v[92:95]
  v_mfma_f32_16x16x32_bf16 v[120:123], a[28:31], v[200:203], v[120:123]
  v_mfma_f32_16x16x32_bf16 v[148:151], a[28:31], v[204:207], v[148:151]
  v_mfma_f32_16x16x32_bf16 v[68:71], a[32:35], v[192:195], v[68:71]
  v_mfma_f32_16x16x32_bf16 v[96:99], a[32:35], v[196:199], v[96:99]
  v_mfma_f32_16x16x32_bf16 v[124:127], a[32:35], v[200:203], v[124:127]
  v_mfma_f32_16x16x32_bf16 v[152:155], a[32:35], v[204:207], v[152:155]
  v_mfma_f32_16x16x32_bf16 v[72:75], a[36:39], v[192:195], v[72:75]
  v_mfma_f32_16x16x32_bf16 v[100:103], a[36:39], v[196:199], v[100:103]
  v_mfma_f32_16x16x32_bf16 v[128:131], a[36:39], v[200:203], v[128:131]
  v_mfma_f32_16x16x32_bf16 v[156:159], a[36:39], v[204:207], v[156:159]
  ds_read_b128 v[208:211], v36 offset:24576
  v_mfma_f32_16x16x32_bf16 v[76:79], a[40:43], v[192:195], v[76:79]
  v_mfma_f32_16x16x32_bf16 v[104:107], a[40:43], v[196:199], v[104:107]
  ds_read_b128 v[212:215], v38 offset:24576
  v_mfma_f32_16x16x32_bf16 v[132:135], a[40:43], v[200:203], v[132:135]
  v_mfma_f32_16x16x32_bf16 v[160:163], a[40:43], v[204:207], v[160:163]
  ds_read_b128 v[216:219], v40 offset:24576
  v_mfma_f32_16x16x32_bf16 v[80:83], a[44:47], v[192:195], v[80:83]
  v_mfma_f32_16x16x32_bf16 v[108:111], a[44:47], v[196:199], v[108:111]
  ds_read_b128 v[220:223], v42 offset:24576
  v_mfma_f32_16x16x32_bf16 v[136:139], a[44:47], v[200:203], v[136:139]
  v_mfma_f32_16x16x32_bf16 v[164:167], a[44:47], v[204:207], v[164:167]
  ds_read_b128 v[224:227], v37 offset:24576
  v_mfma_f32_16x16x32_bf16 v[84:87], a[48:51], v[192:195], v[84:87]
  v_mfma_f32_16x16x32_bf16 v[112:115], a[48:51], v[196:199], v[112:115]
  ds_read_b128 v[228:231], v39 offset:24576
  v_mfma_f32_16x16x32_bf16 v[140:143], a[48:51], v[200:203], v[140:143]
  v_mfma_f32_16x16x32_bf16 v[168:171], a[48:51], v[204:207], v[168:171]
  ds_read_b128 v[232:235], v41 offset:24576
  v_mfma_f32_16x16x32_bf16 v[88:91], a[52:55], v[192:195], v[88:91]
  v_mfma_f32_16x16x32_bf16 v[116:119], a[52:55], v[196:199], v[116:119]
  ds_read_b128 v[236:239], v43 offset:24576
  v_mfma_f32_16x16x32_bf16 v[144:147], a[52:55], v[200:203], v[144:147]
  v_mfma_f32_16x16x32_bf16 v[172:175], a[52:55], v[204:207], v[172:175]
  s_waitcnt lgkmcnt(0)
  s_waitcnt vmcnt(7)
  s_waitcnt vmcnt(0)
  v_mfma_f32_16x16x32_bf16 v[92:95], a[56:59], v[212:215], v[92:95]
  v_mfma_f32_16x16x32_bf16 v[96:99], a[60:63], v[212:215], v[96:99]
  v_mfma_f32_16x16x32_bf16 v[100:103], a[64:67], v[212:215], v[100:103]
  v_mfma_f32_16x16x32_bf16 v[104:107], a[68:71], v[212:215], v[104:107]
  v_mfma_f32_16x16x32_bf16 v[108:111], a[72:75], v[212:215], v[108:111]
  v_mfma_f32_16x16x32_bf16 v[112:115], a[76:79], v[212:215], v[112:115]
  v_mfma_f32_16x16x32_bf16 v[116:119], a[80:83], v[212:215], v[116:119]
  v_mfma_f32_16x16x32_bf16 v[92:95], a[84:87], v[228:231], v[92:95]
  v_mfma_f32_16x16x32_bf16 v[96:99], a[88:91], v[228:231], v[96:99]
  v_mfma_f32_16x16x32_bf16 v[100:103], a[92:95], v[228:231], v[100:103]
  v_mfma_f32_16x16x32_bf16 v[104:107], a[96:99], v[228:231], v[104:107]
  v_mfma_f32_16x16x32_bf16 v[108:111], a[100:103], v[228:231], v[108:111]
  v_mfma_f32_16x16x32_bf16 v[112:115], a[104:107], v[228:231], v[112:115]
  v_mfma_f32_16x16x32_bf16 v[116:119], a[108:111], v[228:231], v[116:119]
  v_mfma_f32_16x16x32_bf16 v[120:123], a[56:59], v[216:219], v[120:123]
  v_mfma_f32_16x16x32_bf16 v[124:127], a[60:63], v[216:219], v[124:127]
  v_mfma_f32_16x16x32_bf16 v[128:131], a[64:67], v[216:219], v[128:131]
  v_mfma_f32_16x16x32_bf16 v[132:135], a[68:71], v[216:219], v[132:135]
  ds_write_b128 v9, v[92:95] offset:7168
  v_mfma_f32_16x16x32_bf16 v[136:139], a[72:75], v[216:219], v[136:139]
  v_mfma_f32_16x16x32_bf16 v[140:143], a[76:79], v[216:219], v[140:143]
  ds_write_b128 v9, v[96:99] offset:8192
  v_mfma_f32_16x16x32_bf16 v[144:147], a[80:83], v[216:219], v[144:147]
  v_mfma_f32_16x16x32_bf16 v[120:123], a[84:87], v[232:235], v[120:123]
  ds_write_b128 v9, v[100:103] offset:9216
  v_mfma_f32_16x16x32_bf16 v[124:127], a[88:91], v[232:235], v[124:127]
  v_mfma_f32_16x16x32_bf16 v[128:131], a[92:95], v[232:235], v[128:131]
  ds_write_b128 v9, v[104:107] offset:10240
  v_mfma_f32_16x16x32_bf16 v[132:135], a[96:99], v[232:235], v[132:135]
  v_mfma_f32_16x16x32_bf16 v[136:139], a[100:103], v[232:235], v[136:139]
  ds_write_b128 v9, v[108:111] offset:11264
  v_mfma_f32_16x16x32_bf16 v[140:143], a[104:107], v[232:235], v[140:143]
  v_mfma_f32_16x16x32_bf16 v[144:147], a[108:111], v[232:235], v[144:147]
  ds_write_b128 v9, v[112:115] offset:12288
  v_mfma_f32_16x16x32_bf16 v[148:151], a[56:59], v[220:223], v[148:151]
  v_mfma_f32_16x16x32_bf16 v[152:155], a[60:63], v[220:223], v[152:155]
  ds_write_b128 v9, v[116:119] offset:13312
  v_mfma_f32_16x16x32_bf16 v[156:159], a[64:67], v[220:223], v[156:159]
  v_mfma_f32_16x16x32_bf16 v[160:163], a[68:71], v[220:223], v[160:163]
  ds_write_b128 v9, v[120:123] offset:14336
  v_mfma_f32_16x16x32_bf16 v[164:167], a[72:75], v[220:223], v[164:167]
  v_mfma_f32_16x16x32_bf16 v[168:171], a[76:79], v[220:223], v[168:171]
  ds_write_b128 v9, v[124:127] offset:15360
  v_mfma_f32_16x16x32_bf16 v[172:175], a[80:83], v[220:223], v[172:175]
  v_mfma_f32_16x16x32_bf16 v[148:151], a[84:87], v[236:239], v[148:151]
  ds_write_b128 v9, v[128:131] offset:16384
  v_mfma_f32_16x16x32_bf16 v[152:155], a[88:91], v[236:239], v[152:155]
  v_mfma_f32_16x16x32_bf16 v[156:159], a[92:95], v[236:239], v[156:159]
  ds_write_b128 v9, v[132:135] offset:17408
  v_mfma_f32_16x16x32_bf16 v[160:163], a[96:99], v[236:239], v[160:163]
  v_mfma_f32_16x16x32_bf16 v[164:167], a[100:103], v[236:239], v[164:167]
  ds_write_b128 v9, v[136:139] offset:18432
  v_mfma_f32_16x16x32_bf16 v[168:171], a[104:107], v[236:239], v[168:171]
  v_mfma_f32_16x16x32_bf16 v[172:175], a[108:111], v[236:239], v[172:175]
  ds_write_b128 v9, v[140:143] offset:19456
  v_mfma_f32_16x16x32_bf16 v[64:67], a[56:59], v[208:211], v[64:67]
  ds_write_b128 v9, v[144:147] offset:20480
  v_mfma_f32_16x16x32_bf16 v[68:71], a[60:63], v[208:211], v[68:71]
  ds_write_b128 v9, v[148:151] offset:21504
  v_mfma_f32_16x16x32_bf16 v[72:75], a[64:67], v[208:211], v[72:75]
  ds_write_b128 v9, v[152:155] offset:22528
  v_mfma_f32_16x16x32_bf16 v[76:79], a[68:71], v[208:211], v[76:79]
  ds_write_b128 v9, v[156:159] offset:23552
  v_mfma_f32_16x16x32_bf16 v[80:83], a[72:75], v[208:211], v[80:83]
  ds_write_b128 v9, v[160:163] offset:24576
  v_mfma_f32_16x16x32_bf16 v[84:87], a[76:79], v[208:211], v[84:87]
  ds_write_b128 v9, v[164:167] offset:25600
  v_mfma_f32_16x16x32_bf16 v[88:91], a[80:83], v[208:211], v[88:91]
  ds_write_b128 v9, v[168:171] offset:26624
  v_mfma_f32_16x16x32_bf16 v[64:67], a[84:87], v[224:227], v[64:67]
  ds_write_b128 v9, v[172:175] offset:27648
  v_mfma_f32_16x16x32_bf16 v[68:71], a[88:91], v[224:227], v[68:71]
  v_mfma_f32_16x16x32_bf16 v[72:75], a[92:95], v[224:227], v[72:75]
  v_mfma_f32_16x16x32_bf16 v[76:79], a[96:99], v[224:227], v[76:79]
  v_mfma_f32_16x16x32_bf16 v[80:83], a[100:103], v[224:227], v[80:83]
  v_mfma_f32_16x16x32_bf16 v[84:87], a[104:107], v[224:227], v[84:87]
  v_mfma_f32_16x16x32_bf16 v[88:91], a[108:111], v[224:227], v[88:91]
  s_waitcnt lgkmcnt(0)
  s_barrier
  ds_read_b128 v[92:95], v44 offset:0
  ds_read_b128 v[96:99], v44 offset:1024
  ds_read_b128 v[100:103], v44 offset:2048
  ds_read_b128 v[104:107], v44 offset:3072
  ds_read_b128 v[108:111], v44 offset:4096
  ds_read_b128 v[112:115], v44 offset:5120
  ds_read_b128 v[116:119], v44 offset:6144
  ds_read_b128 v[120:123], v45 offset:0
  ds_read_b128 v[124:127], v45 offset:1024
  ds_read_b128 v[128:131], v45 offset:2048
  ds_read_b128 v[132:135], v45 offset:3072
  ds_read_b128 v[136:139], v45 offset:4096
  ds_read_b128 v[140:143], v45 offset:5120
  ds_read_b128 v[144:147], v45 offset:6144
  s_waitcnt lgkmcnt(7)
  v_pk_add_f32 v[64:65], v[64:65], v[92:93]
  v_pk_add_f32 v[66:67], v[66:67], v[94:95]
  v_pk_add_f32 v[68:69], v[68:69], v[96:97]
  v_pk_add_f32 v[70:71], v[70:71], v[98:99]
  v_pk_add_f32 v[72:73], v[72:73], v[100:101]
  v_pk_add_f32 v[74:75], v[74:75], v[102:103]
  v_pk_add_f32 v[76:77], v[76:77], v[104:105]
  v_pk_add_f32 v[78:79], v[78:79], v[106:107]
  v_pk_add_f32 v[80:81], v[80:81], v[108:109]
  v_pk_add_f32 v[82:83], v[82:83], v[110:111]
  v_pk_add_f32 v[84:85], v[84:85], v[112:113]
  v_pk_add_f32 v[86:87], v[86:87], v[114:115]
  v_pk_add_f32 v[88:89], v[88:89], v[116:117]
  v_pk_add_f32 v[90:91], v[90:91], v[118:119]
  ds_read_b128 v[148:151], v46 offset:0
  ds_read_b128 v[152:155], v46 offset:1024
  ds_read_b128 v[156:159], v46 offset:2048
  ds_read_b128 v[160:163], v46 offset:3072
  ds_read_b128 v[164:167], v46 offset:4096
  ds_read_b128 v[168:171], v46 offset:5120
  ds_read_b128 v[172:175], v46 offset:6144
  s_waitcnt lgkmcnt(7)
  v_pk_add_f32 v[64:65], v[64:65], v[120:121]
  v_pk_add_f32 v[66:67], v[66:67], v[122:123]
  v_pk_add_f32 v[68:69], v[68:69], v[124:125]
  v_pk_add_f32 v[70:71], v[70:71], v[126:127]
  v_pk_add_f32 v[72:73], v[72:73], v[128:129]
  v_pk_add_f32 v[74:75], v[74:75], v[130:131]
  v_pk_add_f32 v[76:77], v[76:77], v[132:133]
  v_pk_add_f32 v[78:79], v[78:79], v[134:135]
  v_pk_add_f32 v[80:81], v[80:81], v[136:137]
  v_pk_add_f32 v[82:83], v[82:83], v[138:139]
  v_pk_add_f32 v[84:85], v[84:85], v[140:141]
  v_pk_add_f32 v[86:87], v[86:87], v[142:143]
  v_pk_add_f32 v[88:89], v[88:89], v[144:145]
  v_pk_add_f32 v[90:91], v[90:91], v[146:147]
  v_lshlrev_b32 v19, 3, v1
  s_mul_i32 s38, s3, 3584
  s_add_u32 s38, s38, 131072
  v_add_u32 v19, s38, v19
  s_waitcnt lgkmcnt(0)
  ds_read_b64 v[20:21], v19 offset:0
  ds_read_b64 v[22:23], v19 offset:512
  ds_read_b64 v[24:25], v19 offset:1024
  ds_read_b64 v[26:27], v19 offset:1536
  ds_read_b64 v[28:29], v19 offset:2048
  ds_read_b64 v[30:31], v19 offset:2560
  ds_read_b64 v[32:33], v19 offset:3072
  v_lshlrev_b32 v34, 16, v34
  v_mov_b32 v35, v34
  v_pk_add_f32 v[64:65], v[64:65], v[148:149]
  v_pk_add_f32 v[66:67], v[66:67], v[150:151]
  v_pk_add_f32 v[64:65], v[64:65], v[34:35]
  v_pk_add_f32 v[66:67], v[66:67], v[34:35]
  v_pk_add_f32 v[68:69], v[68:69], v[152:153]
  v_pk_add_f32 v[70:71], v[70:71], v[154:155]
  v_pk_add_f32 v[68:69], v[68:69], v[34:35]
  v_pk_add_f32 v[70:71], v[70:71], v[34:35]
  v_pk_add_f32 v[72:73], v[72:73], v[156:157]
  v_pk_add_f32 v[74:75], v[74:75], v[158:159]
  v_pk_add_f32 v[72:73], v[72:73], v[34:35]
  v_pk_add_f32 v[74:75], v[74:75], v[34:35]
  v_pk_add_f32 v[76:77], v[76:77], v[160:161]
  v_pk_add_f32 v[78:79], v[78:79], v[162:163]
  v_pk_add_f32 v[76:77], v[76:77], v[34:35]
  v_pk_add_f32 v[78:79], v[78:79], v[34:35]
  v_pk_add_f32 v[80:81], v[80:81], v[164:165]
  v_pk_add_f32 v[82:83], v[82:83], v[166:167]
  v_pk_add_f32 v[80:81], v[80:81], v[34:35]
  v_pk_add_f32 v[82:83], v[82:83], v[34:35]
  v_pk_add_f32 v[84:85], v[84:85], v[168:169]
  v_pk_add_f32 v[86:87], v[86:87], v[170:171]
  v_pk_add_f32 v[84:85], v[84:85], v[34:35]
  v_pk_add_f32 v[86:87], v[86:87], v[34:35]
  v_pk_add_f32 v[88:89], v[88:89], v[172:173]
  v_pk_add_f32 v[90:91], v[90:91], v[174:175]
  v_pk_add_f32 v[88:89], v[88:89], v[34:35]
  v_pk_add_f32 v[90:91], v[90:91], v[34:35]
  s_waitcnt lgkmcnt(0)
  s_barrier
  v_lshlrev_b32 v240, 16, v20
  v_and_b32 v241, 0xffff0000, v20
  v_lshlrev_b32 v242, 16, v21
  v_and_b32 v243, 0xffff0000, v21
  v_pk_mul_f32 v[64:65], v[64:65], v[240:241]
  v_pk_mul_f32 v[66:67], v[66:67], v[242:243]
  v_cvt_pk_bf16_f32 v48, v64, v65
  v_cvt_pk_bf16_f32 v49, v66, v67
  v_lshlrev_b32 v240, 16, v22
  v_and_b32 v241, 0xffff0000, v22
  v_lshlrev_b32 v242, 16, v23
  v_and_b32 v243, 0xffff0000, v23
  v_pk_mul_f32 v[68:69], v[68:69], v[240:241]
  v_pk_mul_f32 v[70:71], v[70:71], v[242:243]
  v_cvt_pk_bf16_f32 v50, v68, v69
  v_cvt_pk_bf16_f32 v51, v70, v71
  v_lshlrev_b32 v240, 16, v24
  v_and_b32 v241, 0xffff0000, v24
  v_lshlrev_b32 v242, 16, v25
  v_and_b32 v243, 0xffff0000, v25
  v_pk_mul_f32 v[72:73], v[72:73], v[240:241]
  v_pk_mul_f32 v[74:75], v[74:75], v[242:243]
  v_cvt_pk_bf16_f32 v52, v72, v73
  v_cvt_pk_bf16_f32 v53, v74, v75
  v_lshlrev_b32 v240, 16, v26
  v_and_b32 v241, 0xffff0000, v26
  v_lshlrev_b32 v242, 16, v27
  v_and_b32 v243, 0xffff0000, v27
  v_pk_mul_f32 v[76:77], v[76:77], v[240:241]
  v_pk_mul_f32 v[78:79], v[78:79], v[242:243]
  v_cvt_pk_bf16_f32 v54, v76, v77
  v_cvt_pk_bf16_f32 v55, v78, v79
  v_lshlrev_b32 v240, 16, v28
  v_and_b32 v241, 0xffff0000, v28
  v_lshlrev_b32 v242, 16, v29
  v_and_b32 v243, 0xffff0000, v29
  v_pk_mul_f32 v[80:81], v[80:81], v[240:241]
  v_pk_mul_f32 v[82:83], v[82:83], v[242:243]
  v_cvt_pk_bf16_f32 v56, v80, v81
  v_cvt_pk_bf16_f32 v57, v82, v83
  v_lshlrev_b32 v240, 16, v30
  v_and_b32 v241, 0xffff0000, v30
  v_lshlrev_b32 v242, 16, v31
  v_and_b32 v243, 0xffff0000, v31
  v_pk_mul_f32 v[84:85], v[84:85], v[240:241]
  v_pk_mul_f32 v[86:87], v[86:87], v[242:243]
  v_cvt_pk_bf16_f32 v58, v84, v85
  v_cvt_pk_bf16_f32 v59, v86, v87
  v_lshlrev_b32 v240, 16, v32
  v_and_b32 v241, 0xffff0000, v32
  v_lshlrev_b32 v242, 16, v33
  v_and_b32 v243, 0xffff0000, v33
  v_pk_mul_f32 v[88:89], v[88:89], v[240:241]
  v_pk_mul_f32 v[90:91], v[90:91], v[242:243]
  v_cvt_pk_bf16_f32 v60, v88, v89
  v_cvt_pk_bf16_f32 v61, v90, v91
  s_lshl_b32 s41, s30, 2
  s_add_u32 s41, s41, s3
  s_mul_i32 s41, s41, 28672
  s_add_u32 s41, s41, 16842752
  s_mul_i32 s42, s31, 7
  s_lshr_b32 s43, s42, 1
  s_lshl_b32 s43, s43, 10
  s_add_u32 s41, s41, s43
  v_lshlrev_b32 v19, 3, v1
  s_bitcmp1_b32 s31, 0
  s_cbranch_scc1 adaLN_cond__spectral_fnet__mixer_gmlp__prompt_kernel_uodd70
  buffer_store_dwordx4 v[48:51], v8, s[12:15], s41 offen offset:0 sc1
  buffer_store_dwordx4 v[52:55], v8, s[12:15], s41 offen offset:1024 sc1
  buffer_store_dwordx4 v[56:59], v8, s[12:15], s41 offen offset:2048 sc1
  buffer_store_dwordx2 v[60:61], v19, s[12:15], s41 offen offset:3072 sc1
  s_branch adaLN_cond__spectral_fnet__mixer_gmlp__prompt_kernel_udone71
adaLN_cond__spectral_fnet__mixer_gmlp__prompt_kernel_uodd70:
  buffer_store_dwordx2 v[48:49], v19, s[12:15], s41 offen offset:512 sc1
  buffer_store_dwordx4 v[50:53], v8, s[12:15], s41 offen offset:1024 sc1
  buffer_store_dwordx4 v[54:57], v8, s[12:15], s41 offen offset:2048 sc1
  buffer_store_dwordx4 v[58:61], v8, s[12:15], s41 offen offset:3072 sc1
adaLN_cond__spectral_fnet__mixer_gmlp__prompt_kernel_udone71:
  s_load_dwordx2 s[4:5], s[0:1], 72
  s_load_dwordx2 s[6:7], s[0:1], 112
  s_load_dwordx2 s[24:25], s[0:1], 96
  v_and_b32 v1, 63, v0
  s_and_b32 s28, s2, 7
  s_lshr_b32 s29, s2, 3
  s_lshr_b32 s30, s28, 1
  s_lshl_b32 s30, s30, 3
  s_lshr_b32 s31, s29, 2
  s_add_u32 s30, s30, s31
  s_and_b32 s31, s28, 1
  s_lshl_b32 s31, s31, 2
  s_and_b32 s32, s29, 3
  s_add_u32 s31, s31, s32
  v_lshrrev_b32 v2, 4, v1
  v_and_b32 v3, 15, v1
  v_lshrrev_b32 v8, 2, v3
  v_and_b32 v9, 3, v3
  v_lshl_add_u32 v8, v8, 3, v9
  s_lshl_b32 s39, s30, 6
  s_lshr_b32 s40, s3, 1
  s_lshl_b32 s40, s40, 5
  s_add_u32 s39, s39, s40
  s_and_b32 s40, s3, 1
  s_lshl_b32 s40, s40, 2
  s_add_u32 s39, s39, s40
  v_add_u32 v8, s39, v8
  v_and_b32 v9, 1, v2
  v_lshlrev_b32 v9, 4, v9
  v_lshrrev_b32 v10, 1, v2
  v_lshl_add_u32 v9, v10, 3, v9
  s_lshl_b32 s40, s31, 6
  v_add_u32 v9, s40, v9
  v_lshlrev_b32 v10, 1, v9
  v_lshl_add_u32 v4, v8, 10, v10
  v_lshlrev_b32 v5, 2, v9
  v_lshrrev_b32 v8, 3, v1
  v_and_b32 v9, 7, v1
  v_bfe_u32 v10, v8, 1, 2
  v_lshlrev_b32 v10, 1, v10
  v_xor_b32 v9, v9, v10
  v_lshlrev_b32 v9, 4, v9
  v_lshl_add_u32 v6, v8, 10, v9
  v_lshlrev_b32 v7, 4, v1
  s_lshl_b32 s33, s3, 13
  s_lshl_b32 s34, s31, 7
  s_add_u32 s66, s34, 24576
  s_mov_b32 s67, 3072
  s_add_u32 s33, s33, s34
  s_lshl_b32 s35, s3, 10
  s_lshl_b32 s36, s30, 2
  s_add_u32 s36, s36, s3
  s_mul_i32 s36, s36, 28672
  s_add_u32 s36, s36, 16842752
  v_bfe_u32 v8, v1, 2, 2
  v_lshl_add_u32 v9, v2, 2, v8
  v_bfe_u32 v10, v9, 1, 2
  v_lshlrev_b32 v10, 5, v10
  v_lshl_add_u32 v10, v9, 7, v10
  v_and_b32 v11, 3, v1
  v_lshl_add_u32 v10, v11, 3, v10
  v_xor_b32 v40, 0, v10
  v_add_u32 v44, 0x10000, v40
  v_xor_b32 v41, 32, v10
  v_add_u32 v45, 0x10000, v41
  v_xor_b32 v42, 64, v10
  v_add_u32 v46, 0x10000, v42
  v_xor_b32 v43, 96, v10
  v_add_u32 v47, 0x10000, v43
  s_waitcnt lgkmcnt(0)
  s_mov_b32 s8, s4
  s_mov_b32 s9, s5
  s_mov_b32 s10, 0xe0000
  s_mov_b32 s11, 0x20000
  s_mov_b32 s12, s6
  s_mov_b32 s13, s7
  s_mov_b32 s14, 0x2000000
  s_mov_b32 s15, 0x20000
  s_mov_b32 s16, s24
  s_mov_b32 s17, s25
  s_mov_b32 s18, 0x200000
  s_mov_b32 s19, 0x20000
  s_waitcnt vmcnt(0) lgkmcnt(0)
  s_barrier
  s_cmp_lg_u32 s3, 3
  s_cbranch_scc1 adaLN_cond__spectral_fnet__mixer_gmlp__prompt_kernel_join73
  v_mov_b32 v254, s101
  v_mov_b32 v255, 0
  s_lshl_b32 s88, s2, 7
  s_add_u32 s88, s88, 23199744
  s_mov_b64 s[90:91], exec
  s_mov_b64 exec, 1
  buffer_store_dword v254, v255, s[96:99], s88 offen sc1
  s_mov_b64 exec, s[90:91]
  v_and_b32 v250, 63, v0
  v_lshrrev_b32 v251, 2, v250
  v_and_b32 v252, 3, v250
  v_lshl_add_u32 v251, v252, 3, v251
  s_lshr_b32 s88, s30, 3
  s_lshl_b32 s88, s88, 1
  s_and_b32 s89, s30, 7
  s_lshl_b32 s89, s89, 5
  s_add_u32 s88, s88, s89
  v_add_u32 v251, s88, v251
  v_lshlrev_b32 v251, 7, v251
  v_add_u32 v251, 131072, v251
  v_mov_b32 v252, 0x40000000
  v_cmp_gt_u32 vcc, 8, v250
  s_nop 1
  v_cndmask_b32 v250, v252, v251, vcc
  s_mov_b32 s88, 23068672
  s_mov_b32 s89, 0x40000
adaLN_cond__spectral_fnet__mixer_gmlp__prompt_kernel_gb74:
  buffer_load_dword v244, v250, s[96:99], s88 offen sc1
  s_waitcnt vmcnt(0)
  v_cmp_le_u32 vcc, 0x40000000, v250
  s_nop 1
  v_cndmask_b32 v244, v244, v254, vcc
  v_xor_b32 v244, v244, v254
  v_cmp_ne_u32 vcc, 0, v244
  s_nop 4
  s_cbranch_vccz adaLN_cond__spectral_fnet__mixer_gmlp__prompt_kernel_gbd75
  s_sub_u32 s89, s89, 1
  s_cmp_lg_u32 s89, 0
  s_cbranch_scc1 adaLN_cond__spectral_fnet__mixer_gmlp__prompt_kernel_gb74
adaLN_cond__spectral_fnet__mixer_gmlp__prompt_kernel_gbd75:
  s_mov_b64 s[90:91], exec
  s_cmp_lg_u32 s2, 0
  s_cbranch_scc1 adaLN_cond__spectral_fnet__mixer_gmlp__prompt_kernel_gbe76
  s_mov_b32 s88, 23396352
  s_mov_b64 exec, 1
  buffer_store_dword v254, v255, s[96:99], s88 offen sc1
  s_mov_b64 exec, s[90:91]
adaLN_cond__spectral_fnet__mixer_gmlp__prompt_kernel_gbe76:
  s_branch adaLN_cond__spectral_fnet__mixer_gmlp__prompt_kernel_join277
adaLN_cond__spectral_fnet__mixer_gmlp__prompt_kernel_join73:
  s_getpc_b64 s[92:93]
adaLN_cond__spectral_fnet__mixer_gmlp__prompt_kernel_ct78:
  s_lshl_b32 s94, s3, 13
  v_and_b32 v244, 63, v0
  v_lshlrev_b32 v244, 7, v244
  v_add_u32 v244, s94, v244
  v_cmp_gt_u32 vcc, code_end-adaLN_cond__spectral_fnet__mixer_gmlp__prompt_kernel_ct78, v244
  s_nop 0
  s_and_saveexec_b64 s[94:95], vcc
  s_cbranch_execz adaLN_cond__spectral_fnet__mixer_gmlp__prompt_kernel_ctn79
  global_load_dword v245, v244, s[92:93]
adaLN_cond__spectral_fnet__mixer_gmlp__prompt_kernel_ctn79:
  s_mov_b64 exec, s[94:95]
  s_add_u32 s43, s33, 0
  s_add_u32 m0, s35, 0
  s_nop 0
  buffer_load_dwordx4 v6, s[8:11], s43 offen lds
  s_add_u32 s43, s33, 32768
  s_add_u32 m0, s35, 4096
  s_nop 0
  buffer_load_dwordx4 v6, s[8:11], s43 offen lds
  s_add_u32 s43, s33, 65536
  s_add_u32 m0, s35, 8192
  s_nop 0
  buffer_load_dwordx4 v6, s[8:11], s43 offen lds
  s_add_u32 s43, s33, 98304
  s_add_u32 m0, s35, 12288
  s_nop 0
  buffer_load_dwordx4 v6, s[8:11], s43 offen lds
  s_add_u32 s43, s33, 131072
  s_add_u32 m0, s35, 16384
  s_nop 0
  buffer_load_dwordx4 v6, s[8:11], s43 offen lds
  s_add_u32 s43, s33, 163840
  s_add_u32 m0, s35, 20480
  s_nop 0
  buffer_load_dwordx4 v6, s[8:11], s43 offen lds
  s_add_u32 s43, s33, 196608
  s_add_u32 m0, s35, 24576
  s_nop 0
  buffer_load_dwordx4 v6, s[8:11], s43 offen lds
  s_add_u32 s43, s33, 229376
  s_add_u32 m0, s35, 28672
  s_nop 0
  buffer_load_dwordx4 v6, s[8:11], s43 offen lds
  s_add_u32 s43, s33, 262144
  s_add_u32 m0, s35, 32768
  s_nop 0
  buffer_load_dwordx4 v6, s[8:11], s43 offen lds
  s_add_u32 s43, s33, 294912
  s_add_u32 m0, s35, 36864
  s_nop 0
  buffer_load_dwordx4 v6, s[8:11], s43 offen lds
  s_add_u32 s43, s33, 327680
  s_add_u32 m0, s35, 40960
  s_nop 0
  buffer_load_dwordx4 v6, s[8:11], s43 offen lds
  s_add_u32 s43, s33, 360448
  s_add_u32 m0, s35, 45056
  s_nop 0
  buffer_load_dwordx4 v6, s[8:11], s43 offen lds
  s_add_u32 s43, s33, 393216
  s_add_u32 m0, s35, 49152
  s_nop 0
  buffer_load_dwordx4 v6, s[8:11], s43 offen lds
  s_add_u32 s43, s33, 425984
  s_add_u32 m0, s35, 53248
  s_nop 0
  buffer_load_dwordx4 v6, s[8:11], s43 offen lds
  s_add_u32 s43, s33, 458752
  s_add_u32 m0, s35, 57344
  s_nop 0
  buffer_load_dwordx4 v6, s[8:11], s43 offen lds
  s_add_u32 s43, s33, 491520
  s_add_u32 m0, s35, 61440
  s_nop 0
  buffer_load_dwordx4 v6, s[8:11], s43 offen lds
  s_add_u32 s43, s33, 524288
  s_add_u32 m0, s35, 65536
  s_nop 0
  buffer_load_dwordx4 v6, s[8:11], s43 offen lds
  s_add_u32 s43, s33, 557056
  s_add_u32 m0, s35, 69632
  s_nop 0
  buffer_load_dwordx4 v6, s[8:11], s43 offen lds
  s_add_u32 s43, s33, 589824
  s_add_u32 m0, s35, 73728
  s_nop 0
  buffer_load_dwordx4 v6, s[8:11], s43 offen lds
  s_add_u32 s43, s33, 622592
  s_add_u32 m0, s35, 77824
  s_nop 0
  buffer_load_dwordx4 v6, s[8:11], s43 offen lds
  s_add_u32 s43, s33, 655360
  s_add_u32 m0, s35, 81920
  s_nop 0
  buffer_load_dwordx4 v6, s[8:11], s43 offen lds
  s_add_u32 s43, s33, 688128
  s_add_u32 m0, s35, 86016
  s_nop 0
  buffer_load_dwordx4 v6, s[8:11], s43 offen lds
  s_add_u32 s43, s33, 720896
  s_add_u32 m0, s35, 90112
  s_nop 0
  buffer_load_dwordx4 v6, s[8:11], s43 offen lds
  s_add_u32 s43, s33, 753664
  s_add_u32 m0, s35, 94208
  s_nop 0
  buffer_load_dwordx4 v6, s[8:11], s43 offen lds
  s_add_u32 s43, s33, 786432
  s_add_u32 m0, s35, 98304
  s_nop 0
  buffer_load_dwordx4 v6, s[8:11], s43 offen lds
  s_add_u32 s43, s33, 819200
  s_add_u32 m0, s35, 102400
  s_nop 0
  buffer_load_dwordx4 v6, s[8:11], s43 offen lds
  s_add_u32 s43, s33, 851968
  s_add_u32 m0, s35, 106496
  s_nop 0
  buffer_load_dwordx4 v6, s[8:11], s43 offen lds
  s_add_u32 s43, s33, 884736
  s_add_u32 m0, s35, 110592
  s_nop 0
  buffer_load_dwordx4 v6, s[8:11], s43 offen lds
  s_cmp_eq_u32 s3, 1
  s_cbranch_scc1 adaLN_cond__spectral_fnet__mixer_gmlp__prompt_kernel_alt81
  s_cmp_eq_u32 s3, 2
  s_cbranch_scc1 adaLN_cond__spectral_fnet__mixer_gmlp__prompt_kernel_alt82
  s_add_u32 s43, s66, 0
  s_add_u32 m0, s67, 0
  s_nop 0
  buffer_load_dwordx4 v6, s[8:11], s43 offen lds
  s_add_u32 s43, s66, 98304
  s_add_u32 m0, s67, 12288
  s_nop 0
  buffer_load_dwordx4 v6, s[8:11], s43 offen lds
  s_add_u32 s43, s66, 196608
  s_add_u32 m0, s67, 24576
  s_nop 0
  buffer_load_dwordx4 v6, s[8:11], s43 offen lds
  s_add_u32 s43, s66, 294912
  s_add_u32 m0, s67, 36864
  s_nop 0
  buffer_load_dwordx4 v6, s[8:11], s43 offen lds
  s_add_u32 s43, s66, 393216
  s_add_u32 m0, s67, 49152
  s_nop 0
  buffer_load_dwordx4 v6, s[8:11], s43 offen lds
  s_add_u32 s43, s66, 491520
  s_add_u32 m0, s67, 61440
  s_nop 0
  buffer_load_dwordx4 v6, s[8:11], s43 offen lds
  s_add_u32 s43, s66, 589824
  s_add_u32 m0, s67, 73728
  s_nop 0
  buffer_load_dwordx4 v6, s[8:11], s43 offen lds
  s_add_u32 s43, s66, 688128
  s_add_u32 m0, s67, 86016
  s_nop 0
  buffer_load_dwordx4 v6, s[8:11], s43 offen lds
  s_add_u32 s43, s66, 786432
  s_add_u32 m0, s67, 98304
  s_nop 0
  buffer_load_dwordx4 v6, s[8:11], s43 offen lds
  s_add_u32 s43, s66, 884736
  s_add_u32 m0, s67, 110592
  s_nop 0
  buffer_load_dwordx4 v6, s[8:11], s43 offen lds
  s_branch adaLN_cond__spectral_fnet__mixer_gmlp__prompt_kernel_join2b83
adaLN_cond__spectral_fnet__mixer_gmlp__prompt_kernel_alt81:
  s_add_u32 s43, s66, 32768
  s_add_u32 m0, s67, 4096
  s_nop 0
  buffer_load_dwordx4 v6, s[8:11], s43 offen lds
  s_add_u32 s43, s66, 131072
  s_add_u32 m0, s67, 16384
  s_nop 0
  buffer_load_dwordx4 v6, s[8:11], s43 offen lds
  s_add_u32 s43, s66, 229376
  s_add_u32 m0, s67, 28672
  s_nop 0
  buffer_load_dwordx4 v6, s[8:11], s43 offen lds
  s_add_u32 s43, s66, 327680
  s_add_u32 m0, s67, 40960
  s_nop 0
  buffer_load_dwordx4 v6, s[8:11], s43 offen lds
  s_add_u32 s43, s66, 425984
  s_add_u32 m0, s67, 53248
  s_nop 0
  buffer_load_dwordx4 v6, s[8:11], s43 offen lds
  s_add_u32 s43, s66, 524288
  s_add_u32 m0, s67, 65536
  s_nop 0
  buffer_load_dwordx4 v6, s[8:11], s43 offen lds
  s_add_u32 s43, s66, 622592
  s_add_u32 m0, s67, 77824
  s_nop 0
  buffer_load_dwordx4 v6, s[8:11], s43 offen lds
  s_add_u32 s43, s66, 720896
  s_add_u32 m0, s67, 90112
  s_nop 0
  buffer_load_dwordx4 v6, s[8:11], s43 offen lds
  s_add_u32 s43, s66, 819200
  s_add_u32 m0, s67, 102400
  s_nop 0
  buffer_load_dwordx4 v6, s[8:11], s43 offen lds
  s_branch adaLN_cond__spectral_fnet__mixer_gmlp__prompt_kernel_join2b83
adaLN_cond__spectral_fnet__mixer_gmlp__prompt_kernel_alt82:
  s_add_u32 s43, s66, 65536
  s_add_u32 m0, s67, 8192
  s_nop 0
  buffer_load_dwordx4 v6, s[8:11], s43 offen lds
  s_add_u32 s43, s66, 163840
  s_add_u32 m0, s67, 20480
  s_nop 0
  buffer_load_dwordx4 v6, s[8:11], s43 offen lds
  s_add_u32 s43, s66, 262144
  s_add_u32 m0, s67, 32768
  s_nop 0
  buffer_load_dwordx4 v6, s[8:11], s43 offen lds
  s_add_u32 s43, s66, 360448
  s_add_u32 m0, s67, 45056
  s_nop 0
  buffer_load_dwordx4 v6, s[8:11], s43 offen lds
  s_add_u32 s43, s66, 458752
  s_add_u32 m0, s67, 57344
  s_nop 0
  buffer_load_dwordx4 v6, s[8:11], s43 offen lds
  s_add_u32 s43, s66, 557056
  s_add_u32 m0, s67, 69632
  s_nop 0
  buffer_load_dwordx4 v6, s[8:11], s43 offen lds
  s_add_u32 s43, s66, 655360
  s_add_u32 m0, s67, 81920
  s_nop 0
  buffer_load_dwordx4 v6, s[8:11], s43 offen lds
  s_add_u32 s43, s66, 753664
  s_add_u32 m0, s67, 94208
  s_nop 0
  buffer_load_dwordx4 v6, s[8:11], s43 offen lds
  s_add_u32 s43, s66, 851968
  s_add_u32 m0, s67, 106496
  s_nop 0
  buffer_load_dwordx4 v6, s[8:11], s43 offen lds
adaLN_cond__spectral_fnet__mixer_gmlp__prompt_kernel_join2b83:
adaLN_cond__spectral_fnet__mixer_gmlp__prompt_kernel_join277:
  s_barrier
  v_lshlrev_b32 v11, 3, v1
  s_waitcnt vmcnt(30)
  s_add_u32 s43, s36, 0
  buffer_load_dwordx4 v[64:67], v7, s[12:15], s43 offen offset:0 sc1
  s_add_u32 s43, s36, 0
  buffer_load_dwordx4 v[68:71], v7, s[12:15], s43 offen offset:1024 sc1
  s_add_u32 s43, s36, 0
  buffer_load_dwordx4 v[72:75], v7, s[12:15], s43 offen offset:2048 sc1
  s_add_u32 s43, s36, 0
  buffer_load_dwordx2 v[76:77], v11, s[12:15], s43 offen offset:3072 sc1
  s_add_u32 s44, s36, 3584
  buffer_load_dwordx2 v[78:79], v11, s[12:15], s44 offen sc1
  s_add_u32 s43, s36, 4096
  buffer_load_dwordx4 v[80:83], v7, s[12:15], s43 offen offset:0 sc1
  s_add_u32 s43, s36, 4096
  buffer_load_dwordx4 v[84:87], v7, s[12:15], s43 offen offset:1024 sc1
  s_add_u32 s43, s36, 4096
  buffer_load_dwordx4 v[88:91], v7, s[12:15], s43 offen offset:2048 sc1
  s_add_u32 s43, s36, 4096
  buffer_load_dwordx4 v[92:95], v7, s[12:15], s43 offen offset:3072 sc1
  s_add_u32 s43, s36, 8192
  buffer_load_dwordx4 v[96:99], v7, s[12:15], s43 offen offset:0 sc1
  s_add_u32 s43, s36, 8192
  buffer_load_dwordx4 v[100:103], v7, s[12:15], s43 offen offset:1024 sc1
  s_add_u32 s43, s36, 8192
  buffer_load_dwordx2 v[104:105], v11, s[12:15], s43 offen offset:2048 sc1
  s_add_u32 s44, s36, 10752
  buffer_load_dwordx2 v[106:107], v11, s[12:15], s44 offen sc1
  s_add_u32 s43, s36, 8192
  buffer_load_dwordx4 v[108:111], v7, s[12:15], s43 offen offset:3072 sc1
  s_add_u32 s43, s36, 12288
  buffer_load_dwordx4 v[112:115], v7, s[12:15], s43 offen offset:0 sc1
  s_add_u32 s43, s36, 12288
  buffer_load_dwordx4 v[116:119], v7, s[12:15], s43 offen offset:1024 sc1
  s_waitcnt vmcnt(16)
  s_barrier
  ds_read_b64_tr_b16 v[176:177], v40 offset:0
  ds_read_b64_tr_b16 v[178:179], v40 offset:2048
  ds_read_b64_tr_b16 v[180:181], v41 offset:0
  ds_read_b64_tr_b16 v[182:183], v41 offset:2048
  ds_read_b64_tr_b16 v[184:185], v42 offset:0
  ds_read_b64_tr_b16 v[186:187], v42 offset:2048
  ds_read_b64_tr_b16 v[188:189], v43 offset:0
  ds_read_b64_tr_b16 v[190:191], v43 offset:2048
  ds_read_b64_tr_b16 v[192:193], v40 offset:4096
  ds_read_b64_tr_b16 v[194:195], v40 offset:6144
  ds_read_b64_tr_b16 v[196:197], v41 offset:4096
  ds_read_b64_tr_b16 v[198:199], v41 offset:6144
  ds_read_b64_tr_b16 v[200:201], v42 offset:4096
  ds_read_b64_tr_b16 v[202:203], v42 offset:6144
  ds_read_b64_tr_b16 v[204:205], v43 offset:4096
  ds_read_b64_tr_b16 v[206:207], v43 offset:6144
  s_waitcnt lgkmcnt(8)
  s_waitcnt vmcnt(15)
  v_mfma_f32_16x16x32_bf16 v[48:51], v[176:179], v[64:67], 0
  s_add_u32 s43, s36, 12288
  buffer_load_dwordx4 v[120:123], v7, s[12:15], s43 offen offset:2048 sc1
  ds_read_b64_tr_b16 v[208:209], v40 offset:8192
  ds_read_b64_tr_b16 v[210:211], v40 offset:10240
  v_mfma_f32_16x16x32_bf16 v[52:55], v[180:183], v[64:67], 0
  s_add_u32 s43, s36, 12288
  buffer_load_dwordx4 v[124:127], v7, s[12:15], s43 offen offset:3072 sc1
  ds_read_b64_tr_b16 v[212:213], v41 offset:8192
  ds_read_b64_tr_b16 v[214:215], v41 offset:10240
  v_mfma_f32_16x16x32_bf16 v[56:59], v[184:187], v[64:67], 0
  s_add_u32 s43, s36, 16384
  buffer_load_dwordx4 v[128:131], v7, s[12:15], s43 offen offset:0 sc1
  ds_read_b64_tr_b16 v[216:217], v42 offset:8192
  ds_read_b64_tr_b16 v[218:219], v42 offset:10240
  v_mfma_f32_16x16x32_bf16 v[60:63], v[188:191], v[64:67], 0
  s_add_u32 s43, s36, 16384
  buffer_load_dwordx2 v[132:133], v11, s[12:15], s43 offen offset:1024 sc1
  ds_read_b64_tr_b16 v[220:221], v43 offset:8192
  ds_read_b64_tr_b16 v[222:223], v43 offset:10240
  s_waitcnt lgkmcnt(8)
  s_waitcnt vmcnt(18)
  v_mfma_f32_16x16x32_bf16 v[48:51], v[192:195], v[68:71], v[48:51]
  s_add_u32 s44, s36, 17920
  buffer_load_dwordx2 v[134:135], v11, s[12:15], s44 offen sc1
  ds_read_b64_tr_b16 v[176:177], v40 offset:12288
  ds_read_b64_tr_b16 v[178:179], v40 offset:14336
  v_mfma_f32_16x16x32_bf16 v[52:55], v[196:199], v[68:71], v[52:55]
  s_add_u32 s43, s36, 16384
  buffer_load_dwordx4 v[136:139], v7, s[12:15], s43 offen offset:2048 sc1
  ds_read_b64_tr_b16 v[180:181], v41 offset:12288
  ds_read_b64_tr_b16 v[182:183], v41 offset:14336
  v_mfma_f32_16x16x32_bf16 v[56:59], v[200:203], v[68:71], v[56:59]
  s_add_u32 s43, s36, 16384
  buffer_load_dwordx4 v[140:143], v7, s[12:15], s43 offen offset:3072 sc1
  ds_read_b64_tr_b16 v[184:185], v42 offset:12288
  ds_read_b64_tr_b16 v[186:187], v42 offset:14336
  v_mfma_f32_16x16x32_bf16 v[60:63], v[204:207], v[68:71], v[60:63]
  s_add_u32 s43, s36, 20480
  buffer_load_dwordx4 v[144:147], v7, s[12:15], s43 offen offset:0 sc1
  ds_read_b64_tr_b16 v[188:189], v43 offset:12288
  ds_read_b64_tr_b16 v[190:191], v43 offset:14336
  s_waitcnt lgkmcnt(8)
  s_waitcnt vmcnt(21)
  v_mfma_f32_16x16x32_bf16 v[48:51], v[208:211], v[72:75], v[48:51]
  s_add_u32 s43, s36, 20480
  buffer_load_dwordx4 v[148:151], v7, s[12:15], s43 offen offset:1024 sc1
  ds_read_b64_tr_b16 v[192:193], v40 offset:16384
  ds_read_b64_tr_b16 v[194:195], v40 offset:18432
  v_mfma_f32_16x16x32_bf16 v[52:55], v[212:215], v[72:75], v[52:55]
  s_add_u32 s43, s36, 20480
  buffer_load_dwordx4 v[152:155], v7, s[12:15], s43 offen offset:2048 sc1
  ds_read_b64_tr_b16 v[196:197], v41 offset:16384
  ds_read_b64_tr_b16 v[198:199], v41 offset:18432
  v_mfma_f32_16x16x32_bf16 v[56:59], v[216:219], v[72:75], v[56:59]
  s_add_u32 s43, s36, 20480
  buffer_load_dwordx4 v[156:159], v7, s[12:15], s43 offen offset:3072 sc1
  ds_read_b64_tr_b16 v[200:201], v42 offset:16384
  ds_read_b64_tr_b16 v[202:203], v42 offset:18432
  v_mfma_f32_16x16x32_bf16 v[60:63], v[220:223], v[72:75], v[60:63]
  s_add_u32 s43, s36, 24576
  buffer_load_dwordx2 v[160:161], v11, s[12:15], s43 offen offset:0 sc1
  ds_read_b64_tr_b16 v[204:205], v43 offset:16384
  ds_read_b64_tr_b16 v[206:207], v43 offset:18432
  s_waitcnt lgkmcnt(8)
  s_waitcnt vmcnt(23)
  v_mfma_f32_16x16x32_bf16 v[48:51], v[176:179], v[76:79], v[48:51]
  s_add_u32 s44, s36, 25088
  buffer_load_dwordx2 v[162:163], v11, s[12:15], s44 offen sc1
  ds_read_b64_tr_b16 v[208:209], v40 offset:20480
  ds_read_b64_tr_b16 v[210:211], v40 offset:22528
  v_mfma_f32_16x16x32_bf16 v[52:55], v[180:183], v[76:79], v[52:55]
  s_add_u32 s43, s36, 24576
  buffer_load_dwordx4 v[164:167], v7, s[12:15], s43 offen offset:1024 sc1
  ds_read_b64_tr_b16 v[212:213], v41 offset:20480
  ds_read_b64_tr_b16 v[214:215], v41 offset:22528
  v_mfma_f32_16x16x32_bf16 v[56:59], v[184:187], v[76:79], v[56:59]
  s_add_u32 s43, s36, 24576
  buffer_load_dwordx4 v[168:171], v7, s[12:15], s43 offen offset:2048 sc1
  ds_read_b64_tr_b16 v[216:217], v42 offset:20480
  ds_read_b64_tr_b16 v[218:219], v42 offset:22528
  v_mfma_f32_16x16x32_bf16 v[60:63], v[188:191], v[76:79], v[60:63]
  s_add_u32 s43, s36, 24576
  buffer_load_dwordx4 v[172:175], v7, s[12:15], s43 offen offset:3072 sc1
  ds_read_b64_tr_b16 v[220:221], v43 offset:20480
  ds_read_b64_tr_b16 v[222:223], v43 offset:22528
  s_waitcnt lgkmcnt(8)
  s_waitcnt vmcnt(26)
  v_mfma_f32_16x16x32_bf16 v[48:51], v[192:195], v[80:83], v[48:51]
  s_mov_b32 s41, 5177344
  buffer_load_dwordx4 v[12:15], v4, s[12:15], s41 offen sc1
  ds_read_b64_tr_b16 v[176:177], v40 offset:24576
  ds_read_b64_tr_b16 v[178:179], v40 offset:26624
  v_mfma_f32_16x16x32_bf16 v[52:55], v[196:199], v[80:83], v[52:55]
  buffer_load_dwordx4 v[16:19], v4, s[12:15], s41 offen offset:64 sc1
  ds_read_b64_tr_b16 v[180:181], v41 offset:24576
  ds_read_b64_tr_b16 v[182:183], v41 offset:26624
  v_mfma_f32_16x16x32_bf16 v[56:59], v[200:203], v[80:83], v[56:59]
  s_mov_b32 s42, 10240
  buffer_load_dwordx4 v[20:23], v5, s[12:15], s42 offen sc1
  ds_read_b64_tr_b16 v[184:185], v42 offset:24576
  ds_read_b64_tr_b16 v[186:187], v42 offset:26624
  v_mfma_f32_16x16x32_bf16 v[60:63], v[204:207], v[80:83], v[60:63]
  buffer_load_dwordx4 v[24:27], v5, s[12:15], s42 offen offset:16 sc1
  ds_read_b64_tr_b16 v[188:189], v43 offset:24576
  ds_read_b64_tr_b16 v[190:191], v43 offset:26624
  s_waitcnt lgkmcnt(8)
  s_waitcnt vmcnt(29)
  v_mfma_f32_16x16x32_bf16 v[48:51], v[208:211], v[84:87], v[48:51]
  buffer_load_dwordx4 v[28:31], v5, s[12:15], s42 offen offset:128 sc1
  ds_read_b64_tr_b16 v[192:193], v40 offset:28672
  ds_read_b64_tr_b16 v[194:195], v40 offset:30720
  v_mfma_f32_16x16x32_bf16 v[52:55], v[212:215], v[84:87], v[52:55]
  buffer_load_dwordx4 v[32:35], v5, s[12:15], s42 offen offset:144 sc1
  ds_read_b64_tr_b16 v[196:197], v41 offset:28672
  ds_read_b64_tr_b16 v[198:199], v41 offset:30720
  v_mfma_f32_16x16x32_bf16 v[56:59], v[216:219], v[84:87], v[56:59]
  ds_read_b64_tr_b16 v[200:201], v42 offset:28672
  ds_read_b64_tr_b16 v[202:203], v42 offset:30720
  v_mfma_f32_16x16x32_bf16 v[60:63], v[220:223], v[84:87], v[60:63]
  ds_read_b64_tr_b16 v[204:205], v43 offset:28672
  ds_read_b64_tr_b16 v[206:207], v43 offset:30720
  s_waitcnt lgkmcnt(8)
  s_waitcnt vmcnt(30)
  v_mfma_f32_16x16x32_bf16 v[48:51], v[176:179], v[88:91], v[48:51]
  ds_read_b64_tr_b16 v[208:209], v40 offset:32768
  ds_read_b64_tr_b16 v[210:211], v40 offset:34816
  v_mfma_f32_16x16x32_bf16 v[52:55], v[180:183], v[88:91], v[52:55]
  ds_read_b64_tr_b16 v[212:213], v41 offset:32768
  ds_read_b64_tr_b16 v[214:215], v41 offset:34816
  v_mfma_f32_16x16x32_bf16 v[56:59], v[184:187], v[88:91], v[56:59]
  ds_read_b64_tr_b16 v[216:217], v42 offset:32768
  ds_read_b64_tr_b16 v[218:219], v42 offset:34816
  v_mfma_f32_16x16x32_bf16 v[60:63], v[188:191], v[88:91], v[60:63]
  ds_read_b64_tr_b16 v[220:221], v43 offset:32768
  ds_read_b64_tr_b16 v[222:223], v43 offset:34816
  s_waitcnt lgkmcnt(8)
  s_waitcnt vmcnt(29)
  v_mfma_f32_16x16x32_bf16 v[48:51], v[192:195], v[92:95], v[48:51]
  ds_read_b64_tr_b16 v[176:177], v40 offset:36864
  ds_read_b64_tr_b16 v[178:179], v40 offset:38912
  v_mfma_f32_16x16x32_bf16 v[52:55], v[196:199], v[92:95], v[52:55]
  ds_read_b64_tr_b16 v[180:181], v41 offset:36864
  ds_read_b64_tr_b16 v[182:183], v41 offset:38912
  v_mfma_f32_16x16x32_bf16 v[56:59], v[200:203], v[92:95], v[56:59]
  ds_read_b64_tr_b16 v[184:185], v42 offset:36864
  ds_read_b64_tr_b16 v[186:187], v42 offset:38912
  v_mfma_f32_16x16x32_bf16 v[60:63], v[204:207], v[92:95], v[60:63]
  ds_read_b64_tr_b16 v[188:189], v43 offset:36864
  ds_read_b64_tr_b16 v[190:191], v43 offset:38912
  s_waitcnt lgkmcnt(8)
  s_waitcnt vmcnt(28)
  v_mfma_f32_16x16x32_bf16 v[48:51], v[208:211], v[96:99], v[48:51]
  ds_read_b64_tr_b16 v[192:193], v40 offset:40960
  ds_read_b64_tr_b16 v[194:195], v40 offset:43008
  v_mfma_f32_16x16x32_bf16 v[52:55], v[212:215], v[96:99], v[52:55]
  ds_read_b64_tr_b16 v[196:197], v41 offset:40960
  ds_read_b64_tr_b16 v[198:199], v41 offset:43008
  v_mfma_f32_16x16x32_bf16 v[56:59], v[216:219], v[96:99], v[56:59]
  ds_read_b64_tr_b16 v[200:201], v42 offset:40960
  ds_read_b64_tr_b16 v[202:203], v42 offset:43008
  v_mfma_f32_16x16x32_bf16 v[60:63], v[220:223], v[96:99], v[60:63]
  ds_read_b64_tr_b16 v[204:205], v43 offset:40960
  ds_read_b64_tr_b16 v[206:207], v43 offset:43008
  s_waitcnt lgkmcnt(8)
  s_waitcnt vmcnt(27)
  v_mfma_f32_16x16x32_bf16 v[48:51], v[176:179], v[100:103], v[48:51]
  ds_read_b64_tr_b16 v[208:209], v40 offset:45056
  ds_read_b64_tr_b16 v[210:211], v40 offset:47104
  v_mfma_f32_16x16x32_bf16 v[52:55], v[180:183], v[100:103], v[52:55]
  ds_read_b64_tr_b16 v[212:213], v41 offset:45056
  ds_read_b64_tr_b16 v[214:215], v41 offset:47104
  v_mfma_f32_16x16x32_bf16 v[56:59], v[184:187], v[100:103], v[56:59]
  ds_read_b64_tr_b16 v[216:217], v42 offset:45056
  ds_read_b64_tr_b16 v[218:219], v42 offset:47104
  v_mfma_f32_16x16x32_bf16 v[60:63], v[188:191], v[100:103], v[60:63]
  ds_read_b64_tr_b16 v[220:221], v43 offset:45056
  ds_read_b64_tr_b16 v[222:223], v43 offset:47104
  s_waitcnt lgkmcnt(8)
  s_waitcnt vmcnt(25)
  v_mfma_f32_16x16x32_bf16 v[48:51], v[192:195], v[104:107], v[48:51]
  ds_read_b64_tr_b16 v[176:177], v40 offset:49152
  ds_read_b64_tr_b16 v[178:179], v40 offset:51200
  v_mfma_f32_16x16x32_bf16 v[52:55], v[196:199], v[104:107], v[52:55]
  ds_read_b64_tr_b16 v[180:181], v41 offset:49152
  ds_read_b64_tr_b16 v[182:183], v41 offset:51200
  v_mfma_f32_16x16x32_bf16 v[56:59], v[200:203], v[104:107], v[56:59]
  ds_read_b64_tr_b16 v[184:185], v42 offset:49152
  ds_read_b64_tr_b16 v[186:187], v42 offset:51200
  v_mfma_f32_16x16x32_bf16 v[60:63], v[204:207], v[104:107], v[60:63]
  ds_read_b64_tr_b16 v[188:189], v43 offset:49152
  ds_read_b64_tr_b16 v[190:191], v43 offset:51200
  s_waitcnt lgkmcnt(8)
  s_waitcnt vmcnt(24)
  v_mfma_f32_16x16x32_bf16 v[48:51], v[208:211], v[108:111], v[48:51]
  ds_read_b64_tr_b16 v[192:193], v40 offset:53248
  ds_read_b64_tr_b16 v[194:195], v40 offset:55296
  v_mfma_f32_16x16x32_bf16 v[52:55], v[212:215], v[108:111], v[52:55]
  ds_read_b64_tr_b16 v[196:197], v41 offset:53248
  ds_read_b64_tr_b16 v[198:199], v41 offset:55296
  v_mfma_f32_16x16x32_bf16 v[56:59], v[216:219], v[108:111], v[56:59]
  ds_read_b64_tr_b16 v[200:201], v42 offset:53248
  ds_read_b64_tr_b16 v[202:203], v42 offset:55296
  v_mfma_f32_16x16x32_bf16 v[60:63], v[220:223], v[108:111], v[60:63]
  ds_read_b64_tr_b16 v[204:205], v43 offset:53248
  ds_read_b64_tr_b16 v[206:207], v43 offset:55296
  s_waitcnt lgkmcnt(8)
  s_waitcnt vmcnt(23)
  v_mfma_f32_16x16x32_bf16 v[48:51], v[176:179], v[112:115], v[48:51]
  ds_read_b64_tr_b16 v[208:209], v40 offset:57344
  ds_read_b64_tr_b16 v[210:211], v40 offset:59392
  v_mfma_f32_16x16x32_bf16 v[52:55], v[180:183], v[112:115], v[52:55]
  ds_read_b64_tr_b16 v[212:213], v41 offset:57344
  ds_read_b64_tr_b16 v[214:215], v41 offset:59392
  v_mfma_f32_16x16x32_bf16 v[56:59], v[184:187], v[112:115], v[56:59]
  ds_read_b64_tr_b16 v[216:217], v42 offset:57344
  ds_read_b64_tr_b16 v[218:219], v42 offset:59392
  v_mfma_f32_16x16x32_bf16 v[60:63], v[188:191], v[112:115], v[60:63]
  ds_read_b64_tr_b16 v[220:221], v43 offset:57344
  ds_read_b64_tr_b16 v[222:223], v43 offset:59392
  s_waitcnt lgkmcnt(8)
  s_waitcnt vmcnt(22)
  v_mfma_f32_16x16x32_bf16 v[48:51], v[192:195], v[116:119], v[48:51]
  ds_read_b64_tr_b16 v[176:177], v40 offset:61440
  ds_read_b64_tr_b16 v[178:179], v40 offset:63488
  v_mfma_f32_16x16x32_bf16 v[52:55], v[196:199], v[116:119], v[52:55]
  ds_read_b64_tr_b16 v[180:181], v41 offset:61440
  ds_read_b64_tr_b16 v[182:183], v41 offset:63488
  v_mfma_f32_16x16x32_bf16 v[56:59], v[200:203], v[116:119], v[56:59]
  ds_read_b64_tr_b16 v[184:185], v42 offset:61440
  ds_read_b64_tr_b16 v[186:187], v42 offset:63488
  v_mfma_f32_16x16x32_bf16 v[60:63], v[204:207], v[116:119], v[60:63]
  ds_read_b64_tr_b16 v[188:189], v43 offset:61440
  ds_read_b64_tr_b16 v[190:191], v43 offset:63488
  s_waitcnt lgkmcnt(8)
  s_waitcnt vmcnt(21)
  v_mfma_f32_16x16x32_bf16 v[48:51], v[208:211], v[120:123], v[48:51]
  ds_read_b64_tr_b16 v[192:193], v44 offset:0
  ds_read_b64_tr_b16 v[194:195], v44 offset:2048
  v_mfma_f32_16x16x32_bf16 v[52:55], v[212:215], v[120:123], v[52:55]
  ds_read_b64_tr_b16 v[196:197], v45 offset:0
  ds_read_b64_tr_b16 v[198:199], v45 offset:2048
  v_mfma_f32_16x16x32_bf16 v[56:59], v[216:219], v[120:123], v[56:59]
  ds_read_b64_tr_b16 v[200:201], v46 offset:0
  ds_read_b64_tr_b16 v[202:203], v46 offset:2048
  v_mfma_f32_16x16x32_bf16 v[60:63], v[220:223], v[120:123], v[60:63]
  ds_read_b64_tr_b16 v[204:205], v47 offset:0
  ds_read_b64_tr_b16 v[206:207], v47 offset:2048
  s_waitcnt lgkmcnt(8)
  s_waitcnt vmcnt(20)
  v_mfma_f32_16x16x32_bf16 v[48:51], v[176:179], v[124:127], v[48:51]
  ds_read_b64_tr_b16 v[208:209], v44 offset:4096
  ds_read_b64_tr_b16 v[210:211], v44 offset:6144
  v_mfma_f32_16x16x32_bf16 v[52:55], v[180:183], v[124:127], v[52:55]
  ds_read_b64_tr_b16 v[212:213], v45 offset:4096
  ds_read_b64_tr_b16 v[214:215], v45 offset:6144
  v_mfma_f32_16x16x32_bf16 v[56:59], v[184:187], v[124:127], v[56:59]
  ds_read_b64_tr_b16 v[216:217], v46 offset:4096
  ds_read_b64_tr_b16 v[218:219], v46 offset:6144
  v_mfma_f32_16x16x32_bf16 v[60:63], v[188:191], v[124:127], v[60:63]
  ds_read_b64_tr_b16 v[220:221], v47 offset:4096
  ds_read_b64_tr_b16 v[222:223], v47 offset:6144
  s_waitcnt lgkmcnt(8)
  s_waitcnt vmcnt(19)
  v_mfma_f32_16x16x32_bf16 v[48:51], v[192:195], v[128:131], v[48:51]
  ds_read_b64_tr_b16 v[176:177], v44 offset:8192
  ds_read_b64_tr_b16 v[178:179], v44 offset:10240
  v_mfma_f32_16x16x32_bf16 v[52:55], v[196:199], v[128:131], v[52:55]
  ds_read_b64_tr_b16 v[180:181], v45 offset:8192
  ds_read_b64_tr_b16 v[182:183], v45 offset:10240
  v_mfma_f32_16x16x32_bf16 v[56:59], v[200:203], v[128:131], v[56:59]
  ds_read_b64_tr_b16 v[184:185], v46 offset:8192
  ds_read_b64_tr_b16 v[186:187], v46 offset:10240
  v_mfma_f32_16x16x32_bf16 v[60:63], v[204:207], v[128:131], v[60:63]
  ds_read_b64_tr_b16 v[188:189], v47 offset:8192
  ds_read_b64_tr_b16 v[190:191], v47 offset:10240
  s_waitcnt lgkmcnt(8)
  s_waitcnt vmcnt(17)
  v_mfma_f32_16x16x32_bf16 v[48:51], v[208:211], v[132:135], v[48:51]
  ds_read_b64_tr_b16 v[192:193], v44 offset:12288
  ds_read_b64_tr_b16 v[194:195], v44 offset:14336
  v_mfma_f32_16x16x32_bf16 v[52:55], v[212:215], v[132:135], v[52:55]
  ds_read_b64_tr_b16 v[196:197], v45 offset:12288
  ds_read_b64_tr_b16 v[198:199], v45 offset:14336
  v_mfma_f32_16x16x32_bf16 v[56:59], v[216:219], v[132:135], v[56:59]
  ds_read_b64_tr_b16 v[200:201], v46 offset:12288
  ds_read_b64_tr_b16 v[202:203], v46 offset:14336
  v_mfma_f32_16x16x32_bf16 v[60:63], v[220:223], v[132:135], v[60:63]
  ds_read_b64_tr_b16 v[204:205], v47 offset:12288
  ds_read_b64_tr_b16 v[206:207], v47 offset:14336
  s_waitcnt lgkmcnt(8)
  s_waitcnt vmcnt(16)
  v_mfma_f32_16x16x32_bf16 v[48:51], v[176:179], v[136:139], v[48:51]
  ds_read_b64_tr_b16 v[208:209], v44 offset:16384
  ds_read_b64_tr_b16 v[210:211], v44 offset:18432
  v_mfma_f32_16x16x32_bf16 v[52:55], v[180:183], v[136:139], v[52:55]
  ds_read_b64_tr_b16 v[212:213], v45 offset:16384
  ds_read_b64_tr_b16 v[214:215], v45 offset:18432
  v_mfma_f32_16x16x32_bf16 v[56:59], v[184:187], v[136:139], v[56:59]
  ds_read_b64_tr_b16 v[216:217], v46 offset:16384
  ds_read_b64_tr_b16 v[218:219], v46 offset:18432
  v_mfma_f32_16x16x32_bf16 v[60:63], v[188:191], v[136:139], v[60:63]
  ds_read_b64_tr_b16 v[220:221], v47 offset:16384
  ds_read_b64_tr_b16 v[222:223], v47 offset:18432
  s_waitcnt lgkmcnt(8)
  s_waitcnt vmcnt(15)
  v_mfma_f32_16x16x32_bf16 v[48:51], v[192:195], v[140:143], v[48:51]
  ds_read_b64_tr_b16 v[176:177], v44 offset:20480
  ds_read_b64_tr_b16 v[178:179], v44 offset:22528
  v_mfma_f32_16x16x32_bf16 v[52:55], v[196:199], v[140:143], v[52:55]
  ds_read_b64_tr_b16 v[180:181], v45 offset:20480
  ds_read_b64_tr_b16 v[182:183], v45 offset:22528
  v_mfma_f32_16x16x32_bf16 v[56:59], v[200:203], v[140:143], v[56:59]
  ds_read_b64_tr_b16 v[184:185], v46 offset:20480
  ds_read_b64_tr_b16 v[186:187], v46 offset:22528
  v_mfma_f32_16x16x32_bf16 v[60:63], v[204:207], v[140:143], v[60:63]
  ds_read_b64_tr_b16 v[188:189], v47 offset:20480
  ds_read_b64_tr_b16 v[190:191], v47 offset:22528
  s_waitcnt lgkmcnt(8)
  s_waitcnt vmcnt(14)
  v_mfma_f32_16x16x32_bf16 v[48:51], v[208:211], v[144:147], v[48:51]
  ds_read_b64_tr_b16 v[192:193], v44 offset:24576
  ds_read_b64_tr_b16 v[194:195], v44 offset:26624
  v_mfma_f32_16x16x32_bf16 v[52:55], v[212:215], v[144:147], v[52:55]
  ds_read_b64_tr_b16 v[196:197], v45 offset:24576
  ds_read_b64_tr_b16 v[198:199], v45 offset:26624
  v_mfma_f32_16x16x32_bf16 v[56:59], v[216:219], v[144:147], v[56:59]
  ds_read_b64_tr_b16 v[200:201], v46 offset:24576
  ds_read_b64_tr_b16 v[202:203], v46 offset:26624
  v_mfma_f32_16x16x32_bf16 v[60:63], v[220:223], v[144:147], v[60:63]
  ds_read_b64_tr_b16 v[204:205], v47 offset:24576
  ds_read_b64_tr_b16 v[206:207], v47 offset:26624
  s_waitcnt lgkmcnt(8)
  s_waitcnt vmcnt(13)
  v_mfma_f32_16x16x32_bf16 v[48:51], v[176:179], v[148:151], v[48:51]
  ds_read_b64_tr_b16 v[208:209], v44 offset:28672
  ds_read_b64_tr_b16 v[210:211], v44 offset:30720
  v_mfma_f32_16x16x32_bf16 v[52:55], v[180:183], v[148:151], v[52:55]
  ds_read_b64_tr_b16 v[212:213], v45 offset:28672
  ds_read_b64_tr_b16 v[214:215], v45 offset:30720
  v_mfma_f32_16x16x32_bf16 v[56:59], v[184:187], v[148:151], v[56:59]
  ds_read_b64_tr_b16 v[216:217], v46 offset:28672
  ds_read_b64_tr_b16 v[218:219], v46 offset:30720
  v_mfma_f32_16x16x32_bf16 v[60:63], v[188:191], v[148:151], v[60:63]
  ds_read_b64_tr_b16 v[220:221], v47 offset:28672
  ds_read_b64_tr_b16 v[222:223], v47 offset:30720
  s_waitcnt lgkmcnt(8)
  s_waitcnt vmcnt(12)
  v_mfma_f32_16x16x32_bf16 v[48:51], v[192:195], v[152:155], v[48:51]
  ds_read_b64_tr_b16 v[176:177], v44 offset:32768
  ds_read_b64_tr_b16 v[178:179], v44 offset:34816
  v_mfma_f32_16x16x32_bf16 v[52:55], v[196:199], v[152:155], v[52:55]
  ds_read_b64_tr_b16 v[180:181], v45 offset:32768
  ds_read_b64_tr_b16 v[182:183], v45 offset:34816
  v_mfma_f32_16x16x32_bf16 v[56:59], v[200:203], v[152:155], v[56:59]
  ds_read_b64_tr_b16 v[184:185], v46 offset:32768
  ds_read_b64_tr_b16 v[186:187], v46 offset:34816
  v_mfma_f32_16x16x32_bf16 v[60:63], v[204:207], v[152:155], v[60:63]
  ds_read_b64_tr_b16 v[188:189], v47 offset:32768
  ds_read_b64_tr_b16 v[190:191], v47 offset:34816
  s_waitcnt lgkmcnt(8)
  s_waitcnt vmcnt(11)
  v_mfma_f32_16x16x32_bf16 v[48:51], v[208:211], v[156:159], v[48:51]
  ds_read_b64_tr_b16 v[192:193], v44 offset:36864
  ds_read_b64_tr_b16 v[194:195], v44 offset:38912
  v_mfma_f32_16x16x32_bf16 v[52:55], v[212:215], v[156:159], v[52:55]
  ds_read_b64_tr_b16 v[196:197], v45 offset:36864
  ds_read_b64_tr_b16 v[198:199], v45 offset:38912
  v_mfma_f32_16x16x32_bf16 v[56:59], v[216:219], v[156:159], v[56:59]
  ds_read_b64_tr_b16 v[200:201], v46 offset:36864
  ds_read_b64_tr_b16 v[202:203], v46 offset:38912
  v_mfma_f32_16x16x32_bf16 v[60:63], v[220:223], v[156:159], v[60:63]
  ds_read_b64_tr_b16 v[204:205], v47 offset:36864
  ds_read_b64_tr_b16 v[206:207], v47 offset:38912
  s_waitcnt lgkmcnt(8)
  s_waitcnt vmcnt(9)
  v_mfma_f32_16x16x32_bf16 v[48:51], v[176:179], v[160:163], v[48:51]
  ds_read_b64_tr_b16 v[208:209], v44 offset:40960
  ds_read_b64_tr_b16 v[210:211], v44 offset:43008
  v_mfma_f32_16x16x32_bf16 v[52:55], v[180:183], v[160:163], v[52:55]
  ds_read_b64_tr_b16 v[212:213], v45 offset:40960
  ds_read_b64_tr_b16 v[214:215], v45 offset:43008
  v_mfma_f32_16x16x32_bf16 v[56:59], v[184:187], v[160:163], v[56:59]
  ds_read_b64_tr_b16 v[216:217], v46 offset:40960
  ds_read_b64_tr_b16 v[218:219], v46 offset:43008
  v_mfma_f32_16x16x32_bf16 v[60:63], v[188:191], v[160:163], v[60:63]
  ds_read_b64_tr_b16 v[220:221], v47 offset:40960
  ds_read_b64_tr_b16 v[222:223], v47 offset:43008
  s_waitcnt lgkmcnt(8)
  s_waitcnt vmcnt(8)
  v_mfma_f32_16x16x32_bf16 v[48:51], v[192:195], v[164:167], v[48:51]
  ds_read_b64_tr_b16 v[176:177], v44 offset:45056
  ds_read_b64_tr_b16 v[178:179], v44 offset:47104
  v_mfma_f32_16x16x32_bf16 v[52:55], v[196:199], v[164:167], v[52:55]
  ds_read_b64_tr_b16 v[180:181], v45 offset:45056
  ds_read_b64_tr_b16 v[182:183], v45 offset:47104
  v_mfma_f32_16x16x32_bf16 v[56:59], v[200:203], v[164:167], v[56:59]
  ds_read_b64_tr_b16 v[184:185], v46 offset:45056
  ds_read_b64_tr_b16 v[186:187], v46 offset:47104
  v_mfma_f32_16x16x32_bf16 v[60:63], v[204:207], v[164:167], v[60:63]
  ds_read_b64_tr_b16 v[188:189], v47 offset:45056
  ds_read_b64_tr_b16 v[190:191], v47 offset:47104
  s_waitcnt lgkmcnt(8)
  s_waitcnt vmcnt(7)
  v_mfma_f32_16x16x32_bf16 v[48:51], v[208:211], v[168:171], v[48:51]
  v_mfma_f32_16x16x32_bf16 v[52:55], v[212:215], v[168:171], v[52:55]
  v_mfma_f32_16x16x32_bf16 v[56:59], v[216:219], v[168:171], v[56:59]
  v_mfma_f32_16x16x32_bf16 v[60:63], v[220:223], v[168:171], v[60:63]
  s_waitcnt lgkmcnt(0)
  s_waitcnt vmcnt(6)
  v_mfma_f32_16x16x32_bf16 v[48:51], v[176:179], v[172:175], v[48:51]
  v_mfma_f32_16x16x32_bf16 v[52:55], v[180:183], v[172:175], v[52:55]
  v_mfma_f32_16x16x32_bf16 v[56:59], v[184:187], v[172:175], v[56:59]
  v_mfma_f32_16x16x32_bf16 v[60:63], v[188:191], v[172:175], v[60:63]
  s_waitcnt vmcnt(0)
  s_nop 4
  v_permlane16_swap_b32 v48, v52
  v_permlane16_swap_b32 v49, v53
  v_permlane16_swap_b32 v50, v54
  v_permlane16_swap_b32 v51, v55
  v_permlane16_swap_b32 v56, v60
  v_permlane16_swap_b32 v57, v61
  v_permlane16_swap_b32 v58, v62
  v_permlane16_swap_b32 v59, v63
  s_lshl_b32 s41, s3, 11
  s_add_u32 s41, s41, 114688
  v_lshlrev_b32 v80, 7, v3
  v_and_b32 v81, 1, v2
  v_lshl_add_u32 v80, v81, 5, v80
  v_lshrrev_b32 v81, 1, v2
  v_lshl_add_u32 v80, v81, 4, v80
  v_add_u32 v80, s41, v80
  v_lshlrev_b32 v64, 16, v12
  v_and_b32 v65, 0xffff0000, v12
  v_lshlrev_b32 v66, 16, v13
  v_and_b32 v67, 0xffff0000, v13
  v_lshlrev_b32 v68, 16, v14
  v_and_b32 v69, 0xffff0000, v14
  v_lshlrev_b32 v70, 16, v15
  v_and_b32 v71, 0xffff0000, v15
  v_fmac_f32 v64, v48, v20
  v_fmac_f32 v65, v49, v21
  v_fmac_f32 v66, v50, v22
  v_fmac_f32 v67, v51, v23
  v_fmac_f32 v68, v52, v24
  v_fmac_f32 v69, v53, v25
  v_fmac_f32 v70, v54, v26
  v_fmac_f32 v71, v55, v27
  v_cvt_pk_bf16_f32 v72, v64, v65
  v_cvt_pk_bf16_f32 v73, v66, v67
  v_cvt_pk_bf16_f32 v74, v68, v69
  v_cvt_pk_bf16_f32 v75, v70, v71
  ds_write_b128 v80, v[72:75] offset:0
  v_lshlrev_b32 v64, 16, v16
  v_and_b32 v65, 0xffff0000, v16
  v_lshlrev_b32 v66, 16, v17
  v_and_b32 v67, 0xffff0000, v17
  v_lshlrev_b32 v68, 16, v18
  v_and_b32 v69, 0xffff0000, v18
  v_lshlrev_b32 v70, 16, v19
  v_and_b32 v71, 0xffff0000, v19
  v_fmac_f32 v64, v56, v28
  v_fmac_f32 v65, v57, v29
  v_fmac_f32 v66, v58, v30
  v_fmac_f32 v67, v59, v31
  v_fmac_f32 v68, v60, v32
  v_fmac_f32 v69, v61, v33
  v_fmac_f32 v70, v62, v34
  v_fmac_f32 v71, v63, v35
  v_cvt_pk_bf16_f32 v76, v64, v65
  v_cvt_pk_bf16_f32 v77, v66, v67
  v_cvt_pk_bf16_f32 v78, v68, v69
  v_cvt_pk_bf16_f32 v79, v70, v71
  ds_write_b128 v80, v[76:79] offset:64
  v_lshlrev_b32 v81, 4, v1
  v_add_u32 v81, s41, v81
  v_lshrrev_b32 v82, 3, v1
  v_lshrrev_b32 v83, 2, v82
  v_and_b32 v82, 3, v82
  v_lshl_add_u32 v82, v83, 3, v82
  v_add_u32 v82, s39, v82
  v_and_b32 v83, 7, v1
  v_lshlrev_b32 v83, 4, v83
  v_lshl_add_u32 v82, v82, 10, v83
  s_lshl_b32 s41, s31, 7
  s_waitcnt lgkmcnt(0)
  ds_read_b128 v[72:75], v81
  ds_read_b128 v[76:79], v81 offset:1024
  s_add_u32 s42, s41, 16384
  s_waitcnt lgkmcnt(1)
  buffer_store_dwordx4 v[72:75], v82, s[16:19], s41 offen sc1
  s_waitcnt lgkmcnt(0)
  buffer_store_dwordx4 v[76:79], v82, s[16:19], s42 offen sc1
persist_end:
  s_endpgm
code_end:
  s_endpgm
.section .rodata,"a"
.p2align 6
.amdhsa_kernel adaLN_cond__spectral_fnet__mixer_gmlp__prompt_kernel
  .amdhsa_next_free_vgpr 512
  .amdhsa_next_free_sgpr 102
  .amdhsa_accum_offset 256
  .amdhsa_group_segment_fixed_size 0
  .amdhsa_kernarg_size 120
  .amdhsa_user_sgpr_count 2
  .amdhsa_user_sgpr_kernarg_segment_ptr 1
  .amdhsa_system_sgpr_workgroup_id_x 1
.end_amdhsa_kernel
```
